```python
import torch

def _softmax(x, axis=-1):
    return torch.softmax(x, dim=axis)
def _gelu(x):
    return torch.nn.functional.gelu(x, approximate="tanh")
def _silu(x):
    return torch.nn.functional.silu(x)
def _sigmoid(x):
    return torch.sigmoid(x)
def _layernorm(x, axis=-1, eps=1e-5):
    m = x.mean(dim=axis, keepdim=True)
    v = x.var(dim=axis, keepdim=True, unbiased=False)
    return (x - m) / torch.sqrt(v + eps)
def _scatter_add(tgt, idx, src, axis=0):
    return tgt.clone().index_add_(axis, idx, src)
def _segment_sum(src, seg, n):
    out = torch.zeros((n,) + src.shape[1:], dtype=src.dtype)
    return out.index_add_(0, seg, src)
def _pad(x, pw):
    flat = tuple(v for pair in reversed(pw) for v in pair)
    return torch.nn.functional.pad(x, flat)

kernel_name = 'concat_heads__mha_block_cached__mha_block_cached__near_ridge'

def setup_inputs():

    _w = (lambda a: (lambda t: t.to(torch.bfloat16) if t.is_floating_point() else t)(torch.as_tensor(a)))
    def _A_setup():
        B, Sq, D = 8, 96, 640
        H, Sk, Dh = 32, 1024, 128
        return {
            "x": _w((lambda *s: torch.randn(*s, dtype=torch.bfloat16) * 0.8)(B, Sq, D)),
            "k_cache": _w((lambda *s: torch.randn(*s, dtype=torch.bfloat16) * 0.8)(B, H, Sk, Dh)),
            "v_cache": _w((lambda *s: torch.randn(*s, dtype=torch.bfloat16) * 0.05)(B, H, Sk, Dh)),
            "wq": _w((lambda *s: torch.randn(*s, dtype=torch.bfloat16) * 0.8)(D, H * Dh) * (D ** -0.5)),
            "wo": _w((lambda *s: torch.randn(*s, dtype=torch.bfloat16) * 0.05)(H * Dh, D) * ((H * Dh) ** -0.5)),
        }
    _A_in = _A_setup()

    def _B_setup():
        B, Sq, D = 8, 96, 640
        H, Sk, Dh = 32, 1024, 128
        return {
            "x": _w((lambda *s: torch.randn(*s, dtype=torch.bfloat16) * 0.8)(B, Sq, D)),
            "k_cache": _w((lambda *s: torch.randn(*s, dtype=torch.bfloat16) * 0.8)(B, H, Sk, Dh)),
            "v_cache": _w((lambda *s: torch.randn(*s, dtype=torch.bfloat16) * 0.05)(B, H, Sk, Dh)),
            "wq": _w((lambda *s: torch.randn(*s, dtype=torch.bfloat16) * 0.8)(D, H * Dh) * (D ** -0.5)),
            "wo": _w((lambda *s: torch.randn(*s, dtype=torch.bfloat16) * 0.05)(H * Dh, D) * ((H * Dh) ** -0.5)),
        }
    _B_in = _B_setup()

    return {
        "A_x": _A_in["x"],
        "A_k_cache": _A_in["k_cache"],
        "A_v_cache": _A_in["v_cache"],
        "A_wq": _A_in["wq"],
        "A_wo": _A_in["wo"],
        "B_x": _B_in["x"],
        "B_k_cache": _B_in["k_cache"],
        "B_v_cache": _B_in["v_cache"],
        "B_wq": _B_in["wq"],
        "B_wo": _B_in["wo"],
    }

def reference(A_x, A_k_cache, A_v_cache, A_wq, A_wo, B_x, B_k_cache, B_v_cache, B_wq, B_wo):
    def _A_ref(x, k_cache, v_cache, wq, wo):
        B, Sq, D = x.shape
        H, Dh = 32, 128
        q = (lambda x, *d: x.permute(*d))((x @ wq).reshape(B, Sq, H, Dh), 0, 2, 1, 3)
        scores = torch.einsum("bhqd,bhkd->bhqk", q, k_cache) * (Dh ** -0.5)
        p = _softmax(scores, axis=-1)
        o = torch.einsum("bhqk,bhkd->bhqd", p, v_cache)
        return (lambda x, *d: x.permute(*d))(o, 0, 2, 1, 3).reshape(B, Sq, H * Dh) @ wo

    def _B_ref(x, k_cache, v_cache, wq, wo):
        B, Sq, D = x.shape
        H, Dh = 32, 128
        q = (lambda x, *d: x.permute(*d))((x @ wq).reshape(B, Sq, H, Dh), 0, 2, 1, 3)
        scores = torch.einsum("bhqd,bhkd->bhqk", q, k_cache) * (Dh ** -0.5)
        p = _softmax(scores, axis=-1)
        o = torch.einsum("bhqk,bhkd->bhqd", p, v_cache)
        return (lambda x, *d: x.permute(*d))(o, 0, 2, 1, 3).reshape(B, Sq, H * Dh) @ wo

    a = _A_ref(A_x, A_k_cache, A_v_cache, A_wq, A_wo)
    b = _B_ref(B_x, B_k_cache, B_v_cache, B_wq, B_wo)
    return torch.concatenate([a, b], axis=-1)
```

```asm
; @launch grid=(256,1,1) block=(256,1,1) lds=163840
.amdgcn_target "amdgcn-amd-amdhsa--gfx950"
.text
.globl concat_heads__mha_block_cached__mha_block_cached__near_ridge_kernel
.p2align 8
.type concat_heads__mha_block_cached__mha_block_cached__near_ridge_kernel,@function
concat_heads__mha_block_cached__mha_block_cached__near_ridge_kernel:
    s_load_dwordx16 s[64:79], s[0:1], 0
    s_load_dwordx8 s[80:87], s[0:1], 64
    s_load_dwordx2 s[88:89], s[0:1], 96
    s_cmp_ge_u32 s2, 256
    s_cbranch_scc1 L_exit
    v_lshrrev_b32 v2, 6, v0
    v_and_b32 v1, 63, v0
    v_readfirstlane_b32 s34, v2
    s_and_b32 s38, s2, 7
    s_lshr_b32 s39, s2, 3
    s_lshr_b32 s35, s38, 2
    s_and_b32 s40, s38, 3
    s_lshl_b32 s36, s40, 3
    s_and_b32 s41, s39, 7
    s_add_u32 s36, s36, s41
    s_lshr_b32 s37, s39, 3
    s_mul_i32 s42, s37, 5
    s_add_u32 s42, s42, 1
    s_lshr_b32 s42, s42, 1
    s_mov_b32 s42, 0
    s_add_u32 s42, s42, s41
    s_cmp_ge_u32 s42, 10
    s_cselect_b32 s41, 10, 0
    s_sub_u32 s42, s42, s41
    s_mul_i32 s57, s39, 13
    s_lshr_b32 s57, s57, 6
    s_mul_i32 s41, s57, 5
    s_sub_u32 s58, s39, s41
    s_and_b32 s41, s40, 1
    s_mul_i32 s41, s41, 5
    s_add_u32 s58, s58, s41
    s_lshr_b32 s41, s40, 1
    s_mul_i32 s41, s41, 6
    s_add_u32 s57, s57, s41
    s_cmp_ge_u32 s39, 30
    s_cselect_b32 s58, 15, s58
    s_cselect_b32 s57, 0, s57
    s_mul_i32 s92, s57, 11
    s_lshr_b32 s92, s92, 5
    s_lshl_b32 s56, s2, 2
    s_add_u32 s56, s56, s34
    s_lshl_b32 s56, s56, 8
    s_add_u32 s56, s56, 13631488
    s_lshl_b32 s44, s34, 13
    s_lshl_b32 s90, s58, 7
    s_cmp_ge_u32 s58, 5
    s_cselect_b32 s38, 5, 0
    s_sub_u32 s94, s58, s38
    s_mul_i32 s94, s94, 0
    s_and_b32 s94, s94, 15
    s_mov_b32 s6, 983040
    s_mov_b32 s7, 0x20000
    s_mov_b32 s10, 67108864
    s_mov_b32 s11, 0x20000
    s_mov_b32 s14, 67108864
    s_mov_b32 s15, 0x20000
    s_mov_b32 s18, 5242880
    s_mov_b32 s19, 0x20000
    s_mov_b32 s22, 5242880
    s_mov_b32 s23, 0x20000
    s_mov_b32 s26, 1966080
    s_mov_b32 s27, 0x20000
    s_mov_b32 s30, 16777216
    s_mov_b32 s31, 0x20000
    s_cmp_eq_u32 s34, 3
    s_cbranch_scc0 L_cpre
L_loader:
    v_lshrrev_b32 v2, 4, v1
    v_and_b32 v3, 15, v1
    v_lshlrev_b32 v5, 2, v2
    v_xor_b32 v5, v5, v3
    v_lshlrev_b32 v4, 8, v2
    v_lshl_add_u32 v16, v5, 4, v4
    v_add_u32 v5, 0, v2
    v_xor_b32 v5, v5, v3
    v_lshl_add_u32 v24, v5, 4, v4
    v_add_u32 v5, 4, v2
    v_xor_b32 v5, v5, v3
    v_lshl_add_u32 v25, v5, 4, v4
    v_add_u32 v5, 8, v2
    v_xor_b32 v5, v5, v3
    v_lshl_add_u32 v26, v5, 4, v4
    v_add_u32 v5, 12, v2
    v_xor_b32 v5, v5, v3
    v_lshl_add_u32 v27, v5, 4, v4
    s_lshl_b32 s45, s37, 5
    s_add_u32 s45, s45, s36
    s_lshl_b32 s45, s45, 18
    s_and_b32 s97, s2, 7
    s_lshl_b32 s97, s97, 1
    s_lshr_b32 s38, s2, 3
    s_add_u32 s97, s97, s38
    s_and_b32 s97, s97, 0
    s_lshl_b32 s97, s97, 14
    v_lshlrev_b32 v20, 19, v1
    v_lshlrev_b32 v21, 25, v1
    v_mov_b32 v19, 0
    v_lshlrev_b32 v23, 18, v1
    s_lshl_b32 s38, s35, 2
    s_add_u32 s63, s38, s37
    s_lshl_b32 s63, s63, 5
    s_add_u32 s63, s63, s36
    s_lshl_b32 s63, s63, 7
    s_add_u32 s63, s63, 12582912
    s_mul_i32 s40, s35, 8
    s_add_u32 s40, s40, s37
    s_mul_i32 s40, s40, 96
    s_add_u32 s40, s40, s36
    s_lshl_b32 s40, s40, 13
    s_getpc_b64 s[54:55]
L_pc:
    s_sub_u32 s54, s54, L_pc-concat_heads__mha_block_cached__mha_block_cached__near_ridge_kernel
    s_subb_u32 s55, s55, 0
    s_lshr_b32 s38, s2, 3
    s_lshl_b32 s38, s38, 11
    v_lshlrev_b32 v2, 7, v1
    v_add_u32 v2, s38, v2
    v_min_u32 v2, L_end-concat_heads__mha_block_cached__mha_block_cached__near_ridge_kernel-4, v2
    s_mov_b64 exec, 0xffff
    global_load_dword v22, v2, s[54:55]
    s_mov_b64 exec, -1
    s_waitcnt lgkmcnt(0)
    s_cmp_eq_u32 s35, 0
    s_cselect_b64 s[16:17], s[70:71], s[80:81]
    s_cselect_b64 s[4:5], s[64:65], s[74:75]
    s_cselect_b64 s[8:9], s[66:67], s[76:77]
    s_cselect_b64 s[12:13], s[68:69], s[78:79]
    s_cselect_b64 s[20:21], s[72:73], s[82:83]
    s_mov_b64 s[24:25], s[84:85]
    s_mov_b64 s[28:29], s[88:89]
    s_mov_b64 s[32:33], s[86:87]
    s_and_b32 s17, s17, 0xffff
    s_and_b32 s5, s5, 0xffff
    s_and_b32 s9, s9, 0xffff
    s_and_b32 s13, s13, 0xffff
    s_and_b32 s21, s21, 0xffff
    s_and_b32 s25, s25, 0xffff
    s_and_b32 s29, s29, 0xffff
    s_mov_b64 exec, 3
    buffer_load_dword v22, v21, s[8:11], s45 offen
    buffer_load_dword v22, v21, s[12:15], s45 offen
    s_mov_b64 exec, 0x3ffffff
    buffer_load_dword v22, v20, s[20:23], 0 offen
    buffer_load_dword v22, v20, s[24:27], 0 offen
    s_mov_b64 exec, 0x7007
    buffer_load_dword v22, v23, s[28:31], s40 offen
    s_mov_b64 exec, 1
    buffer_load_dword v22, v19, s[28:31], s63 offen
    global_load_dword v22, v19, s[32:33] offset:128
    s_mov_b64 exec, -1
    s_cmp_lg_u32 s2, 0
    s_cbranch_scc1 L_notag
    s_memrealtime s[54:55]
    s_waitcnt lgkmcnt(0)
    s_mul_i32 s55, s55, 0x9e3779b1
    s_add_u32 s54, s54, s55
    s_or_b32 s54, s54, 4
    s_and_b32 s54, s54, -4
    v_mov_b32 v4, s54
    s_mov_b64 exec, 1
    global_store_dword v19, v4, s[32:33] sc1
    s_mov_b64 exec, -1
L_notag:
    s_branch L_loader2
L_cpre:
    v_lshrrev_b32 v2, 3, v1
    v_mul_u32_u24 v2, 1280, v2
    v_lshrrev_b32 v3, 4, v1
    v_and_b32 v4, 7, v1
    v_xor_b32 v3, v3, v4
    v_xor_b32 v4, 0, v3
    v_lshl_add_u32 v12, v4, 4, v2
    v_xor_b32 v4, 4, v3
    v_lshl_add_u32 v13, v4, 4, v2
    v_add_u32 v13, 9216, v13
    v_xor_b32 v4, 0, v3
    v_lshl_add_u32 v14, v4, 4, v2
    v_add_u32 v14, 18432, v14
    v_xor_b32 v4, 4, v3
    v_lshl_add_u32 v15, v4, 4, v2
    v_add_u32 v15, 27648, v15
    s_mul_i32 s43, s37, 3
    s_add_u32 s43, s43, s34
    s_mul_i32 s52, s35, 24
    s_add_u32 s52, s52, s43
    s_mul_i32 s43, s43, 40960
    s_cmp_ge_u32 s42, 9
    s_cselect_b32 s38, 9, 0
    s_sub_u32 s42, s42, s38
    s_cmp_ge_u32 s42, 9
    s_cselect_b32 s38, 9, 0
    s_sub_u32 s42, s42, s38
    s_add_u32 s97, s42, 1
    s_mov_b32 s42, 0
    v_lshrrev_b32 v2, 4, v1
    v_and_b32 v3, 15, v1
    v_lshlrev_b32 v5, 2, v2
    v_xor_b32 v5, v5, v3
    v_lshlrev_b32 v4, 13, v2
    v_lshl_add_u32 v104, v5, 4, v4
    v_add_u32 v105, 31744, v104
    v_add_u32 v106, 63488, v104
    v_add_u32 v107, 95232, v104
    s_mul_i32 s45, s34, 163840
    s_lshl_b32 s38, s36, 8
    s_add_u32 s45, s45, s38
    s_mul_i32 s63, s34, 5120
    s_mul_i32 s96, s34, 163840
    s_sub_u32 s96, 491520, s96
    s_mov_b64 s[60:61], 0xffffff
    s_cmp_eq_u32 s34, 1
    s_cselect_b32 s60, 0xff000000, s60
    s_cselect_b32 s61, 0xfff, s61
    s_cmp_eq_u32 s34, 2
    s_cselect_b32 s60, 0, s60
    s_cselect_b32 s61, 0xfffff000, s61
    s_waitcnt lgkmcnt(0)
    s_cmp_eq_u32 s35, 0
    s_cselect_b64 s[16:17], s[70:71], s[80:81]
    s_cselect_b64 s[4:5], s[64:65], s[74:75]
    s_cselect_b64 s[8:9], s[66:67], s[76:77]
    s_cselect_b64 s[12:13], s[68:69], s[78:79]
    s_cselect_b64 s[20:21], s[72:73], s[82:83]
    s_mov_b64 s[24:25], s[84:85]
    s_mov_b64 s[28:29], s[88:89]
    s_mov_b64 s[32:33], s[86:87]
    s_and_b32 s17, s17, 0xffff
    s_and_b32 s5, s5, 0xffff
    s_and_b32 s9, s9, 0xffff
    s_and_b32 s13, s13, 0xffff
    s_and_b32 s21, s21, 0xffff
    s_and_b32 s25, s25, 0xffff
    s_and_b32 s29, s29, 0xffff
    s_lshl_b32 s40, s42, 19
    s_add_u32 s40, s40, s45
    s_add_u32 m0, s63, 114688
    s_add_u32 s39, s40, 0
    buffer_load_dwordx4 v104, s[16:19], s39 offen offset:0 sc1 lds
    buffer_load_dwordx4 v105, s[16:19], s39 offen offset:1024 sc1 lds
    buffer_load_dwordx4 v106, s[16:19], s39 offen offset:2048 sc1 lds
    buffer_load_dwordx4 v107, s[16:19], s39 offen offset:3072 sc1 lds
    s_add_u32 m0, s63, 118784
    s_add_u32 s39, s40, 131072
    buffer_load_dwordx4 v104, s[16:19], s39 offen offset:0 sc1 lds
    s_mov_b32 m0, 130048
    s_add_u32 s39, s40, s96
    s_mov_b64 exec, s[60:61]
    buffer_load_dwordx4 v104, s[16:19], s39 offen sc1 lds
    s_mov_b64 exec, -1
    s_lshl_b32 s38, s42, 7
    s_add_u32 s38, s38, s43
    s_add_u32 m0, s44, 0
    s_add_u32 s39, s38, 0
    buffer_load_dwordx4 v12, s[4:7], s39 offen offset:0 sc1 lds
    buffer_load_dwordx4 v13, s[4:7], s39 offen offset:1024 sc1 lds
    buffer_load_dwordx4 v14, s[4:7], s39 offen offset:2048 sc1 lds
    buffer_load_dwordx4 v15, s[4:7], s39 offen offset:3072 sc1 lds
    s_add_u32 m0, s44, 4096
    s_add_u32 s39, s38, 491520
    buffer_load_dwordx4 v12, s[4:7], s39 offen offset:0 sc1 lds
    buffer_load_dwordx4 v13, s[4:7], s39 offen offset:1024 sc1 lds
    buffer_load_dwordx4 v14, s[4:7], s39 offen offset:2048 sc1 lds
    buffer_load_dwordx4 v15, s[4:7], s39 offen offset:3072 sc1 lds
    s_mov_b32 s42, s97
    s_cmp_eq_u32 s58, 15
    s_cselect_b32 s22, 0, s22
    s_lshl_b32 s52, s52, 5
    s_add_u32 s52, s52, s36
    s_lshl_b32 s52, s52, 13
    v_lshrrev_b32 v2, 5, v1
    v_bfe_u32 v3, v1, 2, 2
    v_lshl_add_u32 v4, v2, 3, v3
    v_lshlrev_b32 v4, 8, v4
    v_lshl_add_u32 v4, v3, 6, v4
    v_bfe_u32 v5, v1, 4, 1
    v_lshl_add_u32 v4, v5, 5, v4
    v_and_b32 v5, 1, v1
    v_lshl_add_u32 v4, v5, 4, v4
    v_bfe_u32 v5, v1, 1, 1
    v_lshl_add_u32 v4, v5, 3, v4
    v_xor_b32 v96, 0, v4
    v_add_u32 v96, 114688, v96
    v_xor_b32 v97, 64, v4
    v_add_u32 v97, 114688, v97
    v_xor_b32 v98, 128, v4
    v_add_u32 v98, 114688, v98
    v_xor_b32 v99, 192, v4
    v_add_u32 v99, 114688, v99
    v_and_b32 v3, 31, v1
    v_bfe_u32 v4, v1, 1, 3
    v_xor_b32 v4, v4, v2
    v_lshlrev_b32 v4, 4, v4
    v_lshl_add_u32 v4, v3, 7, v4
    s_add_u32 s38, s44, 0
    v_xor_b32 v100, 0, v4
    v_add_u32 v100, s38, v100
    v_xor_b32 v101, 32, v4
    v_add_u32 v101, s38, v101
    v_xor_b32 v102, 64, v4
    v_add_u32 v102, s38, v102
    v_xor_b32 v103, 96, v4
    v_add_u32 v103, s38, v103
    v_and_b32 v4, 15, v1
    v_xor_b32 v4, v4, v2
    v_lshlrev_b32 v4, 4, v4
    v_lshl_add_u32 v4, v3, 8, v4
    v_xor_b32 v16, 0, v4
    v_add_u32 v16, 131072, v16
    v_xor_b32 v17, 32, v4
    v_add_u32 v17, 131072, v17
    v_xor_b32 v18, 64, v4
    v_add_u32 v18, 131072, v18
    v_xor_b32 v19, 96, v4
    v_add_u32 v19, 131072, v19
    v_xor_b32 v20, 128, v4
    v_add_u32 v20, 131072, v20
    v_xor_b32 v21, 160, v4
    v_add_u32 v21, 131072, v21
    v_xor_b32 v22, 192, v4
    v_add_u32 v22, 131072, v22
    v_xor_b32 v23, 224, v4
    v_add_u32 v23, 131072, v23
    v_bfe_u32 v3, v1, 2, 2
    v_lshl_add_u32 v4, v2, 2, v3
    v_lshlrev_b32 v4, 8, v4
    v_lshl_add_u32 v4, v3, 6, v4
    v_bfe_u32 v5, v1, 4, 1
    v_lshl_add_u32 v4, v5, 5, v4
    v_and_b32 v5, 3, v1
    v_lshl_add_u32 v4, v5, 3, v4
    v_add_u32 v4, 32768, v4
    v_xor_b32 v24, 0, v4
    v_xor_b32 v25, 64, v4
    v_xor_b32 v26, 128, v4
    v_xor_b32 v27, 192, v4
    v_lshlrev_b32 v28, 4, v1
    v_add_u32 v31, s44, v28
    v_lshrrev_b32 v2, 5, v1
    v_bfe_u32 v3, v1, 2, 2
    v_lshl_add_u32 v29, v2, 2, v3
    v_lshlrev_b32 v29, 7, v29
    v_bfe_u32 v5, v1, 3, 1
    v_lshl_add_u32 v29, v5, 6, v29
    v_bfe_u32 v5, v1, 4, 1
    v_lshl_add_u32 v29, v5, 5, v29
    v_and_b32 v5, 3, v1
    v_lshl_add_u32 v29, v5, 3, v29
    v_add_u32 v29, s44, v29
    v_xor_b32 v30, 64, v29
    s_mul_i32 s53, s34, 1310720
    s_add_u32 s53, s53, s90
    s_mov_b32 s95, s94
    s_add_u32 s62, s34, 4
    s_mov_b32 s59, 0
    v_accvgpr_write_b32 a0, 0
    v_accvgpr_write_b32 a1, 0
    v_accvgpr_write_b32 a2, 0
    v_accvgpr_write_b32 a3, 0
    v_accvgpr_write_b32 a4, 0
    v_accvgpr_write_b32 a5, 0
    v_accvgpr_write_b32 a6, 0
    v_accvgpr_write_b32 a7, 0
    v_accvgpr_write_b32 a8, 0
    v_accvgpr_write_b32 a9, 0
    v_accvgpr_write_b32 a10, 0
    v_accvgpr_write_b32 a11, 0
    v_accvgpr_write_b32 a12, 0
    v_accvgpr_write_b32 a13, 0
    v_accvgpr_write_b32 a14, 0
    v_accvgpr_write_b32 a15, 0
    v_accvgpr_write_b32 a16, 0
    v_accvgpr_write_b32 a17, 0
    v_accvgpr_write_b32 a18, 0
    v_accvgpr_write_b32 a19, 0
    v_accvgpr_write_b32 a20, 0
    v_accvgpr_write_b32 a21, 0
    v_accvgpr_write_b32 a22, 0
    v_accvgpr_write_b32 a23, 0
    v_accvgpr_write_b32 a24, 0
    v_accvgpr_write_b32 a25, 0
    v_accvgpr_write_b32 a26, 0
    v_accvgpr_write_b32 a27, 0
    v_accvgpr_write_b32 a28, 0
    v_accvgpr_write_b32 a29, 0
    v_accvgpr_write_b32 a30, 0
    v_accvgpr_write_b32 a31, 0
    v_accvgpr_write_b32 a32, 0
    v_accvgpr_write_b32 a33, 0
    v_accvgpr_write_b32 a34, 0
    v_accvgpr_write_b32 a35, 0
    v_accvgpr_write_b32 a36, 0
    v_accvgpr_write_b32 a37, 0
    v_accvgpr_write_b32 a38, 0
    v_accvgpr_write_b32 a39, 0
    v_accvgpr_write_b32 a40, 0
    v_accvgpr_write_b32 a41, 0
    v_accvgpr_write_b32 a42, 0
    v_accvgpr_write_b32 a43, 0
    v_accvgpr_write_b32 a44, 0
    v_accvgpr_write_b32 a45, 0
    v_accvgpr_write_b32 a46, 0
    v_accvgpr_write_b32 a47, 0
    v_accvgpr_write_b32 a48, 0
    v_accvgpr_write_b32 a49, 0
    v_accvgpr_write_b32 a50, 0
    v_accvgpr_write_b32 a51, 0
    v_accvgpr_write_b32 a52, 0
    v_accvgpr_write_b32 a53, 0
    v_accvgpr_write_b32 a54, 0
    v_accvgpr_write_b32 a55, 0
    v_accvgpr_write_b32 a56, 0
    v_accvgpr_write_b32 a57, 0
    v_accvgpr_write_b32 a58, 0
    v_accvgpr_write_b32 a59, 0
    v_accvgpr_write_b32 a60, 0
    v_accvgpr_write_b32 a61, 0
    v_accvgpr_write_b32 a62, 0
    v_accvgpr_write_b32 a63, 0
    v_mov_b32 v32, 0
    v_mov_b32 v33, 0
    v_mov_b32 v34, 0
    v_mov_b32 v35, 0
    v_mov_b32 v36, 0
    v_mov_b32 v37, 0
    v_mov_b32 v38, 0
    v_mov_b32 v39, 0
    v_mov_b32 v40, 0
    v_mov_b32 v41, 0
    v_mov_b32 v42, 0
    v_mov_b32 v43, 0
    v_mov_b32 v44, 0
    v_mov_b32 v45, 0
    v_mov_b32 v46, 0
    v_mov_b32 v47, 0
    v_mov_b32 v6, 0
    v_mov_b32 v7, 0
    v_mov_b32 v8, 0
    v_mov_b32 v9, 0
    s_mov_b32 s51, 0x3e0293ee
    s_mov_b32 s49, 0xff800000
    s_mov_b32 s50, 0xff800000
    s_mov_b32 s46, 0
    s_mov_b32 s47, 114688
    s_mov_b32 s48, 0
    s_lshl_b32 s40, s42, 19
    s_add_u32 s40, s40, s45
    s_add_u32 m0, s63, 32768
    s_add_u32 s39, s40, 0
    buffer_load_dwordx4 v104, s[16:19], s39 offen offset:0 sc1 lds
    buffer_load_dwordx4 v105, s[16:19], s39 offen offset:1024 sc1 lds
    buffer_load_dwordx4 v106, s[16:19], s39 offen offset:2048 sc1 lds
    buffer_load_dwordx4 v107, s[16:19], s39 offen offset:3072 sc1 lds
    s_add_u32 m0, s63, 36864
    s_add_u32 s39, s40, 131072
    buffer_load_dwordx4 v104, s[16:19], s39 offen offset:0 sc1 lds
    s_mov_b32 m0, 48128
    s_add_u32 s39, s40, s96
    s_mov_b64 exec, s[60:61]
    buffer_load_dwordx4 v104, s[16:19], s39 offen sc1 lds
    s_mov_b64 exec, -1
    s_lshl_b32 s38, s42, 7
    s_add_u32 s38, s38, s43
    s_add_u32 m0, s44, 49152
    s_add_u32 s39, s38, 0
    buffer_load_dwordx4 v12, s[4:7], s39 offen offset:0 sc1 lds
    buffer_load_dwordx4 v13, s[4:7], s39 offen offset:1024 sc1 lds
    buffer_load_dwordx4 v14, s[4:7], s39 offen offset:2048 sc1 lds
    buffer_load_dwordx4 v15, s[4:7], s39 offen offset:3072 sc1 lds
    s_add_u32 m0, s44, 53248
    s_add_u32 s39, s38, 491520
    buffer_load_dwordx4 v12, s[4:7], s39 offen offset:0 sc1 lds
    buffer_load_dwordx4 v13, s[4:7], s39 offen offset:1024 sc1 lds
    buffer_load_dwordx4 v14, s[4:7], s39 offen offset:2048 sc1 lds
    buffer_load_dwordx4 v15, s[4:7], s39 offen offset:3072 sc1 lds
    s_add_u32 s42, s42, 1
    s_cmp_eq_u32 s42, 10
    s_cselect_b32 s42, 1, s42
    s_waitcnt vmcnt(14)
    s_barrier
    ds_read_b128 v[80:83], v100 offset:0
    ds_read_b128 v[84:87], v100 offset:4096
    ds_read_b64_tr_b16 v[48:49], v96 offset:0
    ds_read_b64_tr_b16 v[50:51], v96 offset:1024
    ds_read_b64_tr_b16 v[52:53], v97 offset:0
    ds_read_b64_tr_b16 v[54:55], v97 offset:1024
    ds_read_b64_tr_b16 v[56:57], v98 offset:0
    ds_read_b64_tr_b16 v[58:59], v98 offset:1024
    ds_read_b64_tr_b16 v[60:61], v99 offset:0
    ds_read_b64_tr_b16 v[62:63], v99 offset:1024
    s_waitcnt lgkmcnt(0)
    v_mfma_f32_32x32x16_bf16 v[128:143], v[48:51], v[80:83], 0
    ds_read_b128 v[88:91], v101 offset:0
    ds_read_b128 v[92:95], v101 offset:4096
    ds_read_b64_tr_b16 v[64:65], v96 offset:4096
    ds_read_b64_tr_b16 v[66:67], v96 offset:5120
    v_mfma_f32_32x32x16_bf16 v[192:207], v[48:51], v[84:87], 0
    ds_read_b64_tr_b16 v[68:69], v97 offset:4096
    ds_read_b64_tr_b16 v[70:71], v97 offset:5120
    ds_read_b64_tr_b16 v[72:73], v98 offset:4096
    ds_read_b64_tr_b16 v[74:75], v98 offset:5120
    v_mfma_f32_32x32x16_bf16 v[144:159], v[52:55], v[80:83], 0
    ds_read_b64_tr_b16 v[76:77], v99 offset:4096
    ds_read_b64_tr_b16 v[78:79], v99 offset:5120
    s_lshl_b32 s40, s42, 19
    s_add_u32 s40, s40, s45
    s_add_u32 m0, s63, 73728
    s_add_u32 s39, s40, 0
    buffer_load_dwordx4 v104, s[16:19], s39 offen offset:0 sc1 lds
    buffer_load_dwordx4 v105, s[16:19], s39 offen offset:1024 sc1 lds
    v_mfma_f32_32x32x16_bf16 v[208:223], v[52:55], v[84:87], 0
    buffer_load_dwordx4 v106, s[16:19], s39 offen offset:2048 sc1 lds
    buffer_load_dwordx4 v107, s[16:19], s39 offen offset:3072 sc1 lds
    s_add_u32 m0, s63, 77824
    s_add_u32 s39, s40, 131072
    buffer_load_dwordx4 v104, s[16:19], s39 offen offset:0 sc1 lds
    v_mfma_f32_32x32x16_bf16 v[160:175], v[56:59], v[80:83], 0
    s_mov_b32 m0, 89088
    s_add_u32 s39, s40, s96
    s_mov_b64 exec, s[60:61]
    buffer_load_dwordx4 v104, s[16:19], s39 offen sc1 lds
    s_mov_b64 exec, -1
    s_lshl_b32 s38, s42, 7
    s_add_u32 s38, s38, s43
    s_add_u32 m0, s44, 90112
    v_mfma_f32_32x32x16_bf16 v[176:191], v[60:63], v[80:83], 0
    s_add_u32 s39, s38, 0
    buffer_load_dwordx4 v12, s[4:7], s39 offen offset:0 sc1 lds
    buffer_load_dwordx4 v13, s[4:7], s39 offen offset:1024 sc1 lds
    buffer_load_dwordx4 v14, s[4:7], s39 offen offset:2048 sc1 lds
    buffer_load_dwordx4 v15, s[4:7], s39 offen offset:3072 sc1 lds
    s_waitcnt lgkmcnt(0)
    v_mfma_f32_32x32x16_bf16 v[128:143], v[64:67], v[88:91], v[128:143]
    ds_read_b128 v[80:83], v102 offset:0
    ds_read_b128 v[84:87], v102 offset:4096
    ds_read_b64_tr_b16 v[48:49], v96 offset:8192
    ds_read_b64_tr_b16 v[50:51], v96 offset:9216
    v_mfma_f32_32x32x16_bf16 v[192:207], v[64:67], v[92:95], v[192:207]
    ds_read_b64_tr_b16 v[52:53], v97 offset:8192
    ds_read_b64_tr_b16 v[54:55], v97 offset:9216
    ds_read_b64_tr_b16 v[56:57], v98 offset:8192
    ds_read_b64_tr_b16 v[58:59], v98 offset:9216
    v_mfma_f32_32x32x16_bf16 v[144:159], v[68:71], v[88:91], v[144:159]
    ds_read_b64_tr_b16 v[60:61], v99 offset:8192
    ds_read_b64_tr_b16 v[62:63], v99 offset:9216
    s_add_u32 m0, s44, 94208
    s_add_u32 s39, s38, 491520
    buffer_load_dwordx4 v12, s[4:7], s39 offen offset:0 sc1 lds
    v_mfma_f32_32x32x16_bf16 v[208:223], v[68:71], v[92:95], v[208:223]
    buffer_load_dwordx4 v13, s[4:7], s39 offen offset:1024 sc1 lds
    buffer_load_dwordx4 v14, s[4:7], s39 offen offset:2048 sc1 lds
    v_mfma_f32_32x32x16_bf16 v[160:175], v[72:75], v[88:91], v[160:175]
    buffer_load_dwordx4 v15, s[4:7], s39 offen offset:3072 sc1 lds
    s_add_u32 s42, s42, 1
    v_mfma_f32_32x32x16_bf16 v[176:191], v[76:79], v[88:91], v[176:191]
    s_cmp_eq_u32 s42, 10
    s_cselect_b32 s42, 1, s42
    s_waitcnt lgkmcnt(0)
    v_mfma_f32_32x32x16_bf16 v[128:143], v[48:51], v[80:83], v[128:143]
    ds_read_b128 v[88:91], v103 offset:0
    ds_read_b128 v[92:95], v103 offset:4096
    ds_read_b64_tr_b16 v[64:65], v96 offset:12288
    ds_read_b64_tr_b16 v[66:67], v96 offset:13312
    v_mfma_f32_32x32x16_bf16 v[192:207], v[48:51], v[84:87], v[192:207]
    ds_read_b64_tr_b16 v[68:69], v97 offset:12288
    ds_read_b64_tr_b16 v[70:71], v97 offset:13312
    ds_read_b64_tr_b16 v[72:73], v98 offset:12288
    ds_read_b64_tr_b16 v[74:75], v98 offset:13312
    v_mfma_f32_32x32x16_bf16 v[144:159], v[52:55], v[80:83], v[144:159]
    ds_read_b64_tr_b16 v[76:77], v99 offset:12288
    ds_read_b64_tr_b16 v[78:79], v99 offset:13312
    v_subrev_u32 v96, 81920, v96
    v_subrev_u32 v97, 81920, v97
    v_mfma_f32_32x32x16_bf16 v[208:223], v[52:55], v[84:87], v[208:223]
    v_subrev_u32 v98, 81920, v98
    v_subrev_u32 v99, 81920, v99
    v_mfma_f32_32x32x16_bf16 v[160:175], v[56:59], v[80:83], v[160:175]
    v_add_u32 v100, 49152, v100
    v_add_u32 v101, 49152, v101
    v_mfma_f32_32x32x16_bf16 v[176:191], v[60:63], v[80:83], v[176:191]
    v_add_u32 v102, 49152, v102
    v_add_u32 v103, 49152, v103
    s_waitcnt lgkmcnt(0)
    s_waitcnt vmcnt(14)
    s_barrier
    v_mfma_f32_32x32x16_bf16 v[128:143], v[64:67], v[88:91], v[128:143]
    ds_read_b128 v[80:83], v100 offset:0
    ds_read_b128 v[84:87], v100 offset:4096
    ds_read_b64_tr_b16 v[48:49], v96 offset:0
    ds_read_b64_tr_b16 v[50:51], v96 offset:1024
    v_mfma_f32_32x32x16_bf16 v[192:207], v[64:67], v[92:95], v[192:207]
    ds_read_b64_tr_b16 v[52:53], v97 offset:0
    ds_read_b64_tr_b16 v[54:55], v97 offset:1024
    ds_read_b64_tr_b16 v[56:57], v98 offset:0
    ds_read_b64_tr_b16 v[58:59], v98 offset:1024
    v_mfma_f32_32x32x16_bf16 v[144:159], v[68:71], v[88:91], v[144:159]
    ds_read_b64_tr_b16 v[60:61], v99 offset:0
    ds_read_b64_tr_b16 v[62:63], v99 offset:1024
    s_lshl_b32 s40, s42, 19
    s_add_u32 s40, s40, s45
    s_add_u32 m0, s63, 114688
    s_add_u32 s39, s40, 0
    v_mfma_f32_32x32x16_bf16 v[208:223], v[68:71], v[92:95], v[208:223]
    buffer_load_dwordx4 v104, s[16:19], s39 offen offset:0 sc1 lds
    buffer_load_dwordx4 v105, s[16:19], s39 offen offset:1024 sc1 lds
    buffer_load_dwordx4 v106, s[16:19], s39 offen offset:2048 sc1 lds
    v_mfma_f32_32x32x16_bf16 v[160:175], v[72:75], v[88:91], v[160:175]
    buffer_load_dwordx4 v107, s[16:19], s39 offen offset:3072 sc1 lds
    s_add_u32 m0, s63, 118784
    s_add_u32 s39, s40, 131072
    buffer_load_dwordx4 v104, s[16:19], s39 offen offset:0 sc1 lds
    v_mfma_f32_32x32x16_bf16 v[176:191], v[76:79], v[88:91], v[176:191]
    s_mov_b32 m0, 130048
    s_add_u32 s39, s40, s96
    s_mov_b64 exec, s[60:61]
    buffer_load_dwordx4 v104, s[16:19], s39 offen sc1 lds
    s_mov_b64 exec, -1
    s_waitcnt lgkmcnt(0)
    v_mfma_f32_32x32x16_bf16 v[128:143], v[48:51], v[80:83], v[128:143]
    ds_read_b128 v[88:91], v101 offset:0
    ds_read_b128 v[92:95], v101 offset:4096
    ds_read_b64_tr_b16 v[64:65], v96 offset:4096
    ds_read_b64_tr_b16 v[66:67], v96 offset:5120
    v_mfma_f32_32x32x16_bf16 v[192:207], v[48:51], v[84:87], v[192:207]
    ds_read_b64_tr_b16 v[68:69], v97 offset:4096
    ds_read_b64_tr_b16 v[70:71], v97 offset:5120
    ds_read_b64_tr_b16 v[72:73], v98 offset:4096
    ds_read_b64_tr_b16 v[74:75], v98 offset:5120
    v_mfma_f32_32x32x16_bf16 v[144:159], v[52:55], v[80:83], v[144:159]
    ds_read_b64_tr_b16 v[76:77], v99 offset:4096
    ds_read_b64_tr_b16 v[78:79], v99 offset:5120
    s_lshl_b32 s38, s42, 7
    s_add_u32 s38, s38, s43
    v_mfma_f32_32x32x16_bf16 v[208:223], v[52:55], v[84:87], v[208:223]
    s_add_u32 m0, s44, 0
    s_add_u32 s39, s38, 0
    v_mfma_f32_32x32x16_bf16 v[160:175], v[56:59], v[80:83], v[160:175]
    buffer_load_dwordx4 v12, s[4:7], s39 offen offset:0 sc1 lds
    buffer_load_dwordx4 v13, s[4:7], s39 offen offset:1024 sc1 lds
    v_mfma_f32_32x32x16_bf16 v[176:191], v[60:63], v[80:83], v[176:191]
    buffer_load_dwordx4 v14, s[4:7], s39 offen offset:2048 sc1 lds
    buffer_load_dwordx4 v15, s[4:7], s39 offen offset:3072 sc1 lds
    s_waitcnt lgkmcnt(0)
    v_mfma_f32_32x32x16_bf16 v[128:143], v[64:67], v[88:91], v[128:143]
    ds_read_b128 v[80:83], v102 offset:0
    ds_read_b128 v[84:87], v102 offset:4096
    ds_read_b64_tr_b16 v[48:49], v96 offset:8192
    ds_read_b64_tr_b16 v[50:51], v96 offset:9216
    v_mfma_f32_32x32x16_bf16 v[192:207], v[64:67], v[92:95], v[192:207]
    ds_read_b64_tr_b16 v[52:53], v97 offset:8192
    ds_read_b64_tr_b16 v[54:55], v97 offset:9216
    ds_read_b64_tr_b16 v[56:57], v98 offset:8192
    ds_read_b64_tr_b16 v[58:59], v98 offset:9216
    v_mfma_f32_32x32x16_bf16 v[144:159], v[68:71], v[88:91], v[144:159]
    ds_read_b64_tr_b16 v[60:61], v99 offset:8192
    ds_read_b64_tr_b16 v[62:63], v99 offset:9216
    s_add_u32 m0, s44, 4096
    s_add_u32 s39, s38, 491520
    buffer_load_dwordx4 v12, s[4:7], s39 offen offset:0 sc1 lds
    v_mfma_f32_32x32x16_bf16 v[208:223], v[68:71], v[92:95], v[208:223]
    buffer_load_dwordx4 v13, s[4:7], s39 offen offset:1024 sc1 lds
    buffer_load_dwordx4 v14, s[4:7], s39 offen offset:2048 sc1 lds
    v_mfma_f32_32x32x16_bf16 v[160:175], v[72:75], v[88:91], v[160:175]
    buffer_load_dwordx4 v15, s[4:7], s39 offen offset:3072 sc1 lds
    s_add_u32 s42, s42, 1
    v_mfma_f32_32x32x16_bf16 v[176:191], v[76:79], v[88:91], v[176:191]
    s_cmp_eq_u32 s42, 10
    s_cselect_b32 s42, 1, s42
    s_waitcnt lgkmcnt(0)
    v_mfma_f32_32x32x16_bf16 v[128:143], v[48:51], v[80:83], v[128:143]
    ds_read_b128 v[88:91], v103 offset:0
    ds_read_b128 v[92:95], v103 offset:4096
    ds_read_b64_tr_b16 v[64:65], v96 offset:12288
    ds_read_b64_tr_b16 v[66:67], v96 offset:13312
    v_mfma_f32_32x32x16_bf16 v[192:207], v[48:51], v[84:87], v[192:207]
    ds_read_b64_tr_b16 v[68:69], v97 offset:12288
    ds_read_b64_tr_b16 v[70:71], v97 offset:13312
    ds_read_b64_tr_b16 v[72:73], v98 offset:12288
    ds_read_b64_tr_b16 v[74:75], v98 offset:13312
    v_mfma_f32_32x32x16_bf16 v[144:159], v[52:55], v[80:83], v[144:159]
    ds_read_b64_tr_b16 v[76:77], v99 offset:12288
    ds_read_b64_tr_b16 v[78:79], v99 offset:13312
    v_add_u32 v96, 40960, v96
    v_add_u32 v97, 40960, v97
    v_mfma_f32_32x32x16_bf16 v[208:223], v[52:55], v[84:87], v[208:223]
    v_add_u32 v98, 40960, v98
    v_add_u32 v99, 40960, v99
    v_mfma_f32_32x32x16_bf16 v[160:175], v[56:59], v[80:83], v[160:175]
    v_add_u32 v100, 40960, v100
    v_add_u32 v101, 40960, v101
    v_mfma_f32_32x32x16_bf16 v[176:191], v[60:63], v[80:83], v[176:191]
    v_add_u32 v102, 40960, v102
    v_add_u32 v103, 40960, v103
    s_waitcnt lgkmcnt(0)
    s_waitcnt vmcnt(14)
    s_barrier
    v_mfma_f32_32x32x16_bf16 v[128:143], v[64:67], v[88:91], v[128:143]
    ds_read_b128 v[80:83], v100 offset:0
    ds_read_b128 v[84:87], v100 offset:4096
    ds_read_b64_tr_b16 v[48:49], v96 offset:0
    ds_read_b64_tr_b16 v[50:51], v96 offset:1024
    v_mfma_f32_32x32x16_bf16 v[192:207], v[64:67], v[92:95], v[192:207]
    ds_read_b64_tr_b16 v[52:53], v97 offset:0
    ds_read_b64_tr_b16 v[54:55], v97 offset:1024
    ds_read_b64_tr_b16 v[56:57], v98 offset:0
    ds_read_b64_tr_b16 v[58:59], v98 offset:1024
    v_mfma_f32_32x32x16_bf16 v[144:159], v[68:71], v[88:91], v[144:159]
    ds_read_b64_tr_b16 v[60:61], v99 offset:0
    ds_read_b64_tr_b16 v[62:63], v99 offset:1024
    s_lshl_b32 s40, s42, 19
    s_add_u32 s40, s40, s45
    s_add_u32 m0, s63, 32768
    s_add_u32 s39, s40, 0
    v_mfma_f32_32x32x16_bf16 v[208:223], v[68:71], v[92:95], v[208:223]
    buffer_load_dwordx4 v104, s[16:19], s39 offen offset:0 sc1 lds
    buffer_load_dwordx4 v105, s[16:19], s39 offen offset:1024 sc1 lds
    buffer_load_dwordx4 v106, s[16:19], s39 offen offset:2048 sc1 lds
    v_mfma_f32_32x32x16_bf16 v[160:175], v[72:75], v[88:91], v[160:175]
    buffer_load_dwordx4 v107, s[16:19], s39 offen offset:3072 sc1 lds
    s_add_u32 m0, s63, 36864
    s_add_u32 s39, s40, 131072
    buffer_load_dwordx4 v104, s[16:19], s39 offen offset:0 sc1 lds
    v_mfma_f32_32x32x16_bf16 v[176:191], v[76:79], v[88:91], v[176:191]
    s_mov_b32 m0, 48128
    s_add_u32 s39, s40, s96
    s_mov_b64 exec, s[60:61]
    buffer_load_dwordx4 v104, s[16:19], s39 offen sc1 lds
    s_mov_b64 exec, -1
    s_waitcnt lgkmcnt(0)
    v_mfma_f32_32x32x16_bf16 v[128:143], v[48:51], v[80:83], v[128:143]
    ds_read_b128 v[88:91], v101 offset:0
    ds_read_b128 v[92:95], v101 offset:4096
    ds_read_b64_tr_b16 v[64:65], v96 offset:4096
    ds_read_b64_tr_b16 v[66:67], v96 offset:5120
    v_mfma_f32_32x32x16_bf16 v[192:207], v[48:51], v[84:87], v[192:207]
    ds_read_b64_tr_b16 v[68:69], v97 offset:4096
    ds_read_b64_tr_b16 v[70:71], v97 offset:5120
    ds_read_b64_tr_b16 v[72:73], v98 offset:4096
    ds_read_b64_tr_b16 v[74:75], v98 offset:5120
    v_mfma_f32_32x32x16_bf16 v[144:159], v[52:55], v[80:83], v[144:159]
    ds_read_b64_tr_b16 v[76:77], v99 offset:4096
    ds_read_b64_tr_b16 v[78:79], v99 offset:5120
    s_lshl_b32 s38, s42, 7
    s_add_u32 s38, s38, s43
    v_mfma_f32_32x32x16_bf16 v[208:223], v[52:55], v[84:87], v[208:223]
    s_add_u32 m0, s44, 49152
    s_add_u32 s39, s38, 0
    v_mfma_f32_32x32x16_bf16 v[160:175], v[56:59], v[80:83], v[160:175]
    buffer_load_dwordx4 v12, s[4:7], s39 offen offset:0 sc1 lds
    buffer_load_dwordx4 v13, s[4:7], s39 offen offset:1024 sc1 lds
    v_mfma_f32_32x32x16_bf16 v[176:191], v[60:63], v[80:83], v[176:191]
    buffer_load_dwordx4 v14, s[4:7], s39 offen offset:2048 sc1 lds
    buffer_load_dwordx4 v15, s[4:7], s39 offen offset:3072 sc1 lds
    s_waitcnt lgkmcnt(0)
    v_mfma_f32_32x32x16_bf16 v[128:143], v[64:67], v[88:91], v[128:143]
    ds_read_b128 v[80:83], v102 offset:0
    ds_read_b128 v[84:87], v102 offset:4096
    ds_read_b64_tr_b16 v[48:49], v96 offset:8192
    ds_read_b64_tr_b16 v[50:51], v96 offset:9216
    v_mfma_f32_32x32x16_bf16 v[192:207], v[64:67], v[92:95], v[192:207]
    ds_read_b64_tr_b16 v[52:53], v97 offset:8192
    ds_read_b64_tr_b16 v[54:55], v97 offset:9216
    ds_read_b64_tr_b16 v[56:57], v98 offset:8192
    ds_read_b64_tr_b16 v[58:59], v98 offset:9216
    v_mfma_f32_32x32x16_bf16 v[144:159], v[68:71], v[88:91], v[144:159]
    ds_read_b64_tr_b16 v[60:61], v99 offset:8192
    ds_read_b64_tr_b16 v[62:63], v99 offset:9216
    s_add_u32 m0, s44, 53248
    s_add_u32 s39, s38, 491520
    buffer_load_dwordx4 v12, s[4:7], s39 offen offset:0 sc1 lds
    v_mfma_f32_32x32x16_bf16 v[208:223], v[68:71], v[92:95], v[208:223]
    buffer_load_dwordx4 v13, s[4:7], s39 offen offset:1024 sc1 lds
    buffer_load_dwordx4 v14, s[4:7], s39 offen offset:2048 sc1 lds
    v_mfma_f32_32x32x16_bf16 v[160:175], v[72:75], v[88:91], v[160:175]
    buffer_load_dwordx4 v15, s[4:7], s39 offen offset:3072 sc1 lds
    s_add_u32 s42, s42, 1
    v_mfma_f32_32x32x16_bf16 v[176:191], v[76:79], v[88:91], v[176:191]
    s_cmp_eq_u32 s42, 10
    s_cselect_b32 s42, 1, s42
    s_waitcnt lgkmcnt(0)
    v_mfma_f32_32x32x16_bf16 v[128:143], v[48:51], v[80:83], v[128:143]
    ds_read_b128 v[88:91], v103 offset:0
    ds_read_b128 v[92:95], v103 offset:4096
    ds_read_b64_tr_b16 v[64:65], v96 offset:12288
    ds_read_b64_tr_b16 v[66:67], v96 offset:13312
    v_mfma_f32_32x32x16_bf16 v[192:207], v[48:51], v[84:87], v[192:207]
    ds_read_b64_tr_b16 v[68:69], v97 offset:12288
    ds_read_b64_tr_b16 v[70:71], v97 offset:13312
    ds_read_b64_tr_b16 v[72:73], v98 offset:12288
    ds_read_b64_tr_b16 v[74:75], v98 offset:13312
    v_mfma_f32_32x32x16_bf16 v[144:159], v[52:55], v[80:83], v[144:159]
    ds_read_b64_tr_b16 v[76:77], v99 offset:12288
    ds_read_b64_tr_b16 v[78:79], v99 offset:13312
    v_add_u32 v96, 40960, v96
    v_add_u32 v97, 40960, v97
    v_mfma_f32_32x32x16_bf16 v[208:223], v[52:55], v[84:87], v[208:223]
    v_add_u32 v98, 40960, v98
    v_add_u32 v99, 40960, v99
    v_mfma_f32_32x32x16_bf16 v[160:175], v[56:59], v[80:83], v[160:175]
    v_subrev_u32 v100, 90112, v100
    v_subrev_u32 v101, 90112, v101
    v_mfma_f32_32x32x16_bf16 v[176:191], v[60:63], v[80:83], v[176:191]
    v_subrev_u32 v102, 90112, v102
    v_subrev_u32 v103, 90112, v103
    s_waitcnt lgkmcnt(0)
    s_waitcnt vmcnt(14)
    s_barrier
    v_mfma_f32_32x32x16_bf16 v[128:143], v[64:67], v[88:91], v[128:143]
    ds_read_b128 v[80:83], v100 offset:0
    ds_read_b128 v[84:87], v100 offset:4096
    ds_read_b64_tr_b16 v[48:49], v96 offset:0
    ds_read_b64_tr_b16 v[50:51], v96 offset:1024
    v_mfma_f32_32x32x16_bf16 v[192:207], v[64:67], v[92:95], v[192:207]
    ds_read_b64_tr_b16 v[52:53], v97 offset:0
    ds_read_b64_tr_b16 v[54:55], v97 offset:1024
    ds_read_b64_tr_b16 v[56:57], v98 offset:0
    ds_read_b64_tr_b16 v[58:59], v98 offset:1024
    v_mfma_f32_32x32x16_bf16 v[144:159], v[68:71], v[88:91], v[144:159]
    ds_read_b64_tr_b16 v[60:61], v99 offset:0
    ds_read_b64_tr_b16 v[62:63], v99 offset:1024
    s_lshl_b32 s40, s42, 19
    s_add_u32 s40, s40, s45
    s_add_u32 m0, s63, 73728
    s_add_u32 s39, s40, 0
    v_mfma_f32_32x32x16_bf16 v[208:223], v[68:71], v[92:95], v[208:223]
    buffer_load_dwordx4 v104, s[16:19], s39 offen offset:0 sc1 lds
    buffer_load_dwordx4 v105, s[16:19], s39 offen offset:1024 sc1 lds
    buffer_load_dwordx4 v106, s[16:19], s39 offen offset:2048 sc1 lds
    v_mfma_f32_32x32x16_bf16 v[160:175], v[72:75], v[88:91], v[160:175]
    buffer_load_dwordx4 v107, s[16:19], s39 offen offset:3072 sc1 lds
    s_add_u32 m0, s63, 77824
    s_add_u32 s39, s40, 131072
    buffer_load_dwordx4 v104, s[16:19], s39 offen offset:0 sc1 lds
    v_mfma_f32_32x32x16_bf16 v[176:191], v[76:79], v[88:91], v[176:191]
    s_mov_b32 m0, 89088
    s_add_u32 s39, s40, s96
    s_mov_b64 exec, s[60:61]
    buffer_load_dwordx4 v104, s[16:19], s39 offen sc1 lds
    s_mov_b64 exec, -1
    s_waitcnt lgkmcnt(0)
    v_mfma_f32_32x32x16_bf16 v[128:143], v[48:51], v[80:83], v[128:143]
    ds_read_b128 v[88:91], v101 offset:0
    ds_read_b128 v[92:95], v101 offset:4096
    ds_read_b64_tr_b16 v[64:65], v96 offset:4096
    ds_read_b64_tr_b16 v[66:67], v96 offset:5120
    v_mfma_f32_32x32x16_bf16 v[192:207], v[48:51], v[84:87], v[192:207]
    ds_read_b64_tr_b16 v[68:69], v97 offset:4096
    ds_read_b64_tr_b16 v[70:71], v97 offset:5120
    ds_read_b64_tr_b16 v[72:73], v98 offset:4096
    ds_read_b64_tr_b16 v[74:75], v98 offset:5120
    v_mfma_f32_32x32x16_bf16 v[144:159], v[52:55], v[80:83], v[144:159]
    ds_read_b64_tr_b16 v[76:77], v99 offset:4096
    ds_read_b64_tr_b16 v[78:79], v99 offset:5120
    s_lshl_b32 s38, s42, 7
    s_add_u32 s38, s38, s43
    v_mfma_f32_32x32x16_bf16 v[208:223], v[52:55], v[84:87], v[208:223]
    s_add_u32 m0, s44, 90112
    s_add_u32 s39, s38, 0
    v_mfma_f32_32x32x16_bf16 v[160:175], v[56:59], v[80:83], v[160:175]
    buffer_load_dwordx4 v12, s[4:7], s39 offen offset:0 sc1 lds
    buffer_load_dwordx4 v13, s[4:7], s39 offen offset:1024 sc1 lds
    v_mfma_f32_32x32x16_bf16 v[176:191], v[60:63], v[80:83], v[176:191]
    buffer_load_dwordx4 v14, s[4:7], s39 offen offset:2048 sc1 lds
    buffer_load_dwordx4 v15, s[4:7], s39 offen offset:3072 sc1 lds
    s_waitcnt lgkmcnt(0)
    v_mfma_f32_32x32x16_bf16 v[128:143], v[64:67], v[88:91], v[128:143]
    ds_read_b128 v[80:83], v102 offset:0
    ds_read_b128 v[84:87], v102 offset:4096
    ds_read_b64_tr_b16 v[48:49], v96 offset:8192
    ds_read_b64_tr_b16 v[50:51], v96 offset:9216
    v_mfma_f32_32x32x16_bf16 v[192:207], v[64:67], v[92:95], v[192:207]
    ds_read_b64_tr_b16 v[52:53], v97 offset:8192
    ds_read_b64_tr_b16 v[54:55], v97 offset:9216
    ds_read_b64_tr_b16 v[56:57], v98 offset:8192
    ds_read_b64_tr_b16 v[58:59], v98 offset:9216
    v_mfma_f32_32x32x16_bf16 v[144:159], v[68:71], v[88:91], v[144:159]
    ds_read_b64_tr_b16 v[60:61], v99 offset:8192
    ds_read_b64_tr_b16 v[62:63], v99 offset:9216
    s_add_u32 m0, s44, 94208
    s_add_u32 s39, s38, 491520
    buffer_load_dwordx4 v12, s[4:7], s39 offen offset:0 sc1 lds
    v_mfma_f32_32x32x16_bf16 v[208:223], v[68:71], v[92:95], v[208:223]
    buffer_load_dwordx4 v13, s[4:7], s39 offen offset:1024 sc1 lds
    buffer_load_dwordx4 v14, s[4:7], s39 offen offset:2048 sc1 lds
    v_mfma_f32_32x32x16_bf16 v[160:175], v[72:75], v[88:91], v[160:175]
    buffer_load_dwordx4 v15, s[4:7], s39 offen offset:3072 sc1 lds
    s_add_u32 s42, s42, 1
    v_mfma_f32_32x32x16_bf16 v[176:191], v[76:79], v[88:91], v[176:191]
    s_cmp_eq_u32 s42, 10
    s_cselect_b32 s42, 1, s42
    s_waitcnt lgkmcnt(0)
    v_mfma_f32_32x32x16_bf16 v[128:143], v[48:51], v[80:83], v[128:143]
    ds_read_b128 v[88:91], v103 offset:0
    ds_read_b128 v[92:95], v103 offset:4096
    ds_read_b64_tr_b16 v[64:65], v96 offset:12288
    ds_read_b64_tr_b16 v[66:67], v96 offset:13312
    v_mfma_f32_32x32x16_bf16 v[192:207], v[48:51], v[84:87], v[192:207]
    ds_read_b64_tr_b16 v[68:69], v97 offset:12288
    ds_read_b64_tr_b16 v[70:71], v97 offset:13312
    ds_read_b64_tr_b16 v[72:73], v98 offset:12288
    ds_read_b64_tr_b16 v[74:75], v98 offset:13312
    v_mfma_f32_32x32x16_bf16 v[144:159], v[52:55], v[80:83], v[144:159]
    ds_read_b64_tr_b16 v[76:77], v99 offset:12288
    ds_read_b64_tr_b16 v[78:79], v99 offset:13312
    v_subrev_u32 v96, 81920, v96
    v_subrev_u32 v97, 81920, v97
    v_mfma_f32_32x32x16_bf16 v[208:223], v[52:55], v[84:87], v[208:223]
    v_subrev_u32 v98, 81920, v98
    v_subrev_u32 v99, 81920, v99
    v_mfma_f32_32x32x16_bf16 v[160:175], v[56:59], v[80:83], v[160:175]
    v_add_u32 v100, 49152, v100
    v_add_u32 v101, 49152, v101
    v_mfma_f32_32x32x16_bf16 v[176:191], v[60:63], v[80:83], v[176:191]
    v_add_u32 v102, 49152, v102
    v_add_u32 v103, 49152, v103
    s_waitcnt lgkmcnt(0)
    s_waitcnt vmcnt(14)
    s_barrier
    v_mfma_f32_32x32x16_bf16 v[128:143], v[64:67], v[88:91], v[128:143]
    ds_read_b128 v[80:83], v100 offset:0
    ds_read_b128 v[84:87], v100 offset:4096
    ds_read_b64_tr_b16 v[48:49], v96 offset:0
    ds_read_b64_tr_b16 v[50:51], v96 offset:1024
    v_mfma_f32_32x32x16_bf16 v[192:207], v[64:67], v[92:95], v[192:207]
    ds_read_b64_tr_b16 v[52:53], v97 offset:0
    ds_read_b64_tr_b16 v[54:55], v97 offset:1024
    ds_read_b64_tr_b16 v[56:57], v98 offset:0
    ds_read_b64_tr_b16 v[58:59], v98 offset:1024
    v_mfma_f32_32x32x16_bf16 v[144:159], v[68:71], v[88:91], v[144:159]
    ds_read_b64_tr_b16 v[60:61], v99 offset:0
    ds_read_b64_tr_b16 v[62:63], v99 offset:1024
    s_lshl_b32 s40, s42, 19
    s_add_u32 s40, s40, s45
    s_add_u32 m0, s63, 114688
    s_add_u32 s39, s40, 0
    v_mfma_f32_32x32x16_bf16 v[208:223], v[68:71], v[92:95], v[208:223]
    buffer_load_dwordx4 v104, s[16:19], s39 offen offset:0 sc1 lds
    buffer_load_dwordx4 v105, s[16:19], s39 offen offset:1024 sc1 lds
    buffer_load_dwordx4 v106, s[16:19], s39 offen offset:2048 sc1 lds
    v_mfma_f32_32x32x16_bf16 v[160:175], v[72:75], v[88:91], v[160:175]
    buffer_load_dwordx4 v107, s[16:19], s39 offen offset:3072 sc1 lds
    s_add_u32 m0, s63, 118784
    s_add_u32 s39, s40, 131072
    buffer_load_dwordx4 v104, s[16:19], s39 offen offset:0 sc1 lds
    v_mfma_f32_32x32x16_bf16 v[176:191], v[76:79], v[88:91], v[176:191]
    s_mov_b32 m0, 130048
    s_add_u32 s39, s40, s96
    s_mov_b64 exec, s[60:61]
    buffer_load_dwordx4 v104, s[16:19], s39 offen sc1 lds
    s_mov_b64 exec, -1
    s_waitcnt lgkmcnt(0)
    v_mfma_f32_32x32x16_bf16 v[128:143], v[48:51], v[80:83], v[128:143]
    ds_read_b128 v[88:91], v101 offset:0
    ds_read_b128 v[92:95], v101 offset:4096
    ds_read_b64_tr_b16 v[64:65], v96 offset:4096
    ds_read_b64_tr_b16 v[66:67], v96 offset:5120
    v_mfma_f32_32x32x16_bf16 v[192:207], v[48:51], v[84:87], v[192:207]
    ds_read_b64_tr_b16 v[68:69], v97 offset:4096
    ds_read_b64_tr_b16 v[70:71], v97 offset:5120
    ds_read_b64_tr_b16 v[72:73], v98 offset:4096
    ds_read_b64_tr_b16 v[74:75], v98 offset:5120
    v_mfma_f32_32x32x16_bf16 v[144:159], v[52:55], v[80:83], v[144:159]
    ds_read_b64_tr_b16 v[76:77], v99 offset:4096
    ds_read_b64_tr_b16 v[78:79], v99 offset:5120
    s_lshl_b32 s38, s42, 7
    s_add_u32 s38, s38, s43
    v_mfma_f32_32x32x16_bf16 v[208:223], v[52:55], v[84:87], v[208:223]
    s_add_u32 m0, s44, 0
    s_add_u32 s39, s38, 0
    v_mfma_f32_32x32x16_bf16 v[160:175], v[56:59], v[80:83], v[160:175]
    buffer_load_dwordx4 v12, s[4:7], s39 offen offset:0 sc1 lds
    buffer_load_dwordx4 v13, s[4:7], s39 offen offset:1024 sc1 lds
    v_mfma_f32_32x32x16_bf16 v[176:191], v[60:63], v[80:83], v[176:191]
    buffer_load_dwordx4 v14, s[4:7], s39 offen offset:2048 sc1 lds
    buffer_load_dwordx4 v15, s[4:7], s39 offen offset:3072 sc1 lds
    s_waitcnt lgkmcnt(0)
    v_mfma_f32_32x32x16_bf16 v[128:143], v[64:67], v[88:91], v[128:143]
    ds_read_b128 v[80:83], v102 offset:0
    ds_read_b128 v[84:87], v102 offset:4096
    ds_read_b64_tr_b16 v[48:49], v96 offset:8192
    ds_read_b64_tr_b16 v[50:51], v96 offset:9216
    v_mfma_f32_32x32x16_bf16 v[192:207], v[64:67], v[92:95], v[192:207]
    ds_read_b64_tr_b16 v[52:53], v97 offset:8192
    ds_read_b64_tr_b16 v[54:55], v97 offset:9216
    ds_read_b64_tr_b16 v[56:57], v98 offset:8192
    ds_read_b64_tr_b16 v[58:59], v98 offset:9216
    v_mfma_f32_32x32x16_bf16 v[144:159], v[68:71], v[88:91], v[144:159]
    ds_read_b64_tr_b16 v[60:61], v99 offset:8192
    ds_read_b64_tr_b16 v[62:63], v99 offset:9216
    s_add_u32 m0, s44, 4096
    s_add_u32 s39, s38, 491520
    buffer_load_dwordx4 v12, s[4:7], s39 offen offset:0 sc1 lds
    v_mfma_f32_32x32x16_bf16 v[208:223], v[68:71], v[92:95], v[208:223]
    buffer_load_dwordx4 v13, s[4:7], s39 offen offset:1024 sc1 lds
    buffer_load_dwordx4 v14, s[4:7], s39 offen offset:2048 sc1 lds
    v_mfma_f32_32x32x16_bf16 v[160:175], v[72:75], v[88:91], v[160:175]
    buffer_load_dwordx4 v15, s[4:7], s39 offen offset:3072 sc1 lds
    s_add_u32 s42, s42, 1
    v_mfma_f32_32x32x16_bf16 v[176:191], v[76:79], v[88:91], v[176:191]
    s_cmp_eq_u32 s42, 10
    s_cselect_b32 s42, 1, s42
    s_waitcnt lgkmcnt(0)
    v_mfma_f32_32x32x16_bf16 v[128:143], v[48:51], v[80:83], v[128:143]
    ds_read_b128 v[88:91], v103 offset:0
    ds_read_b128 v[92:95], v103 offset:4096
    ds_read_b64_tr_b16 v[64:65], v96 offset:12288
    ds_read_b64_tr_b16 v[66:67], v96 offset:13312
    v_mfma_f32_32x32x16_bf16 v[192:207], v[48:51], v[84:87], v[192:207]
    ds_read_b64_tr_b16 v[68:69], v97 offset:12288
    ds_read_b64_tr_b16 v[70:71], v97 offset:13312
    ds_read_b64_tr_b16 v[72:73], v98 offset:12288
    ds_read_b64_tr_b16 v[74:75], v98 offset:13312
    v_mfma_f32_32x32x16_bf16 v[144:159], v[52:55], v[80:83], v[144:159]
    ds_read_b64_tr_b16 v[76:77], v99 offset:12288
    ds_read_b64_tr_b16 v[78:79], v99 offset:13312
    v_add_u32 v96, 40960, v96
    v_add_u32 v97, 40960, v97
    v_mfma_f32_32x32x16_bf16 v[208:223], v[52:55], v[84:87], v[208:223]
    v_add_u32 v98, 40960, v98
    v_add_u32 v99, 40960, v99
    v_mfma_f32_32x32x16_bf16 v[160:175], v[56:59], v[80:83], v[160:175]
    v_add_u32 v100, 40960, v100
    v_add_u32 v101, 40960, v101
    v_mfma_f32_32x32x16_bf16 v[176:191], v[60:63], v[80:83], v[176:191]
    v_add_u32 v102, 40960, v102
    v_add_u32 v103, 40960, v103
    s_waitcnt lgkmcnt(0)
    s_waitcnt vmcnt(14)
    s_barrier
    v_mfma_f32_32x32x16_bf16 v[128:143], v[64:67], v[88:91], v[128:143]
    ds_read_b128 v[80:83], v100 offset:0
    ds_read_b128 v[84:87], v100 offset:4096
    ds_read_b64_tr_b16 v[48:49], v96 offset:0
    ds_read_b64_tr_b16 v[50:51], v96 offset:1024
    v_mfma_f32_32x32x16_bf16 v[192:207], v[64:67], v[92:95], v[192:207]
    ds_read_b64_tr_b16 v[52:53], v97 offset:0
    ds_read_b64_tr_b16 v[54:55], v97 offset:1024
    ds_read_b64_tr_b16 v[56:57], v98 offset:0
    ds_read_b64_tr_b16 v[58:59], v98 offset:1024
    v_mfma_f32_32x32x16_bf16 v[144:159], v[68:71], v[88:91], v[144:159]
    ds_read_b64_tr_b16 v[60:61], v99 offset:0
    ds_read_b64_tr_b16 v[62:63], v99 offset:1024
    s_lshl_b32 s40, s42, 19
    s_add_u32 s40, s40, s45
    s_add_u32 m0, s63, 32768
    s_add_u32 s39, s40, 0
    v_mfma_f32_32x32x16_bf16 v[208:223], v[68:71], v[92:95], v[208:223]
    buffer_load_dwordx4 v104, s[16:19], s39 offen offset:0 sc1 lds
    buffer_load_dwordx4 v105, s[16:19], s39 offen offset:1024 sc1 lds
    buffer_load_dwordx4 v106, s[16:19], s39 offen offset:2048 sc1 lds
    v_mfma_f32_32x32x16_bf16 v[160:175], v[72:75], v[88:91], v[160:175]
    buffer_load_dwordx4 v107, s[16:19], s39 offen offset:3072 sc1 lds
    s_add_u32 m0, s63, 36864
    s_add_u32 s39, s40, 131072
    buffer_load_dwordx4 v104, s[16:19], s39 offen offset:0 sc1 lds
    v_mfma_f32_32x32x16_bf16 v[176:191], v[76:79], v[88:91], v[176:191]
    s_mov_b32 m0, 48128
    s_add_u32 s39, s40, s96
    s_mov_b64 exec, s[60:61]
    buffer_load_dwordx4 v104, s[16:19], s39 offen sc1 lds
    s_mov_b64 exec, -1
    s_waitcnt lgkmcnt(0)
    v_mfma_f32_32x32x16_bf16 v[128:143], v[48:51], v[80:83], v[128:143]
    ds_read_b128 v[88:91], v101 offset:0
    ds_read_b128 v[92:95], v101 offset:4096
    ds_read_b64_tr_b16 v[64:65], v96 offset:4096
    ds_read_b64_tr_b16 v[66:67], v96 offset:5120
    v_mfma_f32_32x32x16_bf16 v[192:207], v[48:51], v[84:87], v[192:207]
    ds_read_b64_tr_b16 v[68:69], v97 offset:4096
    ds_read_b64_tr_b16 v[70:71], v97 offset:5120
    ds_read_b64_tr_b16 v[72:73], v98 offset:4096
    ds_read_b64_tr_b16 v[74:75], v98 offset:5120
    v_mfma_f32_32x32x16_bf16 v[144:159], v[52:55], v[80:83], v[144:159]
    ds_read_b64_tr_b16 v[76:77], v99 offset:4096
    ds_read_b64_tr_b16 v[78:79], v99 offset:5120
    s_lshl_b32 s38, s42, 7
    s_add_u32 s38, s38, s43
    v_mfma_f32_32x32x16_bf16 v[208:223], v[52:55], v[84:87], v[208:223]
    s_add_u32 m0, s44, 49152
    s_add_u32 s39, s38, 0
    v_mfma_f32_32x32x16_bf16 v[160:175], v[56:59], v[80:83], v[160:175]
    buffer_load_dwordx4 v12, s[4:7], s39 offen offset:0 sc1 lds
    buffer_load_dwordx4 v13, s[4:7], s39 offen offset:1024 sc1 lds
    v_mfma_f32_32x32x16_bf16 v[176:191], v[60:63], v[80:83], v[176:191]
    buffer_load_dwordx4 v14, s[4:7], s39 offen offset:2048 sc1 lds
    buffer_load_dwordx4 v15, s[4:7], s39 offen offset:3072 sc1 lds
    s_waitcnt lgkmcnt(0)
    v_mfma_f32_32x32x16_bf16 v[128:143], v[64:67], v[88:91], v[128:143]
    ds_read_b128 v[80:83], v102 offset:0
    ds_read_b128 v[84:87], v102 offset:4096
    ds_read_b64_tr_b16 v[48:49], v96 offset:8192
    ds_read_b64_tr_b16 v[50:51], v96 offset:9216
    v_mfma_f32_32x32x16_bf16 v[192:207], v[64:67], v[92:95], v[192:207]
    ds_read_b64_tr_b16 v[52:53], v97 offset:8192
    ds_read_b64_tr_b16 v[54:55], v97 offset:9216
    ds_read_b64_tr_b16 v[56:57], v98 offset:8192
    ds_read_b64_tr_b16 v[58:59], v98 offset:9216
    v_mfma_f32_32x32x16_bf16 v[144:159], v[68:71], v[88:91], v[144:159]
    ds_read_b64_tr_b16 v[60:61], v99 offset:8192
    ds_read_b64_tr_b16 v[62:63], v99 offset:9216
    s_add_u32 m0, s44, 53248
    s_add_u32 s39, s38, 491520
    buffer_load_dwordx4 v12, s[4:7], s39 offen offset:0 sc1 lds
    v_mfma_f32_32x32x16_bf16 v[208:223], v[68:71], v[92:95], v[208:223]
    buffer_load_dwordx4 v13, s[4:7], s39 offen offset:1024 sc1 lds
    buffer_load_dwordx4 v14, s[4:7], s39 offen offset:2048 sc1 lds
    v_mfma_f32_32x32x16_bf16 v[160:175], v[72:75], v[88:91], v[160:175]
    buffer_load_dwordx4 v15, s[4:7], s39 offen offset:3072 sc1 lds
    s_add_u32 s42, s42, 1
    v_mfma_f32_32x32x16_bf16 v[176:191], v[76:79], v[88:91], v[176:191]
    s_cmp_eq_u32 s42, 10
    s_cselect_b32 s42, 1, s42
    s_waitcnt lgkmcnt(0)
    v_mfma_f32_32x32x16_bf16 v[128:143], v[48:51], v[80:83], v[128:143]
    ds_read_b128 v[88:91], v103 offset:0
    ds_read_b128 v[92:95], v103 offset:4096
    ds_read_b64_tr_b16 v[64:65], v96 offset:12288
    ds_read_b64_tr_b16 v[66:67], v96 offset:13312
    v_mfma_f32_32x32x16_bf16 v[192:207], v[48:51], v[84:87], v[192:207]
    ds_read_b64_tr_b16 v[68:69], v97 offset:12288
    ds_read_b64_tr_b16 v[70:71], v97 offset:13312
    ds_read_b64_tr_b16 v[72:73], v98 offset:12288
    ds_read_b64_tr_b16 v[74:75], v98 offset:13312
    v_mfma_f32_32x32x16_bf16 v[144:159], v[52:55], v[80:83], v[144:159]
    ds_read_b64_tr_b16 v[76:77], v99 offset:12288
    ds_read_b64_tr_b16 v[78:79], v99 offset:13312
    v_add_u32 v96, 40960, v96
    v_add_u32 v97, 40960, v97
    v_mfma_f32_32x32x16_bf16 v[208:223], v[52:55], v[84:87], v[208:223]
    v_add_u32 v98, 40960, v98
    v_add_u32 v99, 40960, v99
    v_mfma_f32_32x32x16_bf16 v[160:175], v[56:59], v[80:83], v[160:175]
    v_subrev_u32 v100, 90112, v100
    v_subrev_u32 v101, 90112, v101
    v_mfma_f32_32x32x16_bf16 v[176:191], v[60:63], v[80:83], v[176:191]
    v_subrev_u32 v102, 90112, v102
    v_subrev_u32 v103, 90112, v103
    s_waitcnt lgkmcnt(0)
    s_waitcnt vmcnt(14)
    s_barrier
    v_mfma_f32_32x32x16_bf16 v[128:143], v[64:67], v[88:91], v[128:143]
    ds_read_b128 v[80:83], v100 offset:0
    ds_read_b128 v[84:87], v100 offset:4096
    ds_read_b64_tr_b16 v[48:49], v96 offset:0
    ds_read_b64_tr_b16 v[50:51], v96 offset:1024
    v_mfma_f32_32x32x16_bf16 v[192:207], v[64:67], v[92:95], v[192:207]
    ds_read_b64_tr_b16 v[52:53], v97 offset:0
    ds_read_b64_tr_b16 v[54:55], v97 offset:1024
    ds_read_b64_tr_b16 v[56:57], v98 offset:0
    ds_read_b64_tr_b16 v[58:59], v98 offset:1024
    v_mfma_f32_32x32x16_bf16 v[144:159], v[68:71], v[88:91], v[144:159]
    ds_read_b64_tr_b16 v[60:61], v99 offset:0
    ds_read_b64_tr_b16 v[62:63], v99 offset:1024
    s_lshl_b32 s40, s42, 19
    s_add_u32 s40, s40, s45
    s_add_u32 m0, s63, 73728
    s_add_u32 s39, s40, 0
    v_mfma_f32_32x32x16_bf16 v[208:223], v[68:71], v[92:95], v[208:223]
    buffer_load_dwordx4 v104, s[16:19], s39 offen offset:0 sc1 lds
    buffer_load_dwordx4 v105, s[16:19], s39 offen offset:1024 sc1 lds
    buffer_load_dwordx4 v106, s[16:19], s39 offen offset:2048 sc1 lds
    v_mfma_f32_32x32x16_bf16 v[160:175], v[72:75], v[88:91], v[160:175]
    buffer_load_dwordx4 v107, s[16:19], s39 offen offset:3072 sc1 lds
    s_add_u32 m0, s63, 77824
    s_add_u32 s39, s40, 131072
    buffer_load_dwordx4 v104, s[16:19], s39 offen offset:0 sc1 lds
    v_mfma_f32_32x32x16_bf16 v[176:191], v[76:79], v[88:91], v[176:191]
    s_mov_b32 m0, 89088
    s_add_u32 s39, s40, s96
    s_mov_b64 exec, s[60:61]
    buffer_load_dwordx4 v104, s[16:19], s39 offen sc1 lds
    s_mov_b64 exec, -1
    s_waitcnt lgkmcnt(0)
    v_mfma_f32_32x32x16_bf16 v[128:143], v[48:51], v[80:83], v[128:143]
    ds_read_b128 v[88:91], v101 offset:0
    ds_read_b128 v[92:95], v101 offset:4096
    ds_read_b64_tr_b16 v[64:65], v96 offset:4096
    ds_read_b64_tr_b16 v[66:67], v96 offset:5120
    v_mfma_f32_32x32x16_bf16 v[192:207], v[48:51], v[84:87], v[192:207]
    ds_read_b64_tr_b16 v[68:69], v97 offset:4096
    ds_read_b64_tr_b16 v[70:71], v97 offset:5120
    ds_read_b64_tr_b16 v[72:73], v98 offset:4096
    ds_read_b64_tr_b16 v[74:75], v98 offset:5120
    v_mfma_f32_32x32x16_bf16 v[144:159], v[52:55], v[80:83], v[144:159]
    ds_read_b64_tr_b16 v[76:77], v99 offset:4096
    ds_read_b64_tr_b16 v[78:79], v99 offset:5120
    s_lshl_b32 s38, s42, 7
    s_add_u32 s38, s38, s43
    v_mfma_f32_32x32x16_bf16 v[208:223], v[52:55], v[84:87], v[208:223]
    s_add_u32 m0, s44, 90112
    s_add_u32 s39, s38, 0
    v_mfma_f32_32x32x16_bf16 v[160:175], v[56:59], v[80:83], v[160:175]
    buffer_load_dwordx4 v12, s[4:7], s39 offen offset:0 sc1 lds
    buffer_load_dwordx4 v13, s[4:7], s39 offen offset:1024 sc1 lds
    v_mfma_f32_32x32x16_bf16 v[176:191], v[60:63], v[80:83], v[176:191]
    buffer_load_dwordx4 v14, s[4:7], s39 offen offset:2048 sc1 lds
    buffer_load_dwordx4 v15, s[4:7], s39 offen offset:3072 sc1 lds
    s_waitcnt lgkmcnt(0)
    v_mfma_f32_32x32x16_bf16 v[128:143], v[64:67], v[88:91], v[128:143]
    ds_read_b128 v[80:83], v102 offset:0
    ds_read_b128 v[84:87], v102 offset:4096
    ds_read_b64_tr_b16 v[48:49], v96 offset:8192
    ds_read_b64_tr_b16 v[50:51], v96 offset:9216
    v_mfma_f32_32x32x16_bf16 v[192:207], v[64:67], v[92:95], v[192:207]
    ds_read_b64_tr_b16 v[52:53], v97 offset:8192
    ds_read_b64_tr_b16 v[54:55], v97 offset:9216
    ds_read_b64_tr_b16 v[56:57], v98 offset:8192
    ds_read_b64_tr_b16 v[58:59], v98 offset:9216
    v_mfma_f32_32x32x16_bf16 v[144:159], v[68:71], v[88:91], v[144:159]
    ds_read_b64_tr_b16 v[60:61], v99 offset:8192
    ds_read_b64_tr_b16 v[62:63], v99 offset:9216
    s_add_u32 m0, s44, 94208
    s_add_u32 s39, s38, 491520
    buffer_load_dwordx4 v12, s[4:7], s39 offen offset:0 sc1 lds
    v_mfma_f32_32x32x16_bf16 v[208:223], v[68:71], v[92:95], v[208:223]
    buffer_load_dwordx4 v13, s[4:7], s39 offen offset:1024 sc1 lds
    buffer_load_dwordx4 v14, s[4:7], s39 offen offset:2048 sc1 lds
    v_mfma_f32_32x32x16_bf16 v[160:175], v[72:75], v[88:91], v[160:175]
    buffer_load_dwordx4 v15, s[4:7], s39 offen offset:3072 sc1 lds
    s_add_u32 s42, s42, 1
    v_mfma_f32_32x32x16_bf16 v[176:191], v[76:79], v[88:91], v[176:191]
    s_cmp_eq_u32 s42, 10
    s_cselect_b32 s42, 1, s42
    s_waitcnt lgkmcnt(0)
    v_mfma_f32_32x32x16_bf16 v[128:143], v[48:51], v[80:83], v[128:143]
    ds_read_b128 v[88:91], v103 offset:0
    ds_read_b128 v[92:95], v103 offset:4096
    ds_read_b64_tr_b16 v[64:65], v96 offset:12288
    ds_read_b64_tr_b16 v[66:67], v96 offset:13312
    v_mfma_f32_32x32x16_bf16 v[192:207], v[48:51], v[84:87], v[192:207]
    ds_read_b64_tr_b16 v[68:69], v97 offset:12288
    ds_read_b64_tr_b16 v[70:71], v97 offset:13312
    ds_read_b64_tr_b16 v[72:73], v98 offset:12288
    ds_read_b64_tr_b16 v[74:75], v98 offset:13312
    v_mfma_f32_32x32x16_bf16 v[144:159], v[52:55], v[80:83], v[144:159]
    ds_read_b64_tr_b16 v[76:77], v99 offset:12288
    ds_read_b64_tr_b16 v[78:79], v99 offset:13312
    v_subrev_u32 v96, 81920, v96
    v_subrev_u32 v97, 81920, v97
    v_mfma_f32_32x32x16_bf16 v[208:223], v[52:55], v[84:87], v[208:223]
    v_subrev_u32 v98, 81920, v98
    v_subrev_u32 v99, 81920, v99
    v_mfma_f32_32x32x16_bf16 v[160:175], v[56:59], v[80:83], v[160:175]
    v_add_u32 v100, 49152, v100
    v_add_u32 v101, 49152, v101
    v_mfma_f32_32x32x16_bf16 v[176:191], v[60:63], v[80:83], v[176:191]
    v_add_u32 v102, 49152, v102
    v_add_u32 v103, 49152, v103
    s_waitcnt lgkmcnt(0)
    s_waitcnt vmcnt(14)
    s_barrier
    v_mfma_f32_32x32x16_bf16 v[128:143], v[64:67], v[88:91], v[128:143]
    ds_read_b128 v[80:83], v100 offset:0
    ds_read_b128 v[84:87], v100 offset:4096
    ds_read_b64_tr_b16 v[48:49], v96 offset:0
    ds_read_b64_tr_b16 v[50:51], v96 offset:1024
    v_mfma_f32_32x32x16_bf16 v[192:207], v[64:67], v[92:95], v[192:207]
    ds_read_b64_tr_b16 v[52:53], v97 offset:0
    ds_read_b64_tr_b16 v[54:55], v97 offset:1024
    ds_read_b64_tr_b16 v[56:57], v98 offset:0
    ds_read_b64_tr_b16 v[58:59], v98 offset:1024
    v_mfma_f32_32x32x16_bf16 v[144:159], v[68:71], v[88:91], v[144:159]
    ds_read_b64_tr_b16 v[60:61], v99 offset:0
    ds_read_b64_tr_b16 v[62:63], v99 offset:1024
    s_lshl_b32 s40, s42, 19
    s_add_u32 s40, s40, s45
    s_add_u32 m0, s63, 114688
    s_add_u32 s39, s40, 0
    v_mfma_f32_32x32x16_bf16 v[208:223], v[68:71], v[92:95], v[208:223]
    buffer_load_dwordx4 v104, s[16:19], s39 offen offset:0 sc1 lds
    buffer_load_dwordx4 v105, s[16:19], s39 offen offset:1024 sc1 lds
    buffer_load_dwordx4 v106, s[16:19], s39 offen offset:2048 sc1 lds
    v_mfma_f32_32x32x16_bf16 v[160:175], v[72:75], v[88:91], v[160:175]
    buffer_load_dwordx4 v107, s[16:19], s39 offen offset:3072 sc1 lds
    s_add_u32 m0, s63, 118784
    s_add_u32 s39, s40, 131072
    buffer_load_dwordx4 v104, s[16:19], s39 offen offset:0 sc1 lds
    v_mfma_f32_32x32x16_bf16 v[176:191], v[76:79], v[88:91], v[176:191]
    s_mov_b32 m0, 130048
    s_add_u32 s39, s40, s96
    s_mov_b64 exec, s[60:61]
    buffer_load_dwordx4 v104, s[16:19], s39 offen sc1 lds
    s_mov_b64 exec, -1
    s_waitcnt lgkmcnt(0)
    v_mfma_f32_32x32x16_bf16 v[128:143], v[48:51], v[80:83], v[128:143]
    ds_read_b128 v[88:91], v101 offset:0
    ds_read_b128 v[92:95], v101 offset:4096
    ds_read_b64_tr_b16 v[64:65], v96 offset:4096
    ds_read_b64_tr_b16 v[66:67], v96 offset:5120
    v_mfma_f32_32x32x16_bf16 v[192:207], v[48:51], v[84:87], v[192:207]
    ds_read_b64_tr_b16 v[68:69], v97 offset:4096
    ds_read_b64_tr_b16 v[70:71], v97 offset:5120
    ds_read_b64_tr_b16 v[72:73], v98 offset:4096
    ds_read_b64_tr_b16 v[74:75], v98 offset:5120
    v_mfma_f32_32x32x16_bf16 v[144:159], v[52:55], v[80:83], v[144:159]
    ds_read_b64_tr_b16 v[76:77], v99 offset:4096
    ds_read_b64_tr_b16 v[78:79], v99 offset:5120
    s_lshl_b32 s38, s42, 7
    s_add_u32 s38, s38, s43
    v_mfma_f32_32x32x16_bf16 v[208:223], v[52:55], v[84:87], v[208:223]
    s_add_u32 m0, s44, 0
    s_add_u32 s39, s38, 0
    v_mfma_f32_32x32x16_bf16 v[160:175], v[56:59], v[80:83], v[160:175]
    buffer_load_dwordx4 v12, s[4:7], s39 offen offset:0 sc1 lds
    buffer_load_dwordx4 v13, s[4:7], s39 offen offset:1024 sc1 lds
    v_mfma_f32_32x32x16_bf16 v[176:191], v[60:63], v[80:83], v[176:191]
    buffer_load_dwordx4 v14, s[4:7], s39 offen offset:2048 sc1 lds
    buffer_load_dwordx4 v15, s[4:7], s39 offen offset:3072 sc1 lds
    s_waitcnt lgkmcnt(0)
    v_mfma_f32_32x32x16_bf16 v[128:143], v[64:67], v[88:91], v[128:143]
    ds_read_b128 v[80:83], v102 offset:0
    ds_read_b128 v[84:87], v102 offset:4096
    ds_read_b64_tr_b16 v[48:49], v96 offset:8192
    ds_read_b64_tr_b16 v[50:51], v96 offset:9216
    v_mfma_f32_32x32x16_bf16 v[192:207], v[64:67], v[92:95], v[192:207]
    ds_read_b64_tr_b16 v[52:53], v97 offset:8192
    ds_read_b64_tr_b16 v[54:55], v97 offset:9216
    ds_read_b64_tr_b16 v[56:57], v98 offset:8192
    ds_read_b64_tr_b16 v[58:59], v98 offset:9216
    v_mfma_f32_32x32x16_bf16 v[144:159], v[68:71], v[88:91], v[144:159]
    ds_read_b64_tr_b16 v[60:61], v99 offset:8192
    ds_read_b64_tr_b16 v[62:63], v99 offset:9216
    s_add_u32 m0, s44, 4096
    s_add_u32 s39, s38, 491520
    buffer_load_dwordx4 v12, s[4:7], s39 offen offset:0 sc1 lds
    v_mfma_f32_32x32x16_bf16 v[208:223], v[68:71], v[92:95], v[208:223]
    buffer_load_dwordx4 v13, s[4:7], s39 offen offset:1024 sc1 lds
    buffer_load_dwordx4 v14, s[4:7], s39 offen offset:2048 sc1 lds
    v_mfma_f32_32x32x16_bf16 v[160:175], v[72:75], v[88:91], v[160:175]
    buffer_load_dwordx4 v15, s[4:7], s39 offen offset:3072 sc1 lds
    s_add_u32 s42, s42, 1
    v_mfma_f32_32x32x16_bf16 v[176:191], v[76:79], v[88:91], v[176:191]
    s_cmp_eq_u32 s42, 10
    s_cselect_b32 s42, 1, s42
    s_waitcnt lgkmcnt(0)
    v_mfma_f32_32x32x16_bf16 v[128:143], v[48:51], v[80:83], v[128:143]
    ds_read_b128 v[88:91], v103 offset:0
    ds_read_b128 v[92:95], v103 offset:4096
    ds_read_b64_tr_b16 v[64:65], v96 offset:12288
    ds_read_b64_tr_b16 v[66:67], v96 offset:13312
    v_mfma_f32_32x32x16_bf16 v[192:207], v[48:51], v[84:87], v[192:207]
    ds_read_b64_tr_b16 v[68:69], v97 offset:12288
    ds_read_b64_tr_b16 v[70:71], v97 offset:13312
    ds_read_b64_tr_b16 v[72:73], v98 offset:12288
    ds_read_b64_tr_b16 v[74:75], v98 offset:13312
    v_mfma_f32_32x32x16_bf16 v[144:159], v[52:55], v[80:83], v[144:159]
    ds_read_b64_tr_b16 v[76:77], v99 offset:12288
    ds_read_b64_tr_b16 v[78:79], v99 offset:13312
    v_add_u32 v96, 40960, v96
    v_add_u32 v97, 40960, v97
    v_mfma_f32_32x32x16_bf16 v[208:223], v[52:55], v[84:87], v[208:223]
    v_add_u32 v98, 40960, v98
    v_add_u32 v99, 40960, v99
    v_mfma_f32_32x32x16_bf16 v[160:175], v[56:59], v[80:83], v[160:175]
    v_add_u32 v100, 40960, v100
    v_add_u32 v101, 40960, v101
    v_mfma_f32_32x32x16_bf16 v[176:191], v[60:63], v[80:83], v[176:191]
    v_add_u32 v102, 40960, v102
    v_add_u32 v103, 40960, v103
    s_waitcnt lgkmcnt(0)
    s_waitcnt vmcnt(14)
    s_barrier
    v_mfma_f32_32x32x16_bf16 v[128:143], v[64:67], v[88:91], v[128:143]
    ds_read_b128 v[80:83], v100 offset:0
    ds_read_b128 v[84:87], v100 offset:4096
    ds_read_b64_tr_b16 v[48:49], v96 offset:0
    ds_read_b64_tr_b16 v[50:51], v96 offset:1024
    v_mfma_f32_32x32x16_bf16 v[192:207], v[64:67], v[92:95], v[192:207]
    ds_read_b64_tr_b16 v[52:53], v97 offset:0
    ds_read_b64_tr_b16 v[54:55], v97 offset:1024
    ds_read_b64_tr_b16 v[56:57], v98 offset:0
    ds_read_b64_tr_b16 v[58:59], v98 offset:1024
    v_mfma_f32_32x32x16_bf16 v[144:159], v[68:71], v[88:91], v[144:159]
    ds_read_b64_tr_b16 v[60:61], v99 offset:0
    ds_read_b64_tr_b16 v[62:63], v99 offset:1024
    v_mfma_f32_32x32x16_bf16 v[208:223], v[68:71], v[92:95], v[208:223]
    v_mfma_f32_32x32x16_bf16 v[160:175], v[72:75], v[88:91], v[160:175]
    v_mfma_f32_32x32x16_bf16 v[176:191], v[76:79], v[88:91], v[176:191]
    s_waitcnt lgkmcnt(0)
    v_mfma_f32_32x32x16_bf16 v[128:143], v[48:51], v[80:83], v[128:143]
    ds_read_b128 v[88:91], v101 offset:0
    ds_read_b128 v[92:95], v101 offset:4096
    ds_read_b64_tr_b16 v[64:65], v96 offset:4096
    ds_read_b64_tr_b16 v[66:67], v96 offset:5120
    v_mfma_f32_32x32x16_bf16 v[192:207], v[48:51], v[84:87], v[192:207]
    ds_read_b64_tr_b16 v[68:69], v97 offset:4096
    ds_read_b64_tr_b16 v[70:71], v97 offset:5120
    ds_read_b64_tr_b16 v[72:73], v98 offset:4096
    ds_read_b64_tr_b16 v[74:75], v98 offset:5120
    v_mfma_f32_32x32x16_bf16 v[144:159], v[52:55], v[80:83], v[144:159]
    ds_read_b64_tr_b16 v[76:77], v99 offset:4096
    ds_read_b64_tr_b16 v[78:79], v99 offset:5120
    v_mfma_f32_32x32x16_bf16 v[208:223], v[52:55], v[84:87], v[208:223]
    v_mfma_f32_32x32x16_bf16 v[160:175], v[56:59], v[80:83], v[160:175]
    v_mfma_f32_32x32x16_bf16 v[176:191], v[60:63], v[80:83], v[176:191]
    s_waitcnt lgkmcnt(0)
    v_mfma_f32_32x32x16_bf16 v[128:143], v[64:67], v[88:91], v[128:143]
    ds_read_b128 v[80:83], v102 offset:0
    ds_read_b128 v[84:87], v102 offset:4096
    ds_read_b64_tr_b16 v[48:49], v96 offset:8192
    ds_read_b64_tr_b16 v[50:51], v96 offset:9216
    v_mfma_f32_32x32x16_bf16 v[192:207], v[64:67], v[92:95], v[192:207]
    ds_read_b64_tr_b16 v[52:53], v97 offset:8192
    ds_read_b64_tr_b16 v[54:55], v97 offset:9216
    ds_read_b64_tr_b16 v[56:57], v98 offset:8192
    ds_read_b64_tr_b16 v[58:59], v98 offset:9216
    v_mfma_f32_32x32x16_bf16 v[144:159], v[68:71], v[88:91], v[144:159]
    ds_read_b64_tr_b16 v[60:61], v99 offset:8192
    ds_read_b64_tr_b16 v[62:63], v99 offset:9216
    v_mfma_f32_32x32x16_bf16 v[208:223], v[68:71], v[92:95], v[208:223]
    v_mfma_f32_32x32x16_bf16 v[160:175], v[72:75], v[88:91], v[160:175]
    v_mfma_f32_32x32x16_bf16 v[176:191], v[76:79], v[88:91], v[176:191]
    s_waitcnt lgkmcnt(0)
    v_mfma_f32_32x32x16_bf16 v[128:143], v[48:51], v[80:83], v[128:143]
    ds_read_b128 v[88:91], v103 offset:0
    ds_read_b128 v[92:95], v103 offset:4096
    ds_read_b64_tr_b16 v[64:65], v96 offset:12288
    ds_read_b64_tr_b16 v[66:67], v96 offset:13312
    v_mfma_f32_32x32x16_bf16 v[192:207], v[48:51], v[84:87], v[192:207]
    ds_read_b64_tr_b16 v[68:69], v97 offset:12288
    ds_read_b64_tr_b16 v[70:71], v97 offset:13312
    ds_read_b64_tr_b16 v[72:73], v98 offset:12288
    ds_read_b64_tr_b16 v[74:75], v98 offset:13312
    v_mfma_f32_32x32x16_bf16 v[144:159], v[52:55], v[80:83], v[144:159]
    ds_read_b64_tr_b16 v[76:77], v99 offset:12288
    ds_read_b64_tr_b16 v[78:79], v99 offset:13312
    v_add_u32 v96, 40960, v96
    v_add_u32 v97, 40960, v97
    v_mfma_f32_32x32x16_bf16 v[208:223], v[52:55], v[84:87], v[208:223]
    v_add_u32 v98, 40960, v98
    v_add_u32 v99, 40960, v99
    v_mfma_f32_32x32x16_bf16 v[160:175], v[56:59], v[80:83], v[160:175]
    v_subrev_u32 v100, 90112, v100
    v_subrev_u32 v101, 90112, v101
    v_mfma_f32_32x32x16_bf16 v[176:191], v[60:63], v[80:83], v[176:191]
    v_subrev_u32 v102, 90112, v102
    v_subrev_u32 v103, 90112, v103
    s_waitcnt lgkmcnt(0)
    s_waitcnt vmcnt(0)
    s_barrier
    v_mfma_f32_32x32x16_bf16 v[128:143], v[64:67], v[88:91], v[128:143]
    ds_read_b128 v[80:83], v100 offset:0
    ds_read_b128 v[84:87], v100 offset:4096
    ds_read_b64_tr_b16 v[48:49], v96 offset:0
    ds_read_b64_tr_b16 v[50:51], v96 offset:1024
    v_mfma_f32_32x32x16_bf16 v[192:207], v[64:67], v[92:95], v[192:207]
    ds_read_b64_tr_b16 v[52:53], v97 offset:0
    ds_read_b64_tr_b16 v[54:55], v97 offset:1024
    ds_read_b64_tr_b16 v[56:57], v98 offset:0
    ds_read_b64_tr_b16 v[58:59], v98 offset:1024
    v_mfma_f32_32x32x16_bf16 v[144:159], v[68:71], v[88:91], v[144:159]
    ds_read_b64_tr_b16 v[60:61], v99 offset:0
    ds_read_b64_tr_b16 v[62:63], v99 offset:1024
    v_mfma_f32_32x32x16_bf16 v[208:223], v[68:71], v[92:95], v[208:223]
    v_mfma_f32_32x32x16_bf16 v[160:175], v[72:75], v[88:91], v[160:175]
    v_mfma_f32_32x32x16_bf16 v[176:191], v[76:79], v[88:91], v[176:191]
    s_waitcnt lgkmcnt(0)
    v_mfma_f32_32x32x16_bf16 v[128:143], v[48:51], v[80:83], v[128:143]
    ds_read_b128 v[88:91], v101 offset:0
    ds_read_b128 v[92:95], v101 offset:4096
    ds_read_b64_tr_b16 v[64:65], v96 offset:4096
    ds_read_b64_tr_b16 v[66:67], v96 offset:5120
    v_mfma_f32_32x32x16_bf16 v[192:207], v[48:51], v[84:87], v[192:207]
    ds_read_b64_tr_b16 v[68:69], v97 offset:4096
    ds_read_b64_tr_b16 v[70:71], v97 offset:5120
    ds_read_b64_tr_b16 v[72:73], v98 offset:4096
    ds_read_b64_tr_b16 v[74:75], v98 offset:5120
    v_mfma_f32_32x32x16_bf16 v[144:159], v[52:55], v[80:83], v[144:159]
    ds_read_b64_tr_b16 v[76:77], v99 offset:4096
    ds_read_b64_tr_b16 v[78:79], v99 offset:5120
    v_mfma_f32_32x32x16_bf16 v[208:223], v[52:55], v[84:87], v[208:223]
    v_mfma_f32_32x32x16_bf16 v[160:175], v[56:59], v[80:83], v[160:175]
    v_mfma_f32_32x32x16_bf16 v[176:191], v[60:63], v[80:83], v[176:191]
    s_waitcnt lgkmcnt(0)
    v_mfma_f32_32x32x16_bf16 v[128:143], v[64:67], v[88:91], v[128:143]
    ds_read_b128 v[80:83], v102 offset:0
    ds_read_b128 v[84:87], v102 offset:4096
    ds_read_b64_tr_b16 v[48:49], v96 offset:8192
    ds_read_b64_tr_b16 v[50:51], v96 offset:9216
    v_mfma_f32_32x32x16_bf16 v[192:207], v[64:67], v[92:95], v[192:207]
    ds_read_b64_tr_b16 v[52:53], v97 offset:8192
    ds_read_b64_tr_b16 v[54:55], v97 offset:9216
    ds_read_b64_tr_b16 v[56:57], v98 offset:8192
    ds_read_b64_tr_b16 v[58:59], v98 offset:9216
    v_mfma_f32_32x32x16_bf16 v[144:159], v[68:71], v[88:91], v[144:159]
    ds_read_b64_tr_b16 v[60:61], v99 offset:8192
    ds_read_b64_tr_b16 v[62:63], v99 offset:9216
    v_mfma_f32_32x32x16_bf16 v[208:223], v[68:71], v[92:95], v[208:223]
    v_mfma_f32_32x32x16_bf16 v[160:175], v[72:75], v[88:91], v[160:175]
    v_mfma_f32_32x32x16_bf16 v[176:191], v[76:79], v[88:91], v[176:191]
    s_waitcnt lgkmcnt(0)
    v_mfma_f32_32x32x16_bf16 v[128:143], v[48:51], v[80:83], v[128:143]
    ds_read_b128 v[88:91], v103 offset:0
    ds_read_b128 v[92:95], v103 offset:4096
    ds_read_b64_tr_b16 v[64:65], v96 offset:12288
    ds_read_b64_tr_b16 v[66:67], v96 offset:13312
    v_mfma_f32_32x32x16_bf16 v[192:207], v[48:51], v[84:87], v[192:207]
    ds_read_b64_tr_b16 v[68:69], v97 offset:12288
    ds_read_b64_tr_b16 v[70:71], v97 offset:13312
    ds_read_b64_tr_b16 v[72:73], v98 offset:12288
    ds_read_b64_tr_b16 v[74:75], v98 offset:13312
    v_mfma_f32_32x32x16_bf16 v[144:159], v[52:55], v[80:83], v[144:159]
    ds_read_b64_tr_b16 v[76:77], v99 offset:12288
    ds_read_b64_tr_b16 v[78:79], v99 offset:13312
    v_mfma_f32_32x32x16_bf16 v[208:223], v[52:55], v[84:87], v[208:223]
    v_mfma_f32_32x32x16_bf16 v[160:175], v[56:59], v[80:83], v[160:175]
    v_mfma_f32_32x32x16_bf16 v[176:191], v[60:63], v[80:83], v[176:191]
    s_waitcnt lgkmcnt(0)
    s_barrier
    v_mfma_f32_32x32x16_bf16 v[128:143], v[64:67], v[88:91], v[128:143]
    v_mfma_f32_32x32x16_bf16 v[192:207], v[64:67], v[92:95], v[192:207]
    v_mfma_f32_32x32x16_bf16 v[144:159], v[68:71], v[88:91], v[144:159]
    v_mfma_f32_32x32x16_bf16 v[208:223], v[68:71], v[92:95], v[208:223]
    v_mfma_f32_32x32x16_bf16 v[160:175], v[72:75], v[88:91], v[160:175]
    v_mfma_f32_32x32x16_bf16 v[176:191], v[76:79], v[88:91], v[176:191]
    v_lshrrev_b32 v2, 3, v1
    v_mul_u32_u24 v2, 1280, v2
    v_bfe_u32 v3, v1, 4, 1
    v_lshlrev_b32 v3, 2, v3
    v_and_b32 v4, 7, v1
    v_xor_b32 v3, v3, v4
    v_lshl_add_u32 v12, v3, 4, v2
    v_add_u32 v13, 9216, v12
    v_add_u32 v14, 18432, v12
    v_add_u32 v15, 27648, v12
    s_nop 4
    v_mul_f32 v128, s51, v128
    v_mul_f32 v129, s51, v129
    v_cvt_pk_bf16_f32 v96, v128, v129
    v_mul_f32 v130, s51, v130
    v_mul_f32 v131, s51, v131
    v_cvt_pk_bf16_f32 v97, v130, v131
    v_mul_f32 v132, s51, v132
    v_mul_f32 v133, s51, v133
    v_cvt_pk_bf16_f32 v98, v132, v133
    v_mul_f32 v134, s51, v134
    v_mul_f32 v135, s51, v135
    v_cvt_pk_bf16_f32 v99, v134, v135
    v_mul_f32 v136, s51, v136
    v_mul_f32 v137, s51, v137
    v_cvt_pk_bf16_f32 v100, v136, v137
    v_mul_f32 v138, s51, v138
    v_mul_f32 v139, s51, v139
    v_cvt_pk_bf16_f32 v101, v138, v139
    v_mul_f32 v140, s51, v140
    v_mul_f32 v141, s51, v141
    v_cvt_pk_bf16_f32 v102, v140, v141
    v_mul_f32 v142, s51, v142
    v_mul_f32 v143, s51, v143
    v_cvt_pk_bf16_f32 v103, v142, v143
    v_mul_f32 v144, s51, v144
    v_mul_f32 v145, s51, v145
    v_cvt_pk_bf16_f32 v104, v144, v145
    v_mul_f32 v146, s51, v146
    v_mul_f32 v147, s51, v147
    v_cvt_pk_bf16_f32 v105, v146, v147
    v_mul_f32 v148, s51, v148
    v_mul_f32 v149, s51, v149
    v_cvt_pk_bf16_f32 v106, v148, v149
    v_mul_f32 v150, s51, v150
    v_mul_f32 v151, s51, v151
    v_cvt_pk_bf16_f32 v107, v150, v151
    v_mul_f32 v152, s51, v152
    v_mul_f32 v153, s51, v153
    v_cvt_pk_bf16_f32 v108, v152, v153
    v_mul_f32 v154, s51, v154
    v_mul_f32 v155, s51, v155
    v_cvt_pk_bf16_f32 v109, v154, v155
    v_mul_f32 v156, s51, v156
    v_mul_f32 v157, s51, v157
    v_cvt_pk_bf16_f32 v110, v156, v157
    v_mul_f32 v158, s51, v158
    v_mul_f32 v159, s51, v159
    v_cvt_pk_bf16_f32 v111, v158, v159
    ds_read_b128 v[128:131], v16 offset:0
    ds_read_b128 v[132:135], v17 offset:0
    ds_read_b128 v[136:139], v18 offset:0
    ds_read_b128 v[140:143], v19 offset:0
    ds_read_b128 v[144:147], v20 offset:0
    ds_read_b128 v[148:151], v21 offset:0
    ds_read_b128 v[152:155], v22 offset:0
    ds_read_b128 v[156:159], v23 offset:0
    v_mul_f32 v160, s51, v160
    v_mul_f32 v161, s51, v161
    v_cvt_pk_bf16_f32 v112, v160, v161
    v_mul_f32 v162, s51, v162
    v_mul_f32 v163, s51, v163
    v_cvt_pk_bf16_f32 v113, v162, v163
    v_mul_f32 v164, s51, v164
    v_mul_f32 v165, s51, v165
    v_cvt_pk_bf16_f32 v114, v164, v165
    v_mul_f32 v166, s51, v166
    v_mul_f32 v167, s51, v167
    v_cvt_pk_bf16_f32 v115, v166, v167
    v_mul_f32 v168, s51, v168
    v_mul_f32 v169, s51, v169
    v_cvt_pk_bf16_f32 v116, v168, v169
    v_mul_f32 v170, s51, v170
    v_mul_f32 v171, s51, v171
    v_cvt_pk_bf16_f32 v117, v170, v171
    v_mul_f32 v172, s51, v172
    v_mul_f32 v173, s51, v173
    v_cvt_pk_bf16_f32 v118, v172, v173
    v_mul_f32 v174, s51, v174
    v_mul_f32 v175, s51, v175
    v_cvt_pk_bf16_f32 v119, v174, v175
    v_mul_f32 v176, s51, v176
    v_mul_f32 v177, s51, v177
    v_cvt_pk_bf16_f32 v120, v176, v177
    v_mul_f32 v178, s51, v178
    v_mul_f32 v179, s51, v179
    v_cvt_pk_bf16_f32 v121, v178, v179
    v_mul_f32 v180, s51, v180
    v_mul_f32 v181, s51, v181
    v_cvt_pk_bf16_f32 v122, v180, v181
    v_mul_f32 v182, s51, v182
    v_mul_f32 v183, s51, v183
    v_cvt_pk_bf16_f32 v123, v182, v183
    v_mul_f32 v184, s51, v184
    v_mul_f32 v185, s51, v185
    v_cvt_pk_bf16_f32 v124, v184, v185
    v_mul_f32 v186, s51, v186
    v_mul_f32 v187, s51, v187
    v_cvt_pk_bf16_f32 v125, v186, v187
    v_mul_f32 v188, s51, v188
    v_mul_f32 v189, s51, v189
    v_cvt_pk_bf16_f32 v126, v188, v189
    v_mul_f32 v190, s51, v190
    v_mul_f32 v191, s51, v191
    v_cvt_pk_bf16_f32 v127, v190, v191
    s_waitcnt lgkmcnt(0)
    v_mfma_f32_32x32x16_bf16 v[48:63], v[128:131], v[96:99], v[32:47]
    v_mfma_f32_32x32x16_bf16 v[48:63], v[132:135], v[100:103], v[48:63]
    v_mfma_f32_32x32x16_bf16 v[48:63], v[136:139], v[104:107], v[48:63]
    v_mfma_f32_32x32x16_bf16 v[48:63], v[140:143], v[108:111], v[48:63]
    v_mfma_f32_32x32x16_bf16 v[48:63], v[144:147], v[112:115], v[48:63]
    v_mfma_f32_32x32x16_bf16 v[48:63], v[148:151], v[116:119], v[48:63]
    v_mfma_f32_32x32x16_bf16 v[48:63], v[152:155], v[120:123], v[48:63]
    v_mfma_f32_32x32x16_bf16 v[48:63], v[156:159], v[124:127], v[48:63]
    ds_read_b128 v[128:131], v16 offset:8192
    ds_read_b128 v[132:135], v17 offset:8192
    ds_read_b128 v[136:139], v18 offset:8192
    ds_read_b128 v[140:143], v19 offset:8192
    ds_read_b128 v[144:147], v20 offset:8192
    ds_read_b128 v[148:151], v21 offset:8192
    ds_read_b128 v[152:155], v22 offset:8192
    ds_read_b128 v[156:159], v23 offset:8192
    v_add_u32 v16, 16384, v16
    v_add_u32 v17, 16384, v17
    v_add_u32 v18, 16384, v18
    v_add_u32 v19, 16384, v19
    v_add_u32 v20, 16384, v20
    v_add_u32 v21, 16384, v21
    v_add_u32 v22, 16384, v22
    v_add_u32 v23, 16384, v23
    s_nop 3
    v_max3_f32 v10, v48, v49, v50
    v_max3_f32 v11, v51, v52, v53
    v_max3_f32 v10, v10, v54, v55
    v_max3_f32 v11, v11, v56, v57
    v_max3_f32 v10, v10, v58, v59
    v_max3_f32 v11, v11, v60, v61
    v_max3_f32 v10, v10, v62, v63
    v_max_f32 v10, v10, v11
    v_cmp_lt_f32 vcc, s49, v10
    s_branch L_rare_a
L_tick:
    s_waitcnt lgkmcnt(0)
    s_barrier
    s_cmp_eq_u32 s46, 31
    s_cbranch_scc1 L_last
    s_waitcnt lgkmcnt(0)
    v_mfma_f32_32x32x16_bf16 v[64:79], v[128:131], v[96:99], v[32:47]
    ds_read_b64_tr_b16 v[160:161], v24 offset:0
    ds_read_b64_tr_b16 v[162:163], v24 offset:2048
    ds_read_b64_tr_b16 v[164:165], v25 offset:0
    ds_read_b64_tr_b16 v[166:167], v25 offset:2048
    ds_read_b64_tr_b16 v[168:169], v26 offset:0
    ds_read_b64_tr_b16 v[170:171], v26 offset:2048
    v_mfma_f32_32x32x16_bf16 v[64:79], v[132:135], v[100:103], v[64:79]
    ds_read_b64_tr_b16 v[172:173], v27 offset:0
    ds_read_b64_tr_b16 v[174:175], v27 offset:2048
    ds_read_b64_tr_b16 v[176:177], v24 offset:4096
    ds_read_b64_tr_b16 v[178:179], v24 offset:6144
    ds_read_b64_tr_b16 v[180:181], v25 offset:4096
    v_mfma_f32_32x32x16_bf16 v[64:79], v[136:139], v[104:107], v[64:79]
    ds_read_b64_tr_b16 v[182:183], v25 offset:6144
    ds_read_b64_tr_b16 v[184:185], v26 offset:4096
    ds_read_b64_tr_b16 v[186:187], v26 offset:6144
    ds_read_b64_tr_b16 v[188:189], v27 offset:4096
    ds_read_b64_tr_b16 v[190:191], v27 offset:6144
    v_exp_f32 v48, v48
    v_mfma_f32_32x32x16_bf16 v[64:79], v[140:143], v[108:111], v[64:79]
    v_exp_f32 v49, v49
    v_exp_f32 v50, v50
    v_mfma_f32_32x32x16_bf16 v[64:79], v[144:147], v[112:115], v[64:79]
    v_exp_f32 v51, v51
    v_exp_f32 v52, v52
    v_exp_f32 v53, v53
    v_mfma_f32_32x32x16_bf16 v[64:79], v[148:151], v[116:119], v[64:79]
    v_exp_f32 v54, v54
    v_exp_f32 v55, v55
    v_cvt_pk_bf16_f32 v80, v48, v49
    v_cvt_pk_bf16_f32 v81, v50, v51
    v_mfma_f32_32x32x16_bf16 v[64:79], v[152:155], v[120:123], v[64:79]
    v_cvt_pk_bf16_f32 v82, v52, v53
    v_cvt_pk_bf16_f32 v83, v54, v55
    v_exp_f32 v56, v56
    v_exp_f32 v57, v57
    v_mfma_f32_32x32x16_bf16 v[64:79], v[156:159], v[124:127], v[64:79]
    v_exp_f32 v58, v58
    v_exp_f32 v59, v59
    s_waitcnt lgkmcnt(0)
    v_mfma_f32_32x32x16_bf16 a[0:15], v[160:163], v[80:83], a[0:15]
    ds_read_b128 v[128:131], v16 offset:0
    ds_read_b128 v[132:135], v17 offset:0
    ds_read_b128 v[136:139], v18 offset:0
    ds_read_b128 v[140:143], v19 offset:0
    ds_read_b128 v[144:147], v20 offset:0
    ds_read_b128 v[148:151], v21 offset:0
    v_mfma_f32_32x32x16_bf16 a[16:31], v[164:167], v[80:83], a[16:31]
    ds_read_b128 v[152:155], v22 offset:0
    ds_read_b128 v[156:159], v23 offset:0
    v_exp_f32 v60, v60
    v_exp_f32 v61, v61
    v_mfma_f32_32x32x16_bf16 a[32:47], v[168:171], v[80:83], a[32:47]
    v_exp_f32 v62, v62
    v_exp_f32 v63, v63
    v_add_f32 v6, v6, v48
    v_mfma_f32_32x32x16_bf16 a[48:63], v[172:175], v[80:83], a[48:63]
    v_cvt_pk_bf16_f32 v84, v56, v57
    v_cvt_pk_bf16_f32 v85, v58, v59
    v_cvt_pk_bf16_f32 v86, v60, v61
    v_cvt_pk_bf16_f32 v87, v62, v63
    v_add_f32 v7, v7, v49
    v_add_f32 v8, v8, v50
    v_mfma_f32_32x32x16_bf16 a[0:15], v[176:179], v[84:87], a[0:15]
    v_add_f32 v9, v9, v51
    v_add_f32 v6, v6, v52
    v_add_f32 v7, v7, v53
    v_add_f32 v8, v8, v54
    v_add_f32 v9, v9, v55
    v_add_f32 v6, v6, v56
    v_mfma_f32_32x32x16_bf16 a[16:31], v[180:183], v[84:87], a[16:31]
    v_add_f32 v7, v7, v57
    v_add_f32 v8, v8, v58
    v_add_f32 v9, v9, v59
    v_add_f32 v6, v6, v60
    v_add_f32 v7, v7, v61
    v_mfma_f32_32x32x16_bf16 a[32:47], v[184:187], v[84:87], a[32:47]
    v_add_f32 v8, v8, v62
    v_add_f32 v9, v9, v63
    v_max3_f32 v10, v64, v65, v66
    v_max3_f32 v11, v67, v68, v69
    v_max3_f32 v10, v10, v70, v71
    v_max3_f32 v11, v11, v72, v73
    v_mfma_f32_32x32x16_bf16 a[48:63], v[188:191], v[84:87], a[48:63]
    v_max3_f32 v10, v10, v74, v75
    v_max3_f32 v11, v11, v76, v77
    v_max3_f32 v10, v10, v78, v79
    v_max_f32 v10, v10, v11
    v_cmp_lt_f32 vcc, s49, v10
    s_cbranch_vccnz L_rare_b
L_back_b:
    s_cmp_eq_u32 s46, 15
    s_cbranch_scc1 L_switch
L_back_sw:
    s_waitcnt lgkmcnt(0)
    v_mfma_f32_32x32x16_bf16 v[48:63], v[128:131], v[96:99], v[32:47]
    ds_read_b64_tr_b16 v[160:161], v24 offset:8192
    ds_read_b64_tr_b16 v[162:163], v24 offset:10240
    ds_read_b64_tr_b16 v[164:165], v25 offset:8192
    ds_read_b64_tr_b16 v[166:167], v25 offset:10240
    ds_read_b64_tr_b16 v[168:169], v26 offset:8192
    ds_read_b64_tr_b16 v[170:171], v26 offset:10240
    ds_read_b64_tr_b16 v[172:173], v27 offset:8192
    v_mfma_f32_32x32x16_bf16 v[48:63], v[132:135], v[100:103], v[48:63]
    ds_read_b64_tr_b16 v[174:175], v27 offset:10240
    ds_read_b64_tr_b16 v[176:177], v24 offset:12288
    ds_read_b64_tr_b16 v[178:179], v24 offset:14336
    ds_read_b64_tr_b16 v[180:181], v25 offset:12288
    ds_read_b64_tr_b16 v[182:183], v25 offset:14336
    ds_read_b64_tr_b16 v[184:185], v26 offset:12288
    v_mfma_f32_32x32x16_bf16 v[48:63], v[136:139], v[104:107], v[48:63]
    ds_read_b64_tr_b16 v[186:187], v26 offset:14336
    ds_read_b64_tr_b16 v[188:189], v27 offset:12288
    ds_read_b64_tr_b16 v[190:191], v27 offset:14336
    v_exp_f32 v64, v64
    v_exp_f32 v65, v65
    v_mfma_f32_32x32x16_bf16 v[48:63], v[140:143], v[108:111], v[48:63]
    v_exp_f32 v66, v66
    v_exp_f32 v67, v67
    v_exp_f32 v68, v68
    v_mfma_f32_32x32x16_bf16 v[48:63], v[144:147], v[112:115], v[48:63]
    v_exp_f32 v69, v69
    v_exp_f32 v70, v70
    v_exp_f32 v71, v71
    s_cmp_ge_u32 s48, 98304
    s_cselect_b32 s41, 131072, 0
    v_mfma_f32_32x32x16_bf16 v[48:63], v[148:151], v[116:119], v[48:63]
    s_sub_u32 s41, 32768, s41
    s_add_u32 s48, s48, s41
    v_add_u32 v24, s41, v24
    v_add_u32 v25, s41, v25
    v_add_u32 v26, s41, v26
    v_add_u32 v27, s41, v27
    v_cvt_pk_bf16_f32 v80, v64, v65
    v_cvt_pk_bf16_f32 v81, v66, v67
    v_mfma_f32_32x32x16_bf16 v[48:63], v[152:155], v[120:123], v[48:63]
    v_cvt_pk_bf16_f32 v82, v68, v69
    v_cvt_pk_bf16_f32 v83, v70, v71
    v_exp_f32 v72, v72
    v_exp_f32 v73, v73
    v_mfma_f32_32x32x16_bf16 v[48:63], v[156:159], v[124:127], v[48:63]
    v_exp_f32 v74, v74
    v_exp_f32 v75, v75
    s_waitcnt lgkmcnt(0)
    v_mfma_f32_32x32x16_bf16 a[0:15], v[160:163], v[80:83], a[0:15]
    ds_read_b128 v[128:131], v16 offset:8192
    ds_read_b128 v[132:135], v17 offset:8192
    ds_read_b128 v[136:139], v18 offset:8192
    ds_read_b128 v[140:143], v19 offset:8192
    ds_read_b128 v[144:147], v20 offset:8192
    ds_read_b128 v[148:151], v21 offset:8192
    ds_read_b128 v[152:155], v22 offset:8192
    ds_read_b128 v[156:159], v23 offset:8192
    v_exp_f32 v76, v76
    v_mfma_f32_32x32x16_bf16 a[16:31], v[164:167], v[80:83], a[16:31]
    v_exp_f32 v77, v77
    v_exp_f32 v78, v78
    v_exp_f32 v79, v79
    v_mfma_f32_32x32x16_bf16 a[32:47], v[168:171], v[80:83], a[32:47]
    v_add_f32 v6, v6, v64
    v_cvt_pk_bf16_f32 v84, v72, v73
    v_cvt_pk_bf16_f32 v85, v74, v75
    v_cvt_pk_bf16_f32 v86, v76, v77
    v_cvt_pk_bf16_f32 v87, v78, v79
    v_add_f32 v7, v7, v65
    v_mfma_f32_32x32x16_bf16 a[48:63], v[172:175], v[80:83], a[48:63]
    v_add_f32 v8, v8, v66
    v_add_f32 v9, v9, v67
    v_add_f32 v6, v6, v68
    v_add_f32 v7, v7, v69
    v_add_f32 v8, v8, v70
    v_add_f32 v9, v9, v71
    v_add_f32 v6, v6, v72
    v_mfma_f32_32x32x16_bf16 a[0:15], v[176:179], v[84:87], a[0:15]
    v_add_f32 v7, v7, v73
    v_add_f32 v8, v8, v74
    v_add_f32 v9, v9, v75
    v_add_f32 v6, v6, v76
    v_add_f32 v7, v7, v77
    v_add_f32 v8, v8, v78
    v_add_f32 v9, v9, v79
    v_mfma_f32_32x32x16_bf16 a[16:31], v[180:183], v[84:87], a[16:31]
    s_cmp_ge_u32 s47, 98304
    s_cselect_b32 s41, 131072, 0
    s_sub_u32 s41, 32768, s41
    s_add_u32 s47, s47, s41
    v_add_u32 v16, s41, v16
    v_add_u32 v17, s41, v17
    v_add_u32 v18, s41, v18
    v_add_u32 v19, s41, v19
    v_mfma_f32_32x32x16_bf16 a[32:47], v[184:187], v[84:87], a[32:47]
    v_add_u32 v20, s41, v20
    v_add_u32 v21, s41, v21
    v_add_u32 v22, s41, v22
    v_add_u32 v23, s41, v23
    v_max3_f32 v10, v48, v49, v50
    v_max3_f32 v11, v51, v52, v53
    v_max3_f32 v10, v10, v54, v55
    v_mfma_f32_32x32x16_bf16 a[48:63], v[188:191], v[84:87], a[48:63]
    v_max3_f32 v11, v11, v56, v57
    v_max3_f32 v10, v10, v58, v59
    v_max3_f32 v11, v11, v60, v61
    v_max3_f32 v10, v10, v62, v63
    v_max_f32 v10, v10, v11
    v_cmp_lt_f32 vcc, s49, v10
    s_add_u32 s46, s46, 1
    s_sub_u32 s62, s62, 1
    s_cmp_eq_u32 s62, 0
    s_cbranch_scc1 L_snip
L_snip_ret:
    s_cmp_eq_u32 s46, 16
    s_cbranch_scc1 L_epi1
    s_cbranch_vccz L_tick
L_rare_a:
    s_nop 7
    v_mov_b32 v2, v10
    s_nop 1
    v_permlane32_swap_b32 v2, v10
    s_nop 1
    v_max_f32 v11, v2, v10
    v_max_f32 v11, s50, v11
    v_sub_f32 v48, v48, v11
    v_sub_f32 v49, v49, v11
    v_sub_f32 v50, v50, v11
    v_sub_f32 v51, v51, v11
    v_sub_f32 v52, v52, v11
    v_sub_f32 v53, v53, v11
    v_sub_f32 v54, v54, v11
    v_sub_f32 v55, v55, v11
    v_sub_f32 v56, v56, v11
    v_sub_f32 v57, v57, v11
    v_sub_f32 v58, v58, v11
    v_sub_f32 v59, v59, v11
    v_sub_f32 v60, v60, v11
    v_sub_f32 v61, v61, v11
    v_sub_f32 v62, v62, v11
    v_sub_f32 v63, v63, v11
    v_sub_f32 v32, v32, v11
    v_sub_f32 v33, v33, v11
    v_sub_f32 v34, v34, v11
    v_sub_f32 v35, v35, v11
    v_sub_f32 v36, v36, v11
    v_sub_f32 v37, v37, v11
    v_sub_f32 v38, v38, v11
    v_sub_f32 v39, v39, v11
    v_sub_f32 v40, v40, v11
    v_sub_f32 v41, v41, v11
    v_sub_f32 v42, v42, v11
    v_sub_f32 v43, v43, v11
    v_sub_f32 v44, v44, v11
    v_sub_f32 v45, v45, v11
    v_sub_f32 v46, v46, v11
    v_sub_f32 v47, v47, v11
    s_cmp_lg_u32 s50, 0
    s_mov_b32 s49, 0x41000000
    s_mov_b32 s50, 0
    s_cbranch_scc1 L_tick
    v_sub_f32 v2, 0, v11
    v_exp_f32 v2, v2
    s_nop 0
    v_mul_f32 v6, v6, v2
    v_mul_f32 v7, v7, v2
    v_mul_f32 v8, v8, v2
    v_mul_f32 v9, v9, v2
    v_accvgpr_read_b32 v88, a0
    v_accvgpr_read_b32 v89, a1
    v_accvgpr_read_b32 v90, a2
    v_accvgpr_read_b32 v91, a3
    v_mul_f32 v88, v88, v2
    v_mul_f32 v89, v89, v2
    v_mul_f32 v90, v90, v2
    v_mul_f32 v91, v91, v2
    v_accvgpr_write_b32 a0, v88
    v_accvgpr_write_b32 a1, v89
    v_accvgpr_write_b32 a2, v90
    v_accvgpr_write_b32 a3, v91
    v_accvgpr_read_b32 v88, a4
    v_accvgpr_read_b32 v89, a5
    v_accvgpr_read_b32 v90, a6
    v_accvgpr_read_b32 v91, a7
    v_mul_f32 v88, v88, v2
    v_mul_f32 v89, v89, v2
    v_mul_f32 v90, v90, v2
    v_mul_f32 v91, v91, v2
    v_accvgpr_write_b32 a4, v88
    v_accvgpr_write_b32 a5, v89
    v_accvgpr_write_b32 a6, v90
    v_accvgpr_write_b32 a7, v91
    v_accvgpr_read_b32 v88, a8
    v_accvgpr_read_b32 v89, a9
    v_accvgpr_read_b32 v90, a10
    v_accvgpr_read_b32 v91, a11
    v_mul_f32 v88, v88, v2
    v_mul_f32 v89, v89, v2
    v_mul_f32 v90, v90, v2
    v_mul_f32 v91, v91, v2
    v_accvgpr_write_b32 a8, v88
    v_accvgpr_write_b32 a9, v89
    v_accvgpr_write_b32 a10, v90
    v_accvgpr_write_b32 a11, v91
    v_accvgpr_read_b32 v88, a12
    v_accvgpr_read_b32 v89, a13
    v_accvgpr_read_b32 v90, a14
    v_accvgpr_read_b32 v91, a15
    v_mul_f32 v88, v88, v2
    v_mul_f32 v89, v89, v2
    v_mul_f32 v90, v90, v2
    v_mul_f32 v91, v91, v2
    v_accvgpr_write_b32 a12, v88
    v_accvgpr_write_b32 a13, v89
    v_accvgpr_write_b32 a14, v90
    v_accvgpr_write_b32 a15, v91
    v_accvgpr_read_b32 v88, a16
    v_accvgpr_read_b32 v89, a17
    v_accvgpr_read_b32 v90, a18
    v_accvgpr_read_b32 v91, a19
    v_mul_f32 v88, v88, v2
    v_mul_f32 v89, v89, v2
    v_mul_f32 v90, v90, v2
    v_mul_f32 v91, v91, v2
    v_accvgpr_write_b32 a16, v88
    v_accvgpr_write_b32 a17, v89
    v_accvgpr_write_b32 a18, v90
    v_accvgpr_write_b32 a19, v91
    v_accvgpr_read_b32 v88, a20
    v_accvgpr_read_b32 v89, a21
    v_accvgpr_read_b32 v90, a22
    v_accvgpr_read_b32 v91, a23
    v_mul_f32 v88, v88, v2
    v_mul_f32 v89, v89, v2
    v_mul_f32 v90, v90, v2
    v_mul_f32 v91, v91, v2
    v_accvgpr_write_b32 a20, v88
    v_accvgpr_write_b32 a21, v89
    v_accvgpr_write_b32 a22, v90
    v_accvgpr_write_b32 a23, v91
    v_accvgpr_read_b32 v88, a24
    v_accvgpr_read_b32 v89, a25
    v_accvgpr_read_b32 v90, a26
    v_accvgpr_read_b32 v91, a27
    v_mul_f32 v88, v88, v2
    v_mul_f32 v89, v89, v2
    v_mul_f32 v90, v90, v2
    v_mul_f32 v91, v91, v2
    v_accvgpr_write_b32 a24, v88
    v_accvgpr_write_b32 a25, v89
    v_accvgpr_write_b32 a26, v90
    v_accvgpr_write_b32 a27, v91
    v_accvgpr_read_b32 v88, a28
    v_accvgpr_read_b32 v89, a29
    v_accvgpr_read_b32 v90, a30
    v_accvgpr_read_b32 v91, a31
    v_mul_f32 v88, v88, v2
    v_mul_f32 v89, v89, v2
    v_mul_f32 v90, v90, v2
    v_mul_f32 v91, v91, v2
    v_accvgpr_write_b32 a28, v88
    v_accvgpr_write_b32 a29, v89
    v_accvgpr_write_b32 a30, v90
    v_accvgpr_write_b32 a31, v91
    v_accvgpr_read_b32 v88, a32
    v_accvgpr_read_b32 v89, a33
    v_accvgpr_read_b32 v90, a34
    v_accvgpr_read_b32 v91, a35
    v_mul_f32 v88, v88, v2
    v_mul_f32 v89, v89, v2
    v_mul_f32 v90, v90, v2
    v_mul_f32 v91, v91, v2
    v_accvgpr_write_b32 a32, v88
    v_accvgpr_write_b32 a33, v89
    v_accvgpr_write_b32 a34, v90
    v_accvgpr_write_b32 a35, v91
    v_accvgpr_read_b32 v88, a36
    v_accvgpr_read_b32 v89, a37
    v_accvgpr_read_b32 v90, a38
    v_accvgpr_read_b32 v91, a39
    v_mul_f32 v88, v88, v2
    v_mul_f32 v89, v89, v2
    v_mul_f32 v90, v90, v2
    v_mul_f32 v91, v91, v2
    v_accvgpr_write_b32 a36, v88
    v_accvgpr_write_b32 a37, v89
    v_accvgpr_write_b32 a38, v90
    v_accvgpr_write_b32 a39, v91
    v_accvgpr_read_b32 v88, a40
    v_accvgpr_read_b32 v89, a41
    v_accvgpr_read_b32 v90, a42
    v_accvgpr_read_b32 v91, a43
    v_mul_f32 v88, v88, v2
    v_mul_f32 v89, v89, v2
    v_mul_f32 v90, v90, v2
    v_mul_f32 v91, v91, v2
    v_accvgpr_write_b32 a40, v88
    v_accvgpr_write_b32 a41, v89
    v_accvgpr_write_b32 a42, v90
    v_accvgpr_write_b32 a43, v91
    v_accvgpr_read_b32 v88, a44
    v_accvgpr_read_b32 v89, a45
    v_accvgpr_read_b32 v90, a46
    v_accvgpr_read_b32 v91, a47
    v_mul_f32 v88, v88, v2
    v_mul_f32 v89, v89, v2
    v_mul_f32 v90, v90, v2
    v_mul_f32 v91, v91, v2
    v_accvgpr_write_b32 a44, v88
    v_accvgpr_write_b32 a45, v89
    v_accvgpr_write_b32 a46, v90
    v_accvgpr_write_b32 a47, v91
    v_accvgpr_read_b32 v88, a48
    v_accvgpr_read_b32 v89, a49
    v_accvgpr_read_b32 v90, a50
    v_accvgpr_read_b32 v91, a51
    v_mul_f32 v88, v88, v2
    v_mul_f32 v89, v89, v2
    v_mul_f32 v90, v90, v2
    v_mul_f32 v91, v91, v2
    v_accvgpr_write_b32 a48, v88
    v_accvgpr_write_b32 a49, v89
    v_accvgpr_write_b32 a50, v90
    v_accvgpr_write_b32 a51, v91
    v_accvgpr_read_b32 v88, a52
    v_accvgpr_read_b32 v89, a53
    v_accvgpr_read_b32 v90, a54
    v_accvgpr_read_b32 v91, a55
    v_mul_f32 v88, v88, v2
    v_mul_f32 v89, v89, v2
    v_mul_f32 v90, v90, v2
    v_mul_f32 v91, v91, v2
    v_accvgpr_write_b32 a52, v88
    v_accvgpr_write_b32 a53, v89
    v_accvgpr_write_b32 a54, v90
    v_accvgpr_write_b32 a55, v91
    v_accvgpr_read_b32 v88, a56
    v_accvgpr_read_b32 v89, a57
    v_accvgpr_read_b32 v90, a58
    v_accvgpr_read_b32 v91, a59
    v_mul_f32 v88, v88, v2
    v_mul_f32 v89, v89, v2
    v_mul_f32 v90, v90, v2
    v_mul_f32 v91, v91, v2
    v_accvgpr_write_b32 a56, v88
    v_accvgpr_write_b32 a57, v89
    v_accvgpr_write_b32 a58, v90
    v_accvgpr_write_b32 a59, v91
    v_accvgpr_read_b32 v88, a60
    v_accvgpr_read_b32 v89, a61
    v_accvgpr_read_b32 v90, a62
    v_accvgpr_read_b32 v91, a63
    v_mul_f32 v88, v88, v2
    v_mul_f32 v89, v89, v2
    v_mul_f32 v90, v90, v2
    v_mul_f32 v91, v91, v2
    v_accvgpr_write_b32 a60, v88
    v_accvgpr_write_b32 a61, v89
    v_accvgpr_write_b32 a62, v90
    v_accvgpr_write_b32 a63, v91
    s_nop 1
    s_branch L_tick
L_snip:
    s_waitcnt vmcnt(0)
    s_cmp_ge_u32 s59, 5
    s_cbranch_scc1 L_sn_5
    s_cmp_ge_u32 s59, 3
    s_cbranch_scc1 L_sn_3
    s_cmp_ge_u32 s59, 2
    s_cbranch_scc1 L_sn_2
    s_cmp_ge_u32 s59, 1
    s_cbranch_scc1 L_sn_1
    ds_read_b128 v[224:227], v31 offset:0
    ds_read_b128 v[228:231], v31 offset:1024
    ds_read_b128 v[232:235], v31 offset:2048
    ds_read_b128 v[236:239], v31 offset:3072
    v_mul_f32 v192, s51, v192
    v_mul_f32 v193, s51, v193
    v_cvt_pk_bf16_f32 v192, v192, v193
    v_mul_f32 v194, s51, v194
    v_mul_f32 v195, s51, v195
    v_cvt_pk_bf16_f32 v193, v194, v195
    v_mul_f32 v196, s51, v196
    v_mul_f32 v197, s51, v197
    v_cvt_pk_bf16_f32 v194, v196, v197
    v_mul_f32 v198, s51, v198
    v_mul_f32 v199, s51, v199
    v_cvt_pk_bf16_f32 v195, v198, v199
    v_mul_f32 v200, s51, v200
    v_mul_f32 v201, s51, v201
    v_cvt_pk_bf16_f32 v196, v200, v201
    v_mul_f32 v202, s51, v202
    v_mul_f32 v203, s51, v203
    v_cvt_pk_bf16_f32 v197, v202, v203
    v_mul_f32 v204, s51, v204
    v_mul_f32 v205, s51, v205
    v_cvt_pk_bf16_f32 v198, v204, v205
    v_mul_f32 v206, s51, v206
    v_mul_f32 v207, s51, v207
    v_cvt_pk_bf16_f32 v199, v206, v207
    v_mul_f32 v208, s51, v208
    v_mul_f32 v209, s51, v209
    v_cvt_pk_bf16_f32 v200, v208, v209
    v_mul_f32 v210, s51, v210
    v_mul_f32 v211, s51, v211
    v_cvt_pk_bf16_f32 v201, v210, v211
    v_mul_f32 v212, s51, v212
    v_mul_f32 v213, s51, v213
    v_cvt_pk_bf16_f32 v202, v212, v213
    v_mul_f32 v214, s51, v214
    v_mul_f32 v215, s51, v215
    v_cvt_pk_bf16_f32 v203, v214, v215
    v_mul_f32 v216, s51, v216
    v_mul_f32 v217, s51, v217
    v_cvt_pk_bf16_f32 v204, v216, v217
    v_mul_f32 v218, s51, v218
    v_mul_f32 v219, s51, v219
    v_cvt_pk_bf16_f32 v205, v218, v219
    v_mul_f32 v220, s51, v220
    v_mul_f32 v221, s51, v221
    v_cvt_pk_bf16_f32 v206, v220, v221
    v_mul_f32 v222, s51, v222
    v_mul_f32 v223, s51, v223
    v_cvt_pk_bf16_f32 v207, v222, v223
    s_branch L_sn_done
L_sn_1:
    ds_read_b64_tr_b16 a[64:65], v29 offset:0
    ds_read_b64_tr_b16 a[66:67], v29 offset:1024
    ds_read_b64_tr_b16 a[68:69], v30 offset:0
    ds_read_b64_tr_b16 a[70:71], v30 offset:1024
    ds_read_b64_tr_b16 a[72:73], v29 offset:2048
    ds_read_b64_tr_b16 a[74:75], v29 offset:3072
    ds_read_b64_tr_b16 a[76:77], v30 offset:2048
    ds_read_b64_tr_b16 a[78:79], v30 offset:3072
    ds_read_b64_tr_b16 a[80:81], v29 offset:4096
    ds_read_b64_tr_b16 a[82:83], v29 offset:5120
    ds_read_b64_tr_b16 a[84:85], v30 offset:4096
    ds_read_b64_tr_b16 a[86:87], v30 offset:5120
    ds_read_b64_tr_b16 a[88:89], v29 offset:6144
    ds_read_b64_tr_b16 a[90:91], v29 offset:7168
    ds_read_b64_tr_b16 a[92:93], v30 offset:6144
    ds_read_b64_tr_b16 a[94:95], v30 offset:7168
    s_branch L_sn_done
L_sn_2:
    ds_read_b64_tr_b16 a[96:97], v29 offset:0
    ds_read_b64_tr_b16 a[98:99], v29 offset:1024
    ds_read_b64_tr_b16 a[100:101], v30 offset:0
    ds_read_b64_tr_b16 a[102:103], v30 offset:1024
    ds_read_b64_tr_b16 a[104:105], v29 offset:2048
    ds_read_b64_tr_b16 a[106:107], v29 offset:3072
    ds_read_b64_tr_b16 a[108:109], v30 offset:2048
    ds_read_b64_tr_b16 a[110:111], v30 offset:3072
    ds_read_b64_tr_b16 a[112:113], v29 offset:4096
    ds_read_b64_tr_b16 a[114:115], v29 offset:5120
    ds_read_b64_tr_b16 a[116:117], v30 offset:4096
    ds_read_b64_tr_b16 a[118:119], v30 offset:5120
    ds_read_b64_tr_b16 a[120:121], v29 offset:6144
    ds_read_b64_tr_b16 a[122:123], v29 offset:7168
    ds_read_b64_tr_b16 a[124:125], v30 offset:6144
    ds_read_b64_tr_b16 a[126:127], v30 offset:7168
    s_branch L_sn_done
L_sn_3:
    s_cmp_ge_u32 s59, 4
    s_cbranch_scc1 L_sn_4
    ds_read_b64_tr_b16 a[128:129], v29 offset:0
    ds_read_b64_tr_b16 a[130:131], v29 offset:1024
    ds_read_b64_tr_b16 a[132:133], v30 offset:0
    ds_read_b64_tr_b16 a[134:135], v30 offset:1024
    ds_read_b64_tr_b16 a[136:137], v29 offset:2048
    ds_read_b64_tr_b16 a[138:139], v29 offset:3072
    ds_read_b64_tr_b16 a[140:141], v30 offset:2048
    ds_read_b64_tr_b16 a[142:143], v30 offset:3072
    ds_read_b64_tr_b16 a[144:145], v29 offset:4096
    ds_read_b64_tr_b16 a[146:147], v29 offset:5120
    ds_read_b64_tr_b16 a[148:149], v30 offset:4096
    ds_read_b64_tr_b16 a[150:151], v30 offset:5120
    ds_read_b64_tr_b16 a[152:153], v29 offset:6144
    ds_read_b64_tr_b16 a[154:155], v29 offset:7168
    ds_read_b64_tr_b16 a[156:157], v30 offset:6144
    ds_read_b64_tr_b16 a[158:159], v30 offset:7168
    s_branch L_sn_done
L_sn_4:
    ds_read_b64_tr_b16 a[160:161], v29 offset:0
    ds_read_b64_tr_b16 a[162:163], v29 offset:1024
    ds_read_b64_tr_b16 a[164:165], v30 offset:0
    ds_read_b64_tr_b16 a[166:167], v30 offset:1024
    ds_read_b64_tr_b16 a[168:169], v29 offset:2048
    ds_read_b64_tr_b16 a[170:171], v29 offset:3072
    ds_read_b64_tr_b16 a[172:173], v30 offset:2048
    ds_read_b64_tr_b16 a[174:175], v30 offset:3072
    ds_read_b64_tr_b16 a[176:177], v29 offset:4096
    ds_read_b64_tr_b16 a[178:179], v29 offset:5120
    ds_read_b64_tr_b16 a[180:181], v30 offset:4096
    ds_read_b64_tr_b16 a[182:183], v30 offset:5120
    ds_read_b64_tr_b16 a[184:185], v29 offset:6144
    ds_read_b64_tr_b16 a[186:187], v29 offset:7168
    ds_read_b64_tr_b16 a[188:189], v30 offset:6144
    ds_read_b64_tr_b16 a[190:191], v30 offset:7168
    s_branch L_sn_done
L_sn_5:
    s_cmp_ge_u32 s59, 7
    s_cbranch_scc1 L_sn_7
    s_cmp_ge_u32 s59, 6
    s_cbranch_scc1 L_sn_6
    ds_read_b64_tr_b16 a[192:193], v29 offset:0
    ds_read_b64_tr_b16 a[194:195], v29 offset:1024
    ds_read_b64_tr_b16 a[196:197], v30 offset:0
    ds_read_b64_tr_b16 a[198:199], v30 offset:1024
    ds_read_b64_tr_b16 a[200:201], v29 offset:2048
    ds_read_b64_tr_b16 a[202:203], v29 offset:3072
    ds_read_b64_tr_b16 a[204:205], v30 offset:2048
    ds_read_b64_tr_b16 a[206:207], v30 offset:3072
    ds_read_b64_tr_b16 a[208:209], v29 offset:4096
    ds_read_b64_tr_b16 a[210:211], v29 offset:5120
    ds_read_b64_tr_b16 a[212:213], v30 offset:4096
    ds_read_b64_tr_b16 a[214:215], v30 offset:5120
    ds_read_b64_tr_b16 a[216:217], v29 offset:6144
    ds_read_b64_tr_b16 a[218:219], v29 offset:7168
    ds_read_b64_tr_b16 a[220:221], v30 offset:6144
    ds_read_b64_tr_b16 a[222:223], v30 offset:7168
    s_branch L_sn_done
L_sn_6:
    ds_read_b64_tr_b16 a[224:225], v29 offset:0
    ds_read_b64_tr_b16 a[226:227], v29 offset:1024
    ds_read_b64_tr_b16 a[228:229], v30 offset:0
    ds_read_b64_tr_b16 a[230:231], v30 offset:1024
    ds_read_b64_tr_b16 a[232:233], v29 offset:2048
    ds_read_b64_tr_b16 a[234:235], v29 offset:3072
    ds_read_b64_tr_b16 a[236:237], v30 offset:2048
    ds_read_b64_tr_b16 a[238:239], v30 offset:3072
    ds_read_b64_tr_b16 a[240:241], v29 offset:4096
    ds_read_b64_tr_b16 a[242:243], v29 offset:5120
    ds_read_b64_tr_b16 a[244:245], v30 offset:4096
    ds_read_b64_tr_b16 a[246:247], v30 offset:5120
    ds_read_b64_tr_b16 a[248:249], v29 offset:6144
    ds_read_b64_tr_b16 a[250:251], v29 offset:7168
    ds_read_b64_tr_b16 a[252:253], v30 offset:6144
    ds_read_b64_tr_b16 a[254:255], v30 offset:7168
    s_branch L_sn_done
L_sn_7:
    s_cmp_ge_u32 s59, 8
    s_cbranch_scc1 L_sn_8
    ds_read_b64_tr_b16 v[192:193], v29 offset:0
    ds_read_b64_tr_b16 v[194:195], v29 offset:1024
    ds_read_b64_tr_b16 v[196:197], v30 offset:0
    ds_read_b64_tr_b16 v[198:199], v30 offset:1024
    ds_read_b64_tr_b16 v[200:201], v29 offset:2048
    ds_read_b64_tr_b16 v[202:203], v29 offset:3072
    ds_read_b64_tr_b16 v[204:205], v30 offset:2048
    ds_read_b64_tr_b16 v[206:207], v30 offset:3072
    ds_read_b64_tr_b16 v[208:209], v29 offset:4096
    ds_read_b64_tr_b16 v[210:211], v29 offset:5120
    ds_read_b64_tr_b16 v[212:213], v30 offset:4096
    ds_read_b64_tr_b16 v[214:215], v30 offset:5120
    ds_read_b64_tr_b16 v[216:217], v29 offset:6144
    ds_read_b64_tr_b16 v[218:219], v29 offset:7168
    ds_read_b64_tr_b16 v[220:221], v30 offset:6144
    ds_read_b64_tr_b16 v[222:223], v30 offset:7168
    s_branch L_sn_done
L_sn_8:
    ds_read_b64_tr_b16 v[224:225], v29 offset:0
    ds_read_b64_tr_b16 v[226:227], v29 offset:1024
    ds_read_b64_tr_b16 v[228:229], v30 offset:0
    ds_read_b64_tr_b16 v[230:231], v30 offset:1024
    ds_read_b64_tr_b16 v[232:233], v29 offset:2048
    ds_read_b64_tr_b16 v[234:235], v29 offset:3072
    ds_read_b64_tr_b16 v[236:237], v30 offset:2048
    ds_read_b64_tr_b16 v[238:239], v30 offset:3072
    ds_read_b64_tr_b16 v[240:241], v29 offset:4096
    ds_read_b64_tr_b16 v[242:243], v29 offset:5120
    ds_read_b64_tr_b16 v[244:245], v30 offset:4096
    ds_read_b64_tr_b16 v[246:247], v30 offset:5120
    ds_read_b64_tr_b16 v[248:249], v29 offset:6144
    ds_read_b64_tr_b16 v[250:251], v29 offset:7168
    ds_read_b64_tr_b16 v[252:253], v30 offset:6144
    ds_read_b64_tr_b16 v[254:255], v30 offset:7168
    s_branch L_sn_done
L_sn_done:
    s_add_u32 s59, s59, 1
    s_cmp_eq_u32 s59, 9
    s_cselect_b32 s62, 64, 3
    s_cmp_eq_u32 s46, 13
    s_cselect_b32 s62, 4, s62
    s_waitcnt lgkmcnt(0)
    s_mul_i32 s38, s95, 81920
    s_add_u32 s95, s95, 1
    s_and_b32 s95, s95, 15
    s_add_u32 s38, s38, s53
    s_add_u32 m0, s44, 0
    s_add_u32 s39, s38, 0
    buffer_load_dwordx4 v12, s[20:23], s39 offen offset:0 sc1 lds
    buffer_load_dwordx4 v13, s[20:23], s39 offen offset:1024 sc1 lds
    buffer_load_dwordx4 v14, s[20:23], s39 offen offset:2048 sc1 lds
    buffer_load_dwordx4 v15, s[20:23], s39 offen offset:3072 sc1 lds
    s_add_u32 m0, s44, 4096
    s_add_u32 s39, s38, 40960
    buffer_load_dwordx4 v12, s[20:23], s39 offen offset:0 sc1 lds
    buffer_load_dwordx4 v13, s[20:23], s39 offen offset:1024 sc1 lds
    buffer_load_dwordx4 v14, s[20:23], s39 offen offset:2048 sc1 lds
    buffer_load_dwordx4 v15, s[20:23], s39 offen offset:3072 sc1 lds
    s_branch L_snip_ret
L_rare_b:
    s_nop 7
    v_mov_b32 v2, v10
    s_nop 1
    v_permlane32_swap_b32 v2, v10
    s_nop 1
    v_max_f32 v11, v2, v10
    v_max_f32 v11, s50, v11
    v_sub_f32 v64, v64, v11
    v_sub_f32 v65, v65, v11
    v_sub_f32 v66, v66, v11
    v_sub_f32 v67, v67, v11
    v_sub_f32 v68, v68, v11
    v_sub_f32 v69, v69, v11
    v_sub_f32 v70, v70, v11
    v_sub_f32 v71, v71, v11
    v_sub_f32 v72, v72, v11
    v_sub_f32 v73, v73, v11
    v_sub_f32 v74, v74, v11
    v_sub_f32 v75, v75, v11
    v_sub_f32 v76, v76, v11
    v_sub_f32 v77, v77, v11
    v_sub_f32 v78, v78, v11
    v_sub_f32 v79, v79, v11
    v_sub_f32 v32, v32, v11
    v_sub_f32 v33, v33, v11
    v_sub_f32 v34, v34, v11
    v_sub_f32 v35, v35, v11
    v_sub_f32 v36, v36, v11
    v_sub_f32 v37, v37, v11
    v_sub_f32 v38, v38, v11
    v_sub_f32 v39, v39, v11
    v_sub_f32 v40, v40, v11
    v_sub_f32 v41, v41, v11
    v_sub_f32 v42, v42, v11
    v_sub_f32 v43, v43, v11
    v_sub_f32 v44, v44, v11
    v_sub_f32 v45, v45, v11
    v_sub_f32 v46, v46, v11
    v_sub_f32 v47, v47, v11
    s_cmp_lg_u32 s50, 0
    s_mov_b32 s49, 0x41000000
    s_mov_b32 s50, 0
    s_cbranch_scc1 L_back_b
    v_sub_f32 v2, 0, v11
    v_exp_f32 v2, v2
    s_nop 0
    v_mul_f32 v6, v6, v2
    v_mul_f32 v7, v7, v2
    v_mul_f32 v8, v8, v2
    v_mul_f32 v9, v9, v2
    v_accvgpr_read_b32 v88, a0
    v_accvgpr_read_b32 v89, a1
    v_accvgpr_read_b32 v90, a2
    v_accvgpr_read_b32 v91, a3
    v_mul_f32 v88, v88, v2
    v_mul_f32 v89, v89, v2
    v_mul_f32 v90, v90, v2
    v_mul_f32 v91, v91, v2
    v_accvgpr_write_b32 a0, v88
    v_accvgpr_write_b32 a1, v89
    v_accvgpr_write_b32 a2, v90
    v_accvgpr_write_b32 a3, v91
    v_accvgpr_read_b32 v88, a4
    v_accvgpr_read_b32 v89, a5
    v_accvgpr_read_b32 v90, a6
    v_accvgpr_read_b32 v91, a7
    v_mul_f32 v88, v88, v2
    v_mul_f32 v89, v89, v2
    v_mul_f32 v90, v90, v2
    v_mul_f32 v91, v91, v2
    v_accvgpr_write_b32 a4, v88
    v_accvgpr_write_b32 a5, v89
    v_accvgpr_write_b32 a6, v90
    v_accvgpr_write_b32 a7, v91
    v_accvgpr_read_b32 v88, a8
    v_accvgpr_read_b32 v89, a9
    v_accvgpr_read_b32 v90, a10
    v_accvgpr_read_b32 v91, a11
    v_mul_f32 v88, v88, v2
    v_mul_f32 v89, v89, v2
    v_mul_f32 v90, v90, v2
    v_mul_f32 v91, v91, v2
    v_accvgpr_write_b32 a8, v88
    v_accvgpr_write_b32 a9, v89
    v_accvgpr_write_b32 a10, v90
    v_accvgpr_write_b32 a11, v91
    v_accvgpr_read_b32 v88, a12
    v_accvgpr_read_b32 v89, a13
    v_accvgpr_read_b32 v90, a14
    v_accvgpr_read_b32 v91, a15
    v_mul_f32 v88, v88, v2
    v_mul_f32 v89, v89, v2
    v_mul_f32 v90, v90, v2
    v_mul_f32 v91, v91, v2
    v_accvgpr_write_b32 a12, v88
    v_accvgpr_write_b32 a13, v89
    v_accvgpr_write_b32 a14, v90
    v_accvgpr_write_b32 a15, v91
    v_accvgpr_read_b32 v88, a16
    v_accvgpr_read_b32 v89, a17
    v_accvgpr_read_b32 v90, a18
    v_accvgpr_read_b32 v91, a19
    v_mul_f32 v88, v88, v2
    v_mul_f32 v89, v89, v2
    v_mul_f32 v90, v90, v2
    v_mul_f32 v91, v91, v2
    v_accvgpr_write_b32 a16, v88
    v_accvgpr_write_b32 a17, v89
    v_accvgpr_write_b32 a18, v90
    v_accvgpr_write_b32 a19, v91
    v_accvgpr_read_b32 v88, a20
    v_accvgpr_read_b32 v89, a21
    v_accvgpr_read_b32 v90, a22
    v_accvgpr_read_b32 v91, a23
    v_mul_f32 v88, v88, v2
    v_mul_f32 v89, v89, v2
    v_mul_f32 v90, v90, v2
    v_mul_f32 v91, v91, v2
    v_accvgpr_write_b32 a20, v88
    v_accvgpr_write_b32 a21, v89
    v_accvgpr_write_b32 a22, v90
    v_accvgpr_write_b32 a23, v91
    v_accvgpr_read_b32 v88, a24
    v_accvgpr_read_b32 v89, a25
    v_accvgpr_read_b32 v90, a26
    v_accvgpr_read_b32 v91, a27
    v_mul_f32 v88, v88, v2
    v_mul_f32 v89, v89, v2
    v_mul_f32 v90, v90, v2
    v_mul_f32 v91, v91, v2
    v_accvgpr_write_b32 a24, v88
    v_accvgpr_write_b32 a25, v89
    v_accvgpr_write_b32 a26, v90
    v_accvgpr_write_b32 a27, v91
    v_accvgpr_read_b32 v88, a28
    v_accvgpr_read_b32 v89, a29
    v_accvgpr_read_b32 v90, a30
    v_accvgpr_read_b32 v91, a31
    v_mul_f32 v88, v88, v2
    v_mul_f32 v89, v89, v2
    v_mul_f32 v90, v90, v2
    v_mul_f32 v91, v91, v2
    v_accvgpr_write_b32 a28, v88
    v_accvgpr_write_b32 a29, v89
    v_accvgpr_write_b32 a30, v90
    v_accvgpr_write_b32 a31, v91
    v_accvgpr_read_b32 v88, a32
    v_accvgpr_read_b32 v89, a33
    v_accvgpr_read_b32 v90, a34
    v_accvgpr_read_b32 v91, a35
    v_mul_f32 v88, v88, v2
    v_mul_f32 v89, v89, v2
    v_mul_f32 v90, v90, v2
    v_mul_f32 v91, v91, v2
    v_accvgpr_write_b32 a32, v88
    v_accvgpr_write_b32 a33, v89
    v_accvgpr_write_b32 a34, v90
    v_accvgpr_write_b32 a35, v91
    v_accvgpr_read_b32 v88, a36
    v_accvgpr_read_b32 v89, a37
    v_accvgpr_read_b32 v90, a38
    v_accvgpr_read_b32 v91, a39
    v_mul_f32 v88, v88, v2
    v_mul_f32 v89, v89, v2
    v_mul_f32 v90, v90, v2
    v_mul_f32 v91, v91, v2
    v_accvgpr_write_b32 a36, v88
    v_accvgpr_write_b32 a37, v89
    v_accvgpr_write_b32 a38, v90
    v_accvgpr_write_b32 a39, v91
    v_accvgpr_read_b32 v88, a40
    v_accvgpr_read_b32 v89, a41
    v_accvgpr_read_b32 v90, a42
    v_accvgpr_read_b32 v91, a43
    v_mul_f32 v88, v88, v2
    v_mul_f32 v89, v89, v2
    v_mul_f32 v90, v90, v2
    v_mul_f32 v91, v91, v2
    v_accvgpr_write_b32 a40, v88
    v_accvgpr_write_b32 a41, v89
    v_accvgpr_write_b32 a42, v90
    v_accvgpr_write_b32 a43, v91
    v_accvgpr_read_b32 v88, a44
    v_accvgpr_read_b32 v89, a45
    v_accvgpr_read_b32 v90, a46
    v_accvgpr_read_b32 v91, a47
    v_mul_f32 v88, v88, v2
    v_mul_f32 v89, v89, v2
    v_mul_f32 v90, v90, v2
    v_mul_f32 v91, v91, v2
    v_accvgpr_write_b32 a44, v88
    v_accvgpr_write_b32 a45, v89
    v_accvgpr_write_b32 a46, v90
    v_accvgpr_write_b32 a47, v91
    v_accvgpr_read_b32 v88, a48
    v_accvgpr_read_b32 v89, a49
    v_accvgpr_read_b32 v90, a50
    v_accvgpr_read_b32 v91, a51
    v_mul_f32 v88, v88, v2
    v_mul_f32 v89, v89, v2
    v_mul_f32 v90, v90, v2
    v_mul_f32 v91, v91, v2
    v_accvgpr_write_b32 a48, v88
    v_accvgpr_write_b32 a49, v89
    v_accvgpr_write_b32 a50, v90
    v_accvgpr_write_b32 a51, v91
    v_accvgpr_read_b32 v88, a52
    v_accvgpr_read_b32 v89, a53
    v_accvgpr_read_b32 v90, a54
    v_accvgpr_read_b32 v91, a55
    v_mul_f32 v88, v88, v2
    v_mul_f32 v89, v89, v2
    v_mul_f32 v90, v90, v2
    v_mul_f32 v91, v91, v2
    v_accvgpr_write_b32 a52, v88
    v_accvgpr_write_b32 a53, v89
    v_accvgpr_write_b32 a54, v90
    v_accvgpr_write_b32 a55, v91
    v_accvgpr_read_b32 v88, a56
    v_accvgpr_read_b32 v89, a57
    v_accvgpr_read_b32 v90, a58
    v_accvgpr_read_b32 v91, a59
    v_mul_f32 v88, v88, v2
    v_mul_f32 v89, v89, v2
    v_mul_f32 v90, v90, v2
    v_mul_f32 v91, v91, v2
    v_accvgpr_write_b32 a56, v88
    v_accvgpr_write_b32 a57, v89
    v_accvgpr_write_b32 a58, v90
    v_accvgpr_write_b32 a59, v91
    v_accvgpr_read_b32 v88, a60
    v_accvgpr_read_b32 v89, a61
    v_accvgpr_read_b32 v90, a62
    v_accvgpr_read_b32 v91, a63
    v_mul_f32 v88, v88, v2
    v_mul_f32 v89, v89, v2
    v_mul_f32 v90, v90, v2
    v_mul_f32 v91, v91, v2
    v_accvgpr_write_b32 a60, v88
    v_accvgpr_write_b32 a61, v89
    v_accvgpr_write_b32 a62, v90
    v_accvgpr_write_b32 a63, v91
    s_nop 1
    s_branch L_back_b
L_switch:
    v_mov_b32 v112, v224
    v_mov_b32 v113, v225
    v_mov_b32 v114, v226
    v_mov_b32 v115, v227
    v_mov_b32 v116, v228
    v_mov_b32 v117, v229
    v_mov_b32 v118, v230
    v_mov_b32 v119, v231
    v_mov_b32 v120, v232
    v_mov_b32 v121, v233
    v_mov_b32 v122, v234
    v_mov_b32 v123, v235
    v_mov_b32 v124, v236
    v_mov_b32 v125, v237
    v_mov_b32 v126, v238
    v_mov_b32 v127, v239
    v_mov_b32 v96, v192
    v_mov_b32 v97, v193
    v_mov_b32 v98, v194
    v_mov_b32 v99, v195
    v_mov_b32 v100, v196
    v_mov_b32 v101, v197
    v_mov_b32 v102, v198
    v_mov_b32 v103, v199
    v_mov_b32 v104, v200
    v_mov_b32 v105, v201
    v_mov_b32 v106, v202
    v_mov_b32 v107, v203
    v_mov_b32 v108, v204
    v_mov_b32 v109, v205
    v_mov_b32 v110, v206
    v_mov_b32 v111, v207
    v_mov_b32 v32, 0
    v_mov_b32 v33, 0
    v_mov_b32 v34, 0
    v_mov_b32 v35, 0
    v_mov_b32 v36, 0
    v_mov_b32 v37, 0
    v_mov_b32 v38, 0
    v_mov_b32 v39, 0
    v_mov_b32 v40, 0
    v_mov_b32 v41, 0
    v_mov_b32 v42, 0
    v_mov_b32 v43, 0
    v_mov_b32 v44, 0
    v_mov_b32 v45, 0
    v_mov_b32 v46, 0
    v_mov_b32 v47, 0
    s_nop 1
    s_branch L_back_sw
L_epi1:
    v_add_f32 v6, v6, v7
    v_add_f32 v8, v8, v9
    v_add_f32 v6, v6, v8
    v_mov_b32 v2, v6
    s_nop 1
    v_permlane32_swap_b32 v2, v6
    s_nop 1
    v_add_f32 v6, v6, v2
    v_rcp_f32 v2, v6
    s_nop 4
    v_accvgpr_read_b32 v160, a0
    v_accvgpr_read_b32 v161, a1
    v_accvgpr_read_b32 v162, a2
    v_accvgpr_read_b32 v163, a3
    v_accvgpr_read_b32 v164, a4
    v_accvgpr_read_b32 v165, a5
    v_accvgpr_read_b32 v166, a6
    v_accvgpr_read_b32 v167, a7
    v_pk_mul_f32 v[160:161], v[160:161], v[2:3] op_sel_hi:[1,0]
    v_pk_mul_f32 v[162:163], v[162:163], v[2:3] op_sel_hi:[1,0]
    v_pk_mul_f32 v[164:165], v[164:165], v[2:3] op_sel_hi:[1,0]
    v_pk_mul_f32 v[166:167], v[166:167], v[2:3] op_sel_hi:[1,0]
    v_cvt_pk_bf16_f32 v88, v160, v161
    v_cvt_pk_bf16_f32 v89, v162, v163
    v_cvt_pk_bf16_f32 v90, v164, v165
    v_cvt_pk_bf16_f32 v91, v166, v167
    buffer_store_dwordx4 v[88:91], v28, s[28:31], s52 offen offset:0 sc1
    v_accvgpr_read_b32 v168, a8
    v_accvgpr_read_b32 v169, a9
    v_accvgpr_read_b32 v170, a10
    v_accvgpr_read_b32 v171, a11
    v_accvgpr_read_b32 v172, a12
    v_accvgpr_read_b32 v173, a13
    v_accvgpr_read_b32 v174, a14
    v_accvgpr_read_b32 v175, a15
    v_pk_mul_f32 v[168:169], v[168:169], v[2:3] op_sel_hi:[1,0]
    v_pk_mul_f32 v[170:171], v[170:171], v[2:3] op_sel_hi:[1,0]
    v_pk_mul_f32 v[172:173], v[172:173], v[2:3] op_sel_hi:[1,0]
    v_pk_mul_f32 v[174:175], v[174:175], v[2:3] op_sel_hi:[1,0]
    v_cvt_pk_bf16_f32 v92, v168, v169
    v_cvt_pk_bf16_f32 v93, v170, v171
    v_cvt_pk_bf16_f32 v94, v172, v173
    v_cvt_pk_bf16_f32 v95, v174, v175
    buffer_store_dwordx4 v[92:95], v28, s[28:31], s52 offen offset:1024 sc1
    v_accvgpr_read_b32 v176, a16
    v_accvgpr_read_b32 v177, a17
    v_accvgpr_read_b32 v178, a18
    v_accvgpr_read_b32 v179, a19
    v_accvgpr_read_b32 v180, a20
    v_accvgpr_read_b32 v181, a21
    v_accvgpr_read_b32 v182, a22
    v_accvgpr_read_b32 v183, a23
    v_pk_mul_f32 v[176:177], v[176:177], v[2:3] op_sel_hi:[1,0]
    v_pk_mul_f32 v[178:179], v[178:179], v[2:3] op_sel_hi:[1,0]
    v_pk_mul_f32 v[180:181], v[180:181], v[2:3] op_sel_hi:[1,0]
    v_pk_mul_f32 v[182:183], v[182:183], v[2:3] op_sel_hi:[1,0]
    v_cvt_pk_bf16_f32 v88, v176, v177
    v_cvt_pk_bf16_f32 v89, v178, v179
    v_cvt_pk_bf16_f32 v90, v180, v181
    v_cvt_pk_bf16_f32 v91, v182, v183
    buffer_store_dwordx4 v[88:91], v28, s[28:31], s52 offen offset:2048 sc1
    v_accvgpr_read_b32 v184, a24
    v_accvgpr_read_b32 v185, a25
    v_accvgpr_read_b32 v186, a26
    v_accvgpr_read_b32 v187, a27
    v_accvgpr_read_b32 v188, a28
    v_accvgpr_read_b32 v189, a29
    v_accvgpr_read_b32 v190, a30
    v_accvgpr_read_b32 v191, a31
    v_pk_mul_f32 v[184:185], v[184:185], v[2:3] op_sel_hi:[1,0]
    v_pk_mul_f32 v[186:187], v[186:187], v[2:3] op_sel_hi:[1,0]
    v_pk_mul_f32 v[188:189], v[188:189], v[2:3] op_sel_hi:[1,0]
    v_pk_mul_f32 v[190:191], v[190:191], v[2:3] op_sel_hi:[1,0]
    v_cvt_pk_bf16_f32 v92, v184, v185
    v_cvt_pk_bf16_f32 v93, v186, v187
    v_cvt_pk_bf16_f32 v94, v188, v189
    v_cvt_pk_bf16_f32 v95, v190, v191
    buffer_store_dwordx4 v[92:95], v28, s[28:31], s52 offen offset:3072 sc1
    v_accvgpr_read_b32 v160, a32
    v_accvgpr_read_b32 v161, a33
    v_accvgpr_read_b32 v162, a34
    v_accvgpr_read_b32 v163, a35
    v_accvgpr_read_b32 v164, a36
    v_accvgpr_read_b32 v165, a37
    v_accvgpr_read_b32 v166, a38
    v_accvgpr_read_b32 v167, a39
    v_pk_mul_f32 v[160:161], v[160:161], v[2:3] op_sel_hi:[1,0]
    v_pk_mul_f32 v[162:163], v[162:163], v[2:3] op_sel_hi:[1,0]
    v_pk_mul_f32 v[164:165], v[164:165], v[2:3] op_sel_hi:[1,0]
    v_pk_mul_f32 v[166:167], v[166:167], v[2:3] op_sel_hi:[1,0]
    v_cvt_pk_bf16_f32 v88, v160, v161
    v_cvt_pk_bf16_f32 v89, v162, v163
    v_cvt_pk_bf16_f32 v90, v164, v165
    v_cvt_pk_bf16_f32 v91, v166, v167
    s_add_u32 s52, s52, 4096
    buffer_store_dwordx4 v[88:91], v28, s[28:31], s52 offen offset:0 sc1
    v_accvgpr_read_b32 v168, a40
    v_accvgpr_read_b32 v169, a41
    v_accvgpr_read_b32 v170, a42
    v_accvgpr_read_b32 v171, a43
    v_accvgpr_read_b32 v172, a44
    v_accvgpr_read_b32 v173, a45
    v_accvgpr_read_b32 v174, a46
    v_accvgpr_read_b32 v175, a47
    v_pk_mul_f32 v[168:169], v[168:169], v[2:3] op_sel_hi:[1,0]
    v_pk_mul_f32 v[170:171], v[170:171], v[2:3] op_sel_hi:[1,0]
    v_pk_mul_f32 v[172:173], v[172:173], v[2:3] op_sel_hi:[1,0]
    v_pk_mul_f32 v[174:175], v[174:175], v[2:3] op_sel_hi:[1,0]
    v_cvt_pk_bf16_f32 v92, v168, v169
    v_cvt_pk_bf16_f32 v93, v170, v171
    v_cvt_pk_bf16_f32 v94, v172, v173
    v_cvt_pk_bf16_f32 v95, v174, v175
    buffer_store_dwordx4 v[92:95], v28, s[28:31], s52 offen offset:1024 sc1
    v_accvgpr_read_b32 v176, a48
    v_accvgpr_read_b32 v177, a49
    v_accvgpr_read_b32 v178, a50
    v_accvgpr_read_b32 v179, a51
    v_accvgpr_read_b32 v180, a52
    v_accvgpr_read_b32 v181, a53
    v_accvgpr_read_b32 v182, a54
    v_accvgpr_read_b32 v183, a55
    v_pk_mul_f32 v[176:177], v[176:177], v[2:3] op_sel_hi:[1,0]
    v_pk_mul_f32 v[178:179], v[178:179], v[2:3] op_sel_hi:[1,0]
    v_pk_mul_f32 v[180:181], v[180:181], v[2:3] op_sel_hi:[1,0]
    v_pk_mul_f32 v[182:183], v[182:183], v[2:3] op_sel_hi:[1,0]
    v_cvt_pk_bf16_f32 v88, v176, v177
    v_cvt_pk_bf16_f32 v89, v178, v179
    v_cvt_pk_bf16_f32 v90, v180, v181
    v_cvt_pk_bf16_f32 v91, v182, v183
    buffer_store_dwordx4 v[88:91], v28, s[28:31], s52 offen offset:2048 sc1
    v_accvgpr_read_b32 v184, a56
    v_accvgpr_read_b32 v185, a57
    v_accvgpr_read_b32 v186, a58
    v_accvgpr_read_b32 v187, a59
    v_accvgpr_read_b32 v188, a60
    v_accvgpr_read_b32 v189, a61
    v_accvgpr_read_b32 v190, a62
    v_accvgpr_read_b32 v191, a63
    v_pk_mul_f32 v[184:185], v[184:185], v[2:3] op_sel_hi:[1,0]
    v_pk_mul_f32 v[186:187], v[186:187], v[2:3] op_sel_hi:[1,0]
    v_pk_mul_f32 v[188:189], v[188:189], v[2:3] op_sel_hi:[1,0]
    v_pk_mul_f32 v[190:191], v[190:191], v[2:3] op_sel_hi:[1,0]
    v_cvt_pk_bf16_f32 v92, v184, v185
    v_cvt_pk_bf16_f32 v93, v186, v187
    v_cvt_pk_bf16_f32 v94, v188, v189
    v_cvt_pk_bf16_f32 v95, v190, v191
    buffer_store_dwordx4 v[92:95], v28, s[28:31], s52 offen offset:3072 sc1
    s_add_u32 s52, s52, 3141632
    v_mfma_f32_32x32x16_bf16 a[0:15], v[32:35], v[32:35], 0
    v_mfma_f32_32x32x16_bf16 a[16:31], v[32:35], v[32:35], 0
    v_mfma_f32_32x32x16_bf16 a[32:47], v[32:35], v[32:35], 0
    v_mfma_f32_32x32x16_bf16 a[48:63], v[32:35], v[32:35], 0
    v_mov_b32 v6, 0
    v_mov_b32 v7, 0
    v_mov_b32 v8, 0
    v_mov_b32 v9, 0
    s_mov_b32 s50, 0xff800000
    s_branch L_rare_a
L_rare_l:
    s_nop 7
    v_mov_b32 v2, v10
    s_nop 1
    v_permlane32_swap_b32 v2, v10
    s_nop 1
    v_max_f32 v11, v2, v10
    v_max_f32 v11, s50, v11
    v_sub_f32 v64, v64, v11
    v_sub_f32 v65, v65, v11
    v_sub_f32 v66, v66, v11
    v_sub_f32 v67, v67, v11
    v_sub_f32 v68, v68, v11
    v_sub_f32 v69, v69, v11
    v_sub_f32 v70, v70, v11
    v_sub_f32 v71, v71, v11
    v_sub_f32 v72, v72, v11
    v_sub_f32 v73, v73, v11
    v_sub_f32 v74, v74, v11
    v_sub_f32 v75, v75, v11
    v_sub_f32 v76, v76, v11
    v_sub_f32 v77, v77, v11
    v_sub_f32 v78, v78, v11
    v_sub_f32 v79, v79, v11
    v_sub_f32 v32, v32, v11
    v_sub_f32 v33, v33, v11
    v_sub_f32 v34, v34, v11
    v_sub_f32 v35, v35, v11
    v_sub_f32 v36, v36, v11
    v_sub_f32 v37, v37, v11
    v_sub_f32 v38, v38, v11
    v_sub_f32 v39, v39, v11
    v_sub_f32 v40, v40, v11
    v_sub_f32 v41, v41, v11
    v_sub_f32 v42, v42, v11
    v_sub_f32 v43, v43, v11
    v_sub_f32 v44, v44, v11
    v_sub_f32 v45, v45, v11
    v_sub_f32 v46, v46, v11
    v_sub_f32 v47, v47, v11
    s_cmp_lg_u32 s50, 0
    s_mov_b32 s49, 0x41000000
    s_mov_b32 s50, 0
    s_cbranch_scc1 L_back_l
    v_sub_f32 v2, 0, v11
    v_exp_f32 v2, v2
    s_nop 0
    v_mul_f32 v6, v6, v2
    v_mul_f32 v7, v7, v2
    v_mul_f32 v8, v8, v2
    v_mul_f32 v9, v9, v2
    v_accvgpr_read_b32 v88, a0
    v_accvgpr_read_b32 v89, a1
    v_accvgpr_read_b32 v90, a2
    v_accvgpr_read_b32 v91, a3
    v_mul_f32 v88, v88, v2
    v_mul_f32 v89, v89, v2
    v_mul_f32 v90, v90, v2
    v_mul_f32 v91, v91, v2
    v_accvgpr_write_b32 a0, v88
    v_accvgpr_write_b32 a1, v89
    v_accvgpr_write_b32 a2, v90
    v_accvgpr_write_b32 a3, v91
    v_accvgpr_read_b32 v88, a4
    v_accvgpr_read_b32 v89, a5
    v_accvgpr_read_b32 v90, a6
    v_accvgpr_read_b32 v91, a7
    v_mul_f32 v88, v88, v2
    v_mul_f32 v89, v89, v2
    v_mul_f32 v90, v90, v2
    v_mul_f32 v91, v91, v2
    v_accvgpr_write_b32 a4, v88
    v_accvgpr_write_b32 a5, v89
    v_accvgpr_write_b32 a6, v90
    v_accvgpr_write_b32 a7, v91
    v_accvgpr_read_b32 v88, a8
    v_accvgpr_read_b32 v89, a9
    v_accvgpr_read_b32 v90, a10
    v_accvgpr_read_b32 v91, a11
    v_mul_f32 v88, v88, v2
    v_mul_f32 v89, v89, v2
    v_mul_f32 v90, v90, v2
    v_mul_f32 v91, v91, v2
    v_accvgpr_write_b32 a8, v88
    v_accvgpr_write_b32 a9, v89
    v_accvgpr_write_b32 a10, v90
    v_accvgpr_write_b32 a11, v91
    v_accvgpr_read_b32 v88, a12
    v_accvgpr_read_b32 v89, a13
    v_accvgpr_read_b32 v90, a14
    v_accvgpr_read_b32 v91, a15
    v_mul_f32 v88, v88, v2
    v_mul_f32 v89, v89, v2
    v_mul_f32 v90, v90, v2
    v_mul_f32 v91, v91, v2
    v_accvgpr_write_b32 a12, v88
    v_accvgpr_write_b32 a13, v89
    v_accvgpr_write_b32 a14, v90
    v_accvgpr_write_b32 a15, v91
    v_accvgpr_read_b32 v88, a16
    v_accvgpr_read_b32 v89, a17
    v_accvgpr_read_b32 v90, a18
    v_accvgpr_read_b32 v91, a19
    v_mul_f32 v88, v88, v2
    v_mul_f32 v89, v89, v2
    v_mul_f32 v90, v90, v2
    v_mul_f32 v91, v91, v2
    v_accvgpr_write_b32 a16, v88
    v_accvgpr_write_b32 a17, v89
    v_accvgpr_write_b32 a18, v90
    v_accvgpr_write_b32 a19, v91
    v_accvgpr_read_b32 v88, a20
    v_accvgpr_read_b32 v89, a21
    v_accvgpr_read_b32 v90, a22
    v_accvgpr_read_b32 v91, a23
    v_mul_f32 v88, v88, v2
    v_mul_f32 v89, v89, v2
    v_mul_f32 v90, v90, v2
    v_mul_f32 v91, v91, v2
    v_accvgpr_write_b32 a20, v88
    v_accvgpr_write_b32 a21, v89
    v_accvgpr_write_b32 a22, v90
    v_accvgpr_write_b32 a23, v91
    v_accvgpr_read_b32 v88, a24
    v_accvgpr_read_b32 v89, a25
    v_accvgpr_read_b32 v90, a26
    v_accvgpr_read_b32 v91, a27
    v_mul_f32 v88, v88, v2
    v_mul_f32 v89, v89, v2
    v_mul_f32 v90, v90, v2
    v_mul_f32 v91, v91, v2
    v_accvgpr_write_b32 a24, v88
    v_accvgpr_write_b32 a25, v89
    v_accvgpr_write_b32 a26, v90
    v_accvgpr_write_b32 a27, v91
    v_accvgpr_read_b32 v88, a28
    v_accvgpr_read_b32 v89, a29
    v_accvgpr_read_b32 v90, a30
    v_accvgpr_read_b32 v91, a31
    v_mul_f32 v88, v88, v2
    v_mul_f32 v89, v89, v2
    v_mul_f32 v90, v90, v2
    v_mul_f32 v91, v91, v2
    v_accvgpr_write_b32 a28, v88
    v_accvgpr_write_b32 a29, v89
    v_accvgpr_write_b32 a30, v90
    v_accvgpr_write_b32 a31, v91
    v_accvgpr_read_b32 v88, a32
    v_accvgpr_read_b32 v89, a33
    v_accvgpr_read_b32 v90, a34
    v_accvgpr_read_b32 v91, a35
    v_mul_f32 v88, v88, v2
    v_mul_f32 v89, v89, v2
    v_mul_f32 v90, v90, v2
    v_mul_f32 v91, v91, v2
    v_accvgpr_write_b32 a32, v88
    v_accvgpr_write_b32 a33, v89
    v_accvgpr_write_b32 a34, v90
    v_accvgpr_write_b32 a35, v91
    v_accvgpr_read_b32 v88, a36
    v_accvgpr_read_b32 v89, a37
    v_accvgpr_read_b32 v90, a38
    v_accvgpr_read_b32 v91, a39
    v_mul_f32 v88, v88, v2
    v_mul_f32 v89, v89, v2
    v_mul_f32 v90, v90, v2
    v_mul_f32 v91, v91, v2
    v_accvgpr_write_b32 a36, v88
    v_accvgpr_write_b32 a37, v89
    v_accvgpr_write_b32 a38, v90
    v_accvgpr_write_b32 a39, v91
    v_accvgpr_read_b32 v88, a40
    v_accvgpr_read_b32 v89, a41
    v_accvgpr_read_b32 v90, a42
    v_accvgpr_read_b32 v91, a43
    v_mul_f32 v88, v88, v2
    v_mul_f32 v89, v89, v2
    v_mul_f32 v90, v90, v2
    v_mul_f32 v91, v91, v2
    v_accvgpr_write_b32 a40, v88
    v_accvgpr_write_b32 a41, v89
    v_accvgpr_write_b32 a42, v90
    v_accvgpr_write_b32 a43, v91
    v_accvgpr_read_b32 v88, a44
    v_accvgpr_read_b32 v89, a45
    v_accvgpr_read_b32 v90, a46
    v_accvgpr_read_b32 v91, a47
    v_mul_f32 v88, v88, v2
    v_mul_f32 v89, v89, v2
    v_mul_f32 v90, v90, v2
    v_mul_f32 v91, v91, v2
    v_accvgpr_write_b32 a44, v88
    v_accvgpr_write_b32 a45, v89
    v_accvgpr_write_b32 a46, v90
    v_accvgpr_write_b32 a47, v91
    v_accvgpr_read_b32 v88, a48
    v_accvgpr_read_b32 v89, a49
    v_accvgpr_read_b32 v90, a50
    v_accvgpr_read_b32 v91, a51
    v_mul_f32 v88, v88, v2
    v_mul_f32 v89, v89, v2
    v_mul_f32 v90, v90, v2
    v_mul_f32 v91, v91, v2
    v_accvgpr_write_b32 a48, v88
    v_accvgpr_write_b32 a49, v89
    v_accvgpr_write_b32 a50, v90
    v_accvgpr_write_b32 a51, v91
    v_accvgpr_read_b32 v88, a52
    v_accvgpr_read_b32 v89, a53
    v_accvgpr_read_b32 v90, a54
    v_accvgpr_read_b32 v91, a55
    v_mul_f32 v88, v88, v2
    v_mul_f32 v89, v89, v2
    v_mul_f32 v90, v90, v2
    v_mul_f32 v91, v91, v2
    v_accvgpr_write_b32 a52, v88
    v_accvgpr_write_b32 a53, v89
    v_accvgpr_write_b32 a54, v90
    v_accvgpr_write_b32 a55, v91
    v_accvgpr_read_b32 v88, a56
    v_accvgpr_read_b32 v89, a57
    v_accvgpr_read_b32 v90, a58
    v_accvgpr_read_b32 v91, a59
    v_mul_f32 v88, v88, v2
    v_mul_f32 v89, v89, v2
    v_mul_f32 v90, v90, v2
    v_mul_f32 v91, v91, v2
    v_accvgpr_write_b32 a56, v88
    v_accvgpr_write_b32 a57, v89
    v_accvgpr_write_b32 a58, v90
    v_accvgpr_write_b32 a59, v91
    v_accvgpr_read_b32 v88, a60
    v_accvgpr_read_b32 v89, a61
    v_accvgpr_read_b32 v90, a62
    v_accvgpr_read_b32 v91, a63
    v_mul_f32 v88, v88, v2
    v_mul_f32 v89, v89, v2
    v_mul_f32 v90, v90, v2
    v_mul_f32 v91, v91, v2
    v_accvgpr_write_b32 a60, v88
    v_accvgpr_write_b32 a61, v89
    v_accvgpr_write_b32 a62, v90
    v_accvgpr_write_b32 a63, v91
    s_nop 1
    s_branch L_back_l
L_last:
    s_mul_i32 s91, s35, 24
    s_add_u32 s91, s91, s57
    s_lshl_b32 s91, s91, 2
    s_add_u32 s91, s91, s34
    s_lshl_b32 s91, s91, 16
    s_waitcnt lgkmcnt(0)
    v_mfma_f32_32x32x16_bf16 v[64:79], v[128:131], v[96:99], v[32:47]
    ds_read_b64_tr_b16 v[160:161], v24 offset:0
    ds_read_b64_tr_b16 v[162:163], v24 offset:2048
    ds_read_b64_tr_b16 v[164:165], v25 offset:0
    ds_read_b64_tr_b16 v[166:167], v25 offset:2048
    ds_read_b64_tr_b16 v[168:169], v26 offset:0
    v_mfma_f32_32x32x16_bf16 v[64:79], v[132:135], v[100:103], v[64:79]
    ds_read_b64_tr_b16 v[170:171], v26 offset:2048
    ds_read_b64_tr_b16 v[172:173], v27 offset:0
    ds_read_b64_tr_b16 v[174:175], v27 offset:2048
    ds_read_b64_tr_b16 v[176:177], v24 offset:4096
    ds_read_b64_tr_b16 v[178:179], v24 offset:6144
    v_mfma_f32_32x32x16_bf16 v[64:79], v[136:139], v[104:107], v[64:79]
    ds_read_b64_tr_b16 v[180:181], v25 offset:4096
    ds_read_b64_tr_b16 v[182:183], v25 offset:6144
    ds_read_b64_tr_b16 v[184:185], v26 offset:4096
    ds_read_b64_tr_b16 v[186:187], v26 offset:6144
    ds_read_b64_tr_b16 v[188:189], v27 offset:4096
    v_mfma_f32_32x32x16_bf16 v[64:79], v[140:143], v[108:111], v[64:79]
    ds_read_b64_tr_b16 v[190:191], v27 offset:6144
    v_exp_f32 v48, v48
    v_exp_f32 v49, v49
    v_mfma_f32_32x32x16_bf16 v[64:79], v[144:147], v[112:115], v[64:79]
    v_exp_f32 v50, v50
    v_exp_f32 v51, v51
    v_exp_f32 v52, v52
    v_mfma_f32_32x32x16_bf16 v[64:79], v[148:151], v[116:119], v[64:79]
    v_exp_f32 v53, v53
    v_exp_f32 v54, v54
    v_exp_f32 v55, v55
    v_mfma_f32_32x32x16_bf16 v[64:79], v[152:155], v[120:123], v[64:79]
    v_cvt_pk_bf16_f32 v80, v48, v49
    v_cvt_pk_bf16_f32 v81, v50, v51
    v_cvt_pk_bf16_f32 v82, v52, v53
    v_cvt_pk_bf16_f32 v83, v54, v55
    v_mfma_f32_32x32x16_bf16 v[64:79], v[156:159], v[124:127], v[64:79]
    v_exp_f32 v56, v56
    v_exp_f32 v57, v57
    v_exp_f32 v58, v58
    v_exp_f32 v59, v59
    s_waitcnt lgkmcnt(0)
    v_mfma_f32_32x32x16_bf16 a[0:15], v[160:163], v[80:83], a[0:15]
    v_exp_f32 v60, v60
    v_mfma_f32_32x32x16_bf16 a[16:31], v[164:167], v[80:83], a[16:31]
    v_exp_f32 v61, v61
    v_exp_f32 v62, v62
    v_exp_f32 v63, v63
    v_mfma_f32_32x32x16_bf16 a[32:47], v[168:171], v[80:83], a[32:47]
    v_add_f32 v6, v6, v48
    v_cvt_pk_bf16_f32 v84, v56, v57
    v_cvt_pk_bf16_f32 v85, v58, v59
    v_cvt_pk_bf16_f32 v86, v60, v61
    v_mfma_f32_32x32x16_bf16 a[48:63], v[172:175], v[80:83], a[48:63]
    v_cvt_pk_bf16_f32 v87, v62, v63
    v_add_f32 v7, v7, v49
    v_add_f32 v8, v8, v50
    v_add_f32 v9, v9, v51
    v_add_f32 v6, v6, v52
    v_mfma_f32_32x32x16_bf16 a[0:15], v[176:179], v[84:87], a[0:15]
    v_add_f32 v7, v7, v53
    v_add_f32 v8, v8, v54
    v_add_f32 v9, v9, v55
    v_add_f32 v6, v6, v56
    v_add_f32 v7, v7, v57
    v_mfma_f32_32x32x16_bf16 a[16:31], v[180:183], v[84:87], a[16:31]
    v_add_f32 v8, v8, v58
    v_add_f32 v9, v9, v59
    v_add_f32 v6, v6, v60
    v_add_f32 v7, v7, v61
    v_add_f32 v8, v8, v62
    v_mfma_f32_32x32x16_bf16 a[32:47], v[184:187], v[84:87], a[32:47]
    v_add_f32 v9, v9, v63
    v_max3_f32 v10, v64, v65, v66
    v_max3_f32 v11, v67, v68, v69
    v_max3_f32 v10, v10, v70, v71
    v_max3_f32 v11, v11, v72, v73
    v_mfma_f32_32x32x16_bf16 a[48:63], v[188:191], v[84:87], a[48:63]
    v_max3_f32 v10, v10, v74, v75
    v_max3_f32 v11, v11, v76, v77
    v_max3_f32 v10, v10, v78, v79
    v_max_f32 v10, v10, v11
    v_cmp_lt_f32 vcc, s49, v10
    s_cbranch_vccnz L_rare_l
L_back_l:
    ds_read_b64_tr_b16 v[160:161], v24 offset:8192
    ds_read_b64_tr_b16 v[162:163], v24 offset:10240
    ds_read_b64_tr_b16 v[164:165], v25 offset:8192
    ds_read_b64_tr_b16 v[166:167], v25 offset:10240
    ds_read_b64_tr_b16 v[168:169], v26 offset:8192
    ds_read_b64_tr_b16 v[170:171], v26 offset:10240
    ds_read_b64_tr_b16 v[172:173], v27 offset:8192
    ds_read_b64_tr_b16 v[174:175], v27 offset:10240
    ds_read_b64_tr_b16 v[176:177], v24 offset:12288
    ds_read_b64_tr_b16 v[178:179], v24 offset:14336
    ds_read_b64_tr_b16 v[180:181], v25 offset:12288
    ds_read_b64_tr_b16 v[182:183], v25 offset:14336
    ds_read_b64_tr_b16 v[184:185], v26 offset:12288
    ds_read_b64_tr_b16 v[186:187], v26 offset:14336
    ds_read_b64_tr_b16 v[188:189], v27 offset:12288
    ds_read_b64_tr_b16 v[190:191], v27 offset:14336
    v_exp_f32 v64, v64
    v_exp_f32 v65, v65
    v_exp_f32 v66, v66
    v_exp_f32 v67, v67
    v_exp_f32 v68, v68
    v_exp_f32 v69, v69
    v_exp_f32 v70, v70
    v_exp_f32 v71, v71
    v_cvt_pk_bf16_f32 v80, v64, v65
    v_cvt_pk_bf16_f32 v81, v66, v67
    v_cvt_pk_bf16_f32 v82, v68, v69
    v_cvt_pk_bf16_f32 v83, v70, v71
    v_exp_f32 v72, v72
    v_exp_f32 v73, v73
    s_waitcnt lgkmcnt(0)
    v_mfma_f32_32x32x16_bf16 a[0:15], v[160:163], v[80:83], a[0:15]
    v_exp_f32 v74, v74
    v_exp_f32 v75, v75
    v_mfma_f32_32x32x16_bf16 a[16:31], v[164:167], v[80:83], a[16:31]
    v_exp_f32 v76, v76
    v_exp_f32 v77, v77
    v_mfma_f32_32x32x16_bf16 a[32:47], v[168:171], v[80:83], a[32:47]
    v_exp_f32 v78, v78
    v_exp_f32 v79, v79
    v_mfma_f32_32x32x16_bf16 a[48:63], v[172:175], v[80:83], a[48:63]
    v_add_f32 v6, v6, v64
    v_cvt_pk_bf16_f32 v84, v72, v73
    v_cvt_pk_bf16_f32 v85, v74, v75
    v_cvt_pk_bf16_f32 v86, v76, v77
    v_cvt_pk_bf16_f32 v87, v78, v79
    v_add_f32 v7, v7, v65
    v_add_f32 v8, v8, v66
    v_mfma_f32_32x32x16_bf16 a[0:15], v[176:179], v[84:87], a[0:15]
    v_add_f32 v9, v9, v67
    v_mfma_f32_32x32x16_bf16 a[16:31], v[180:183], v[84:87], a[16:31]
    v_add_f32 v6, v6, v68
    v_add_f32 v7, v7, v69
    v_add_f32 v8, v8, v70
    v_add_f32 v9, v9, v71
    v_mfma_f32_32x32x16_bf16 a[32:47], v[184:187], v[84:87], a[32:47]
    v_add_f32 v6, v6, v72
    v_add_f32 v7, v7, v73
    v_add_f32 v8, v8, v74
    v_add_f32 v9, v9, v75
    v_mfma_f32_32x32x16_bf16 a[48:63], v[188:191], v[84:87], a[48:63]
    v_add_f32 v6, v6, v76
    v_add_f32 v7, v7, v77
    v_add_f32 v8, v8, v78
    v_add_f32 v9, v9, v79
    v_add_f32 v6, v6, v7
    v_add_f32 v8, v8, v9
    v_add_f32 v6, v6, v8
    v_mov_b32 v2, v6
    s_nop 1
    v_permlane32_swap_b32 v2, v6
    s_nop 1
    v_add_f32 v6, v6, v2
    v_rcp_f32 v2, v6
    s_nop 4
    v_accvgpr_read_b32 v160, a0
    v_accvgpr_read_b32 v161, a1
    v_accvgpr_read_b32 v162, a2
    v_accvgpr_read_b32 v163, a3
    v_accvgpr_read_b32 v164, a4
    v_accvgpr_read_b32 v165, a5
    v_accvgpr_read_b32 v166, a6
    v_accvgpr_read_b32 v167, a7
    v_pk_mul_f32 v[160:161], v[160:161], v[2:3] op_sel_hi:[1,0]
    v_pk_mul_f32 v[162:163], v[162:163], v[2:3] op_sel_hi:[1,0]
    v_pk_mul_f32 v[164:165], v[164:165], v[2:3] op_sel_hi:[1,0]
    v_pk_mul_f32 v[166:167], v[166:167], v[2:3] op_sel_hi:[1,0]
    v_cvt_pk_bf16_f32 v88, v160, v161
    v_cvt_pk_bf16_f32 v89, v162, v163
    v_cvt_pk_bf16_f32 v90, v164, v165
    v_cvt_pk_bf16_f32 v91, v166, v167
    buffer_store_dwordx4 v[88:91], v28, s[28:31], s52 offen offset:0 sc1
    v_accvgpr_read_b32 v168, a8
    v_accvgpr_read_b32 v169, a9
    v_accvgpr_read_b32 v170, a10
    v_accvgpr_read_b32 v171, a11
    v_accvgpr_read_b32 v172, a12
    v_accvgpr_read_b32 v173, a13
    v_accvgpr_read_b32 v174, a14
    v_accvgpr_read_b32 v175, a15
    v_pk_mul_f32 v[168:169], v[168:169], v[2:3] op_sel_hi:[1,0]
    v_pk_mul_f32 v[170:171], v[170:171], v[2:3] op_sel_hi:[1,0]
    v_pk_mul_f32 v[172:173], v[172:173], v[2:3] op_sel_hi:[1,0]
    v_pk_mul_f32 v[174:175], v[174:175], v[2:3] op_sel_hi:[1,0]
    v_cvt_pk_bf16_f32 v92, v168, v169
    v_cvt_pk_bf16_f32 v93, v170, v171
    v_cvt_pk_bf16_f32 v94, v172, v173
    v_cvt_pk_bf16_f32 v95, v174, v175
    buffer_store_dwordx4 v[92:95], v28, s[28:31], s52 offen offset:1024 sc1
    v_accvgpr_read_b32 v176, a16
    v_accvgpr_read_b32 v177, a17
    v_accvgpr_read_b32 v178, a18
    v_accvgpr_read_b32 v179, a19
    v_accvgpr_read_b32 v180, a20
    v_accvgpr_read_b32 v181, a21
    v_accvgpr_read_b32 v182, a22
    v_accvgpr_read_b32 v183, a23
    v_pk_mul_f32 v[176:177], v[176:177], v[2:3] op_sel_hi:[1,0]
    v_pk_mul_f32 v[178:179], v[178:179], v[2:3] op_sel_hi:[1,0]
    v_pk_mul_f32 v[180:181], v[180:181], v[2:3] op_sel_hi:[1,0]
    v_pk_mul_f32 v[182:183], v[182:183], v[2:3] op_sel_hi:[1,0]
    v_cvt_pk_bf16_f32 v88, v176, v177
    v_cvt_pk_bf16_f32 v89, v178, v179
    v_cvt_pk_bf16_f32 v90, v180, v181
    v_cvt_pk_bf16_f32 v91, v182, v183
    buffer_store_dwordx4 v[88:91], v28, s[28:31], s52 offen offset:2048 sc1
    v_accvgpr_read_b32 v184, a24
    v_accvgpr_read_b32 v185, a25
    v_accvgpr_read_b32 v186, a26
    v_accvgpr_read_b32 v187, a27
    v_accvgpr_read_b32 v188, a28
    v_accvgpr_read_b32 v189, a29
    v_accvgpr_read_b32 v190, a30
    v_accvgpr_read_b32 v191, a31
    v_pk_mul_f32 v[184:185], v[184:185], v[2:3] op_sel_hi:[1,0]
    v_pk_mul_f32 v[186:187], v[186:187], v[2:3] op_sel_hi:[1,0]
    v_pk_mul_f32 v[188:189], v[188:189], v[2:3] op_sel_hi:[1,0]
    v_pk_mul_f32 v[190:191], v[190:191], v[2:3] op_sel_hi:[1,0]
    v_cvt_pk_bf16_f32 v92, v184, v185
    v_cvt_pk_bf16_f32 v93, v186, v187
    v_cvt_pk_bf16_f32 v94, v188, v189
    v_cvt_pk_bf16_f32 v95, v190, v191
    buffer_store_dwordx4 v[92:95], v28, s[28:31], s52 offen offset:3072 sc1
    v_accvgpr_read_b32 v160, a32
    v_accvgpr_read_b32 v161, a33
    v_accvgpr_read_b32 v162, a34
    v_accvgpr_read_b32 v163, a35
    v_accvgpr_read_b32 v164, a36
    v_accvgpr_read_b32 v165, a37
    v_accvgpr_read_b32 v166, a38
    v_accvgpr_read_b32 v167, a39
    v_pk_mul_f32 v[160:161], v[160:161], v[2:3] op_sel_hi:[1,0]
    v_pk_mul_f32 v[162:163], v[162:163], v[2:3] op_sel_hi:[1,0]
    v_pk_mul_f32 v[164:165], v[164:165], v[2:3] op_sel_hi:[1,0]
    v_pk_mul_f32 v[166:167], v[166:167], v[2:3] op_sel_hi:[1,0]
    v_cvt_pk_bf16_f32 v88, v160, v161
    v_cvt_pk_bf16_f32 v89, v162, v163
    v_cvt_pk_bf16_f32 v90, v164, v165
    v_cvt_pk_bf16_f32 v91, v166, v167
    s_add_u32 s52, s52, 4096
    buffer_store_dwordx4 v[88:91], v28, s[28:31], s52 offen offset:0 sc1
    v_accvgpr_read_b32 v168, a40
    v_accvgpr_read_b32 v169, a41
    v_accvgpr_read_b32 v170, a42
    v_accvgpr_read_b32 v171, a43
    v_accvgpr_read_b32 v172, a44
    v_accvgpr_read_b32 v173, a45
    v_accvgpr_read_b32 v174, a46
    v_accvgpr_read_b32 v175, a47
    v_pk_mul_f32 v[168:169], v[168:169], v[2:3] op_sel_hi:[1,0]
    v_pk_mul_f32 v[170:171], v[170:171], v[2:3] op_sel_hi:[1,0]
    v_pk_mul_f32 v[172:173], v[172:173], v[2:3] op_sel_hi:[1,0]
    v_pk_mul_f32 v[174:175], v[174:175], v[2:3] op_sel_hi:[1,0]
    v_cvt_pk_bf16_f32 v92, v168, v169
    v_cvt_pk_bf16_f32 v93, v170, v171
    v_cvt_pk_bf16_f32 v94, v172, v173
    v_cvt_pk_bf16_f32 v95, v174, v175
    buffer_store_dwordx4 v[92:95], v28, s[28:31], s52 offen offset:1024 sc1
    v_accvgpr_read_b32 v176, a48
    v_accvgpr_read_b32 v177, a49
    v_accvgpr_read_b32 v178, a50
    v_accvgpr_read_b32 v179, a51
    v_accvgpr_read_b32 v180, a52
    v_accvgpr_read_b32 v181, a53
    v_accvgpr_read_b32 v182, a54
    v_accvgpr_read_b32 v183, a55
    v_pk_mul_f32 v[176:177], v[176:177], v[2:3] op_sel_hi:[1,0]
    v_pk_mul_f32 v[178:179], v[178:179], v[2:3] op_sel_hi:[1,0]
    v_pk_mul_f32 v[180:181], v[180:181], v[2:3] op_sel_hi:[1,0]
    v_pk_mul_f32 v[182:183], v[182:183], v[2:3] op_sel_hi:[1,0]
    v_cvt_pk_bf16_f32 v88, v176, v177
    v_cvt_pk_bf16_f32 v89, v178, v179
    v_cvt_pk_bf16_f32 v90, v180, v181
    v_cvt_pk_bf16_f32 v91, v182, v183
    buffer_store_dwordx4 v[88:91], v28, s[28:31], s52 offen offset:2048 sc1
    v_accvgpr_read_b32 v184, a56
    v_accvgpr_read_b32 v185, a57
    v_accvgpr_read_b32 v186, a58
    v_accvgpr_read_b32 v187, a59
    v_accvgpr_read_b32 v188, a60
    v_accvgpr_read_b32 v189, a61
    v_accvgpr_read_b32 v190, a62
    v_accvgpr_read_b32 v191, a63
    v_pk_mul_f32 v[184:185], v[184:185], v[2:3] op_sel_hi:[1,0]
    v_pk_mul_f32 v[186:187], v[186:187], v[2:3] op_sel_hi:[1,0]
    v_pk_mul_f32 v[188:189], v[188:189], v[2:3] op_sel_hi:[1,0]
    v_pk_mul_f32 v[190:191], v[190:191], v[2:3] op_sel_hi:[1,0]
    v_cvt_pk_bf16_f32 v92, v184, v185
    v_cvt_pk_bf16_f32 v93, v186, v187
    v_cvt_pk_bf16_f32 v94, v188, v189
    v_cvt_pk_bf16_f32 v95, v190, v191
    buffer_store_dwordx4 v[92:95], v28, s[28:31], s52 offen offset:3072 sc1
    s_add_u32 s39, s94, 0
    s_and_b32 s39, s39, 15
    s_lshl_b32 s39, s39, 12
    s_add_u32 s39, s39, s91
    buffer_load_dwordx4 v[96:99], v28, s[28:31], s39 offen offset:0 sc1
    buffer_load_dwordx4 v[100:103], v28, s[28:31], s39 offen offset:1024 sc1
    buffer_load_dwordx4 v[104:107], v28, s[28:31], s39 offen offset:2048 sc1
    buffer_load_dwordx4 v[108:111], v28, s[28:31], s39 offen offset:3072 sc1
    s_add_u32 s39, s94, 1
    s_and_b32 s39, s39, 15
    s_lshl_b32 s39, s39, 12
    s_add_u32 s39, s39, s91
    buffer_load_dwordx4 v[112:115], v28, s[28:31], s39 offen offset:0 sc1
    buffer_load_dwordx4 v[116:119], v28, s[28:31], s39 offen offset:1024 sc1
    buffer_load_dwordx4 v[120:123], v28, s[28:31], s39 offen offset:2048 sc1
    buffer_load_dwordx4 v[124:127], v28, s[28:31], s39 offen offset:3072 sc1
    s_add_u32 s39, s94, 2
    s_and_b32 s39, s39, 15
    s_lshl_b32 s39, s39, 12
    s_add_u32 s39, s39, s91
    buffer_load_dwordx4 v[128:131], v28, s[28:31], s39 offen offset:0 sc1
    buffer_load_dwordx4 v[132:135], v28, s[28:31], s39 offen offset:1024 sc1
    buffer_load_dwordx4 v[136:139], v28, s[28:31], s39 offen offset:2048 sc1
    buffer_load_dwordx4 v[140:143], v28, s[28:31], s39 offen offset:3072 sc1
    s_waitcnt vmcnt(12) lgkmcnt(0)
    s_barrier
    s_branch L_join
L_loader2:
    s_lshl_b32 s38, s35, 2
    s_add_u32 s38, s38, s92
    s_lshl_b32 s38, s38, 12
    s_add_u32 s38, s38, 12582912
    v_and_b32 v18, 31, v1
    v_lshlrev_b32 v18, 7, v18
    v_add_u32 v18, s38, v18
    v_lshrrev_b32 v2, 5, v1
    v_bfe_u32 v3, v1, 2, 2
    v_lshl_add_u32 v4, v2, 3, v3
    v_lshlrev_b32 v4, 8, v4
    v_lshl_add_u32 v4, v3, 6, v4
    v_bfe_u32 v5, v1, 4, 1
    v_lshl_add_u32 v4, v5, 5, v4
    v_and_b32 v5, 1, v1
    v_lshl_add_u32 v4, v5, 4, v4
    v_bfe_u32 v5, v1, 1, 1
    v_lshl_add_u32 v4, v5, 3, v4
    v_xor_b32 v96, 0, v4
    v_add_u32 v96, 114688, v96
    v_xor_b32 v97, 64, v4
    v_add_u32 v97, 114688, v97
    v_xor_b32 v98, 128, v4
    v_add_u32 v98, 114688, v98
    v_xor_b32 v99, 192, v4
    v_add_u32 v99, 114688, v99
    v_and_b32 v3, 31, v1
    v_bfe_u32 v4, v1, 1, 3
    v_xor_b32 v4, v4, v2
    v_lshlrev_b32 v4, 4, v4
    v_lshl_add_u32 v4, v3, 7, v4
    v_xor_b32 v100, 0, v4
    v_add_u32 v100, 0, v100
    v_xor_b32 v101, 32, v4
    v_add_u32 v101, 0, v101
    v_xor_b32 v102, 64, v4
    v_add_u32 v102, 0, v102
    v_xor_b32 v103, 96, v4
    v_add_u32 v103, 0, v103
    v_lshrrev_b32 v2, 3, v1
    v_mul_u32_u24 v2, 1280, v2
    v_bfe_u32 v3, v1, 4, 1
    v_lshlrev_b32 v3, 2, v3
    v_and_b32 v4, 7, v1
    v_xor_b32 v3, v3, v4
    v_lshl_add_u32 v12, v3, 4, v2
    v_add_u32 v13, 9216, v12
    v_add_u32 v14, 18432, v12
    v_add_u32 v15, 27648, v12
    v_lshrrev_b32 v2, 5, v1
    v_bfe_u32 v3, v1, 2, 2
    v_lshl_add_u32 v29, v2, 2, v3
    v_lshlrev_b32 v29, 7, v29
    v_bfe_u32 v5, v1, 3, 1
    v_lshl_add_u32 v29, v5, 6, v29
    v_bfe_u32 v5, v1, 4, 1
    v_lshl_add_u32 v29, v5, 5, v29
    v_and_b32 v5, 3, v1
    v_lshl_add_u32 v29, v5, 3, v29
    v_lshlrev_b32 v20, 7, v1
    v_add_u32 v29, 24576, v29
    v_xor_b32 v30, 64, v29
    v_lshlrev_b32 v28, 4, v1
    s_mov_b32 s51, 0x3e0293ee
    s_lshl_b32 s40, s36, 2
    s_add_u32 s40, s40, s37
    s_mul_i32 s40, s40, 40960
    s_barrier
    ds_read_b64_tr_b16 v[48:49], v98 offset:0
    ds_read_b64_tr_b16 v[50:51], v98 offset:1024
    ds_read_b64_tr_b16 v[52:53], v99 offset:0
    ds_read_b64_tr_b16 v[54:55], v99 offset:1024
    ds_read_b128 v[64:67], v100 offset:4096
    ds_read_b128 v[68:71], v100 offset:12288
    ds_read_b128 v[72:75], v100 offset:20480
    s_waitcnt lgkmcnt(0)
    v_mfma_f32_32x32x16_bf16 v[128:143], v[48:51], v[64:67], 0
    ds_read_b64_tr_b16 v[56:57], v98 offset:4096
    ds_read_b64_tr_b16 v[58:59], v98 offset:5120
    ds_read_b64_tr_b16 v[60:61], v99 offset:4096
    v_mfma_f32_32x32x16_bf16 v[144:159], v[52:55], v[64:67], 0
    ds_read_b64_tr_b16 v[62:63], v99 offset:5120
    ds_read_b128 v[80:83], v101 offset:4096
    ds_read_b128 v[84:87], v101 offset:12288
    s_add_u32 s38, s97, 0
    s_and_b32 s38, s38, 262143
    v_mfma_f32_32x32x16_bf16 v[160:175], v[48:51], v[68:71], 0
    ds_read_b128 v[88:91], v101 offset:20480
    s_add_u32 s38, s38, s45
    s_mov_b32 m0, 131072
    v_mfma_f32_32x32x16_bf16 v[176:191], v[52:55], v[68:71], 0
    s_add_u32 s39, s38, 0
    buffer_load_dwordx4 v24, s[8:11], s39 offen offset:0 sc1 nt lds
    v_mfma_f32_32x32x16_bf16 v[192:207], v[48:51], v[72:75], 0
    buffer_load_dwordx4 v25, s[8:11], s39 offen offset:1024 sc1 nt lds
    buffer_load_dwordx4 v26, s[8:11], s39 offen offset:2048 sc1 nt lds
    v_mfma_f32_32x32x16_bf16 v[208:223], v[52:55], v[72:75], 0
    buffer_load_dwordx4 v27, s[8:11], s39 offen offset:3072 sc1 nt lds
    s_waitcnt lgkmcnt(0)
    v_mfma_f32_32x32x16_bf16 v[128:143], v[56:59], v[80:83], v[128:143]
    ds_read_b64_tr_b16 v[48:49], v98 offset:8192
    ds_read_b64_tr_b16 v[50:51], v98 offset:9216
    ds_read_b64_tr_b16 v[52:53], v99 offset:8192
    v_mfma_f32_32x32x16_bf16 v[144:159], v[60:63], v[80:83], v[144:159]
    ds_read_b64_tr_b16 v[54:55], v99 offset:9216
    ds_read_b128 v[64:67], v102 offset:4096
    ds_read_b128 v[68:71], v102 offset:12288
    s_mov_b32 m0, 135168
    s_add_u32 s39, s38, 4096
    v_mfma_f32_32x32x16_bf16 v[160:175], v[56:59], v[84:87], v[160:175]
    ds_read_b128 v[72:75], v102 offset:20480
    buffer_load_dwordx4 v24, s[8:11], s39 offen offset:0 sc1 nt lds
    v_mfma_f32_32x32x16_bf16 v[176:191], v[60:63], v[84:87], v[176:191]
    buffer_load_dwordx4 v25, s[8:11], s39 offen offset:1024 sc1 nt lds
    v_mfma_f32_32x32x16_bf16 v[192:207], v[56:59], v[88:91], v[192:207]
    buffer_load_dwordx4 v26, s[8:11], s39 offen offset:2048 sc1 nt lds
    v_mfma_f32_32x32x16_bf16 v[208:223], v[60:63], v[88:91], v[208:223]
    buffer_load_dwordx4 v27, s[8:11], s39 offen offset:3072 sc1 nt lds
    s_waitcnt lgkmcnt(0)
    v_mfma_f32_32x32x16_bf16 v[128:143], v[48:51], v[64:67], v[128:143]
    ds_read_b64_tr_b16 v[56:57], v98 offset:12288
    ds_read_b64_tr_b16 v[58:59], v98 offset:13312
    ds_read_b64_tr_b16 v[60:61], v99 offset:12288
    v_mfma_f32_32x32x16_bf16 v[144:159], v[52:55], v[64:67], v[144:159]
    ds_read_b64_tr_b16 v[62:63], v99 offset:13312
    ds_read_b128 v[80:83], v103 offset:4096
    ds_read_b128 v[84:87], v103 offset:12288
    v_mfma_f32_32x32x16_bf16 v[160:175], v[48:51], v[68:71], v[160:175]
    ds_read_b128 v[88:91], v103 offset:20480
    s_mov_b32 m0, 139264
    s_add_u32 s39, s38, 8192
    buffer_load_dwordx4 v24, s[8:11], s39 offen offset:0 sc1 nt lds
    buffer_load_dwordx4 v25, s[8:11], s39 offen offset:1024 sc1 nt lds
    v_mfma_f32_32x32x16_bf16 v[176:191], v[52:55], v[68:71], v[176:191]
    buffer_load_dwordx4 v26, s[8:11], s39 offen offset:2048 sc1 nt lds
    buffer_load_dwordx4 v27, s[8:11], s39 offen offset:3072 sc1 nt lds
    v_subrev_u32 v96, 81920, v96
    v_mfma_f32_32x32x16_bf16 v[192:207], v[48:51], v[72:75], v[192:207]
    v_subrev_u32 v97, 81920, v97
    v_subrev_u32 v98, 81920, v98
    v_subrev_u32 v99, 81920, v99
    v_add_u32 v100, 49152, v100
    v_mfma_f32_32x32x16_bf16 v[208:223], v[52:55], v[72:75], v[208:223]
    v_add_u32 v101, 49152, v101
    v_add_u32 v102, 49152, v102
    v_add_u32 v103, 49152, v103
    s_waitcnt lgkmcnt(0)
    s_barrier
    v_mfma_f32_32x32x16_bf16 v[128:143], v[56:59], v[80:83], v[128:143]
    ds_read_b64_tr_b16 v[48:49], v98 offset:0
    ds_read_b64_tr_b16 v[50:51], v98 offset:1024
    ds_read_b64_tr_b16 v[52:53], v99 offset:0
    v_mfma_f32_32x32x16_bf16 v[144:159], v[60:63], v[80:83], v[144:159]
    ds_read_b64_tr_b16 v[54:55], v99 offset:1024
    ds_read_b128 v[64:67], v100 offset:4096
    ds_read_b128 v[68:71], v100 offset:12288
    s_mov_b32 m0, 143360
    s_add_u32 s39, s38, 12288
    v_mfma_f32_32x32x16_bf16 v[160:175], v[56:59], v[84:87], v[160:175]
    ds_read_b128 v[72:75], v100 offset:20480
    buffer_load_dwordx4 v24, s[8:11], s39 offen offset:0 sc1 nt lds
    v_mfma_f32_32x32x16_bf16 v[176:191], v[60:63], v[84:87], v[176:191]
    buffer_load_dwordx4 v25, s[8:11], s39 offen offset:1024 sc1 nt lds
    v_mfma_f32_32x32x16_bf16 v[192:207], v[56:59], v[88:91], v[192:207]
    buffer_load_dwordx4 v26, s[8:11], s39 offen offset:2048 sc1 nt lds
    v_mfma_f32_32x32x16_bf16 v[208:223], v[60:63], v[88:91], v[208:223]
    buffer_load_dwordx4 v27, s[8:11], s39 offen offset:3072 sc1 nt lds
    s_waitcnt lgkmcnt(0)
    v_mfma_f32_32x32x16_bf16 v[128:143], v[48:51], v[64:67], v[128:143]
    ds_read_b64_tr_b16 v[56:57], v98 offset:4096
    ds_read_b64_tr_b16 v[58:59], v98 offset:5120
    ds_read_b64_tr_b16 v[60:61], v99 offset:4096
    v_mfma_f32_32x32x16_bf16 v[144:159], v[52:55], v[64:67], v[144:159]
    ds_read_b64_tr_b16 v[62:63], v99 offset:5120
    ds_read_b128 v[80:83], v101 offset:4096
    ds_read_b128 v[84:87], v101 offset:12288
    s_add_u32 s38, s97, 16384
    s_and_b32 s38, s38, 262143
    v_mfma_f32_32x32x16_bf16 v[160:175], v[48:51], v[68:71], v[160:175]
    ds_read_b128 v[88:91], v101 offset:20480
    s_add_u32 s38, s38, s45
    s_mov_b32 m0, 147456
    v_mfma_f32_32x32x16_bf16 v[176:191], v[52:55], v[68:71], v[176:191]
    s_add_u32 s39, s38, 0
    buffer_load_dwordx4 v24, s[8:11], s39 offen offset:0 sc1 nt lds
    v_mfma_f32_32x32x16_bf16 v[192:207], v[48:51], v[72:75], v[192:207]
    buffer_load_dwordx4 v25, s[8:11], s39 offen offset:1024 sc1 nt lds
    buffer_load_dwordx4 v26, s[8:11], s39 offen offset:2048 sc1 nt lds
    v_mfma_f32_32x32x16_bf16 v[208:223], v[52:55], v[72:75], v[208:223]
    buffer_load_dwordx4 v27, s[8:11], s39 offen offset:3072 sc1 nt lds
    s_waitcnt lgkmcnt(0)
    v_mfma_f32_32x32x16_bf16 v[128:143], v[56:59], v[80:83], v[128:143]
    ds_read_b64_tr_b16 v[48:49], v98 offset:8192
    ds_read_b64_tr_b16 v[50:51], v98 offset:9216
    ds_read_b64_tr_b16 v[52:53], v99 offset:8192
    v_mfma_f32_32x32x16_bf16 v[144:159], v[60:63], v[80:83], v[144:159]
    ds_read_b64_tr_b16 v[54:55], v99 offset:9216
    ds_read_b128 v[64:67], v102 offset:4096
    ds_read_b128 v[68:71], v102 offset:12288
    s_mov_b32 m0, 151552
    s_add_u32 s39, s38, 4096
    v_mfma_f32_32x32x16_bf16 v[160:175], v[56:59], v[84:87], v[160:175]
    ds_read_b128 v[72:75], v102 offset:20480
    buffer_load_dwordx4 v24, s[8:11], s39 offen offset:0 sc1 nt lds
    v_mfma_f32_32x32x16_bf16 v[176:191], v[60:63], v[84:87], v[176:191]
    buffer_load_dwordx4 v25, s[8:11], s39 offen offset:1024 sc1 nt lds
    v_mfma_f32_32x32x16_bf16 v[192:207], v[56:59], v[88:91], v[192:207]
    buffer_load_dwordx4 v26, s[8:11], s39 offen offset:2048 sc1 nt lds
    v_mfma_f32_32x32x16_bf16 v[208:223], v[60:63], v[88:91], v[208:223]
    buffer_load_dwordx4 v27, s[8:11], s39 offen offset:3072 sc1 nt lds
    s_waitcnt lgkmcnt(0)
    v_mfma_f32_32x32x16_bf16 v[128:143], v[48:51], v[64:67], v[128:143]
    ds_read_b64_tr_b16 v[56:57], v98 offset:12288
    ds_read_b64_tr_b16 v[58:59], v98 offset:13312
    ds_read_b64_tr_b16 v[60:61], v99 offset:12288
    v_mfma_f32_32x32x16_bf16 v[144:159], v[52:55], v[64:67], v[144:159]
    ds_read_b64_tr_b16 v[62:63], v99 offset:13312
    ds_read_b128 v[80:83], v103 offset:4096
    ds_read_b128 v[84:87], v103 offset:12288
    v_mfma_f32_32x32x16_bf16 v[160:175], v[48:51], v[68:71], v[160:175]
    ds_read_b128 v[88:91], v103 offset:20480
    s_mov_b32 m0, 155648
    s_add_u32 s39, s38, 8192
    buffer_load_dwordx4 v24, s[8:11], s39 offen offset:0 sc1 nt lds
    buffer_load_dwordx4 v25, s[8:11], s39 offen offset:1024 sc1 nt lds
    v_mfma_f32_32x32x16_bf16 v[176:191], v[52:55], v[68:71], v[176:191]
    buffer_load_dwordx4 v26, s[8:11], s39 offen offset:2048 sc1 nt lds
    buffer_load_dwordx4 v27, s[8:11], s39 offen offset:3072 sc1 nt lds
    v_add_u32 v96, 40960, v96
    v_mfma_f32_32x32x16_bf16 v[192:207], v[48:51], v[72:75], v[192:207]
    v_add_u32 v97, 40960, v97
    v_add_u32 v98, 40960, v98
    v_add_u32 v99, 40960, v99
    v_add_u32 v100, 40960, v100
    v_mfma_f32_32x32x16_bf16 v[208:223], v[52:55], v[72:75], v[208:223]
    v_add_u32 v101, 40960, v101
    v_add_u32 v102, 40960, v102
    v_add_u32 v103, 40960, v103
    s_waitcnt lgkmcnt(0)
    s_barrier
    v_mfma_f32_32x32x16_bf16 v[128:143], v[56:59], v[80:83], v[128:143]
    ds_read_b64_tr_b16 v[48:49], v98 offset:0
    ds_read_b64_tr_b16 v[50:51], v98 offset:1024
    ds_read_b64_tr_b16 v[52:53], v99 offset:0
    v_mfma_f32_32x32x16_bf16 v[144:159], v[60:63], v[80:83], v[144:159]
    ds_read_b64_tr_b16 v[54:55], v99 offset:1024
    ds_read_b128 v[64:67], v100 offset:4096
    ds_read_b128 v[68:71], v100 offset:12288
    s_mov_b32 m0, 159744
    s_add_u32 s39, s38, 12288
    v_mfma_f32_32x32x16_bf16 v[160:175], v[56:59], v[84:87], v[160:175]
    ds_read_b128 v[72:75], v100 offset:20480
    buffer_load_dwordx4 v24, s[8:11], s39 offen offset:0 sc1 nt lds
    v_mfma_f32_32x32x16_bf16 v[176:191], v[60:63], v[84:87], v[176:191]
    buffer_load_dwordx4 v25, s[8:11], s39 offen offset:1024 sc1 nt lds
    v_mfma_f32_32x32x16_bf16 v[192:207], v[56:59], v[88:91], v[192:207]
    buffer_load_dwordx4 v26, s[8:11], s39 offen offset:2048 sc1 nt lds
    v_mfma_f32_32x32x16_bf16 v[208:223], v[60:63], v[88:91], v[208:223]
    buffer_load_dwordx4 v27, s[8:11], s39 offen offset:3072 sc1 nt lds
    s_waitcnt lgkmcnt(0)
    v_mfma_f32_32x32x16_bf16 v[128:143], v[48:51], v[64:67], v[128:143]
    ds_read_b64_tr_b16 v[56:57], v98 offset:4096
    ds_read_b64_tr_b16 v[58:59], v98 offset:5120
    ds_read_b64_tr_b16 v[60:61], v99 offset:4096
    v_mfma_f32_32x32x16_bf16 v[144:159], v[52:55], v[64:67], v[144:159]
    ds_read_b64_tr_b16 v[62:63], v99 offset:5120
    ds_read_b128 v[80:83], v101 offset:4096
    ds_read_b128 v[84:87], v101 offset:12288
    s_add_u32 s39, s40, 0
    v_mfma_f32_32x32x16_bf16 v[160:175], v[48:51], v[68:71], v[160:175]
    ds_read_b128 v[88:91], v101 offset:20480
    v_mfma_f32_32x32x16_bf16 v[176:191], v[52:55], v[68:71], v[176:191]
    buffer_load_dword v21, v20, s[20:23], s39 offen
    v_mfma_f32_32x32x16_bf16 v[192:207], v[48:51], v[72:75], v[192:207]
    v_mfma_f32_32x32x16_bf16 v[208:223], v[52:55], v[72:75], v[208:223]
    s_waitcnt lgkmcnt(0)
    v_mfma_f32_32x32x16_bf16 v[128:143], v[56:59], v[80:83], v[128:143]
    ds_read_b64_tr_b16 v[48:49], v98 offset:8192
    ds_read_b64_tr_b16 v[50:51], v98 offset:9216
    ds_read_b64_tr_b16 v[52:53], v99 offset:8192
    v_mfma_f32_32x32x16_bf16 v[144:159], v[60:63], v[80:83], v[144:159]
    ds_read_b64_tr_b16 v[54:55], v99 offset:9216
    ds_read_b128 v[64:67], v102 offset:4096
    ds_read_b128 v[68:71], v102 offset:12288
    v_mfma_f32_32x32x16_bf16 v[160:175], v[56:59], v[84:87], v[160:175]
    ds_read_b128 v[72:75], v102 offset:20480
    v_mfma_f32_32x32x16_bf16 v[176:191], v[60:63], v[84:87], v[176:191]
    v_mfma_f32_32x32x16_bf16 v[192:207], v[56:59], v[88:91], v[192:207]
    v_mfma_f32_32x32x16_bf16 v[208:223], v[60:63], v[88:91], v[208:223]
    s_waitcnt lgkmcnt(0)
    v_mfma_f32_32x32x16_bf16 v[128:143], v[48:51], v[64:67], v[128:143]
    ds_read_b64_tr_b16 v[56:57], v98 offset:12288
    ds_read_b64_tr_b16 v[58:59], v98 offset:13312
    ds_read_b64_tr_b16 v[60:61], v99 offset:12288
    v_mfma_f32_32x32x16_bf16 v[144:159], v[52:55], v[64:67], v[144:159]
    ds_read_b64_tr_b16 v[62:63], v99 offset:13312
    ds_read_b128 v[80:83], v103 offset:4096
    ds_read_b128 v[84:87], v103 offset:12288
    v_mfma_f32_32x32x16_bf16 v[160:175], v[48:51], v[68:71], v[160:175]
    ds_read_b128 v[88:91], v103 offset:20480
    v_add_u32 v96, 40960, v96
    v_add_u32 v97, 40960, v97
    v_mfma_f32_32x32x16_bf16 v[176:191], v[52:55], v[68:71], v[176:191]
    v_add_u32 v98, 40960, v98
    v_add_u32 v99, 40960, v99
    v_mfma_f32_32x32x16_bf16 v[192:207], v[48:51], v[72:75], v[192:207]
    v_subrev_u32 v100, 90112, v100
    v_subrev_u32 v101, 90112, v101
    v_mfma_f32_32x32x16_bf16 v[208:223], v[52:55], v[72:75], v[208:223]
    v_subrev_u32 v102, 90112, v102
    v_subrev_u32 v103, 90112, v103
    s_waitcnt lgkmcnt(0)
    s_barrier
    v_mfma_f32_32x32x16_bf16 v[128:143], v[56:59], v[80:83], v[128:143]
    ds_read_b64_tr_b16 v[48:49], v98 offset:0
    ds_read_b64_tr_b16 v[50:51], v98 offset:1024
    ds_read_b64_tr_b16 v[52:53], v99 offset:0
    v_mfma_f32_32x32x16_bf16 v[144:159], v[60:63], v[80:83], v[144:159]
    ds_read_b64_tr_b16 v[54:55], v99 offset:1024
    ds_read_b128 v[64:67], v100 offset:4096
    ds_read_b128 v[68:71], v100 offset:12288
    v_mfma_f32_32x32x16_bf16 v[160:175], v[56:59], v[84:87], v[160:175]
    ds_read_b128 v[72:75], v100 offset:20480
    v_mfma_f32_32x32x16_bf16 v[176:191], v[60:63], v[84:87], v[176:191]
    v_mfma_f32_32x32x16_bf16 v[192:207], v[56:59], v[88:91], v[192:207]
    v_mfma_f32_32x32x16_bf16 v[208:223], v[60:63], v[88:91], v[208:223]
    s_waitcnt lgkmcnt(0)
    v_mfma_f32_32x32x16_bf16 v[128:143], v[48:51], v[64:67], v[128:143]
    ds_read_b64_tr_b16 v[56:57], v98 offset:4096
    ds_read_b64_tr_b16 v[58:59], v98 offset:5120
    ds_read_b64_tr_b16 v[60:61], v99 offset:4096
    v_mfma_f32_32x32x16_bf16 v[144:159], v[52:55], v[64:67], v[144:159]
    ds_read_b64_tr_b16 v[62:63], v99 offset:5120
    ds_read_b128 v[80:83], v101 offset:4096
    ds_read_b128 v[84:87], v101 offset:12288
    s_add_u32 s39, s40, 8192
    v_mfma_f32_32x32x16_bf16 v[160:175], v[48:51], v[68:71], v[160:175]
    ds_read_b128 v[88:91], v101 offset:20480
    v_mfma_f32_32x32x16_bf16 v[176:191], v[52:55], v[68:71], v[176:191]
    buffer_load_dword v21, v20, s[20:23], s39 offen
    v_mfma_f32_32x32x16_bf16 v[192:207], v[48:51], v[72:75], v[192:207]
    v_mfma_f32_32x32x16_bf16 v[208:223], v[52:55], v[72:75], v[208:223]
    s_waitcnt lgkmcnt(0)
    v_mfma_f32_32x32x16_bf16 v[128:143], v[56:59], v[80:83], v[128:143]
    ds_read_b64_tr_b16 v[48:49], v98 offset:8192
    ds_read_b64_tr_b16 v[50:51], v98 offset:9216
    ds_read_b64_tr_b16 v[52:53], v99 offset:8192
    v_mfma_f32_32x32x16_bf16 v[144:159], v[60:63], v[80:83], v[144:159]
    ds_read_b64_tr_b16 v[54:55], v99 offset:9216
    ds_read_b128 v[64:67], v102 offset:4096
    ds_read_b128 v[68:71], v102 offset:12288
    v_mfma_f32_32x32x16_bf16 v[160:175], v[56:59], v[84:87], v[160:175]
    ds_read_b128 v[72:75], v102 offset:20480
    v_mfma_f32_32x32x16_bf16 v[176:191], v[60:63], v[84:87], v[176:191]
    v_mfma_f32_32x32x16_bf16 v[192:207], v[56:59], v[88:91], v[192:207]
    v_mfma_f32_32x32x16_bf16 v[208:223], v[60:63], v[88:91], v[208:223]
    s_waitcnt lgkmcnt(0)
    v_mfma_f32_32x32x16_bf16 v[128:143], v[48:51], v[64:67], v[128:143]
    ds_read_b64_tr_b16 v[56:57], v98 offset:12288
    ds_read_b64_tr_b16 v[58:59], v98 offset:13312
    ds_read_b64_tr_b16 v[60:61], v99 offset:12288
    v_mfma_f32_32x32x16_bf16 v[144:159], v[52:55], v[64:67], v[144:159]
    ds_read_b64_tr_b16 v[62:63], v99 offset:13312
    ds_read_b128 v[80:83], v103 offset:4096
    ds_read_b128 v[84:87], v103 offset:12288
    v_mfma_f32_32x32x16_bf16 v[160:175], v[48:51], v[68:71], v[160:175]
    ds_read_b128 v[88:91], v103 offset:20480
    v_subrev_u32 v96, 81920, v96
    v_subrev_u32 v97, 81920, v97
    v_mfma_f32_32x32x16_bf16 v[176:191], v[52:55], v[68:71], v[176:191]
    v_subrev_u32 v98, 81920, v98
    v_subrev_u32 v99, 81920, v99
    v_mfma_f32_32x32x16_bf16 v[192:207], v[48:51], v[72:75], v[192:207]
    v_add_u32 v100, 49152, v100
    v_add_u32 v101, 49152, v101
    v_mfma_f32_32x32x16_bf16 v[208:223], v[52:55], v[72:75], v[208:223]
    v_add_u32 v102, 49152, v102
    v_add_u32 v103, 49152, v103
    s_waitcnt lgkmcnt(0)
    s_barrier
    v_mfma_f32_32x32x16_bf16 v[128:143], v[56:59], v[80:83], v[128:143]
    ds_read_b64_tr_b16 v[48:49], v98 offset:0
    ds_read_b64_tr_b16 v[50:51], v98 offset:1024
    ds_read_b64_tr_b16 v[52:53], v99 offset:0
    v_mfma_f32_32x32x16_bf16 v[144:159], v[60:63], v[80:83], v[144:159]
    ds_read_b64_tr_b16 v[54:55], v99 offset:1024
    ds_read_b128 v[64:67], v100 offset:4096
    ds_read_b128 v[68:71], v100 offset:12288
    v_mfma_f32_32x32x16_bf16 v[160:175], v[56:59], v[84:87], v[160:175]
    ds_read_b128 v[72:75], v100 offset:20480
    v_mfma_f32_32x32x16_bf16 v[176:191], v[60:63], v[84:87], v[176:191]
    v_mfma_f32_32x32x16_bf16 v[192:207], v[56:59], v[88:91], v[192:207]
    v_mfma_f32_32x32x16_bf16 v[208:223], v[60:63], v[88:91], v[208:223]
    s_waitcnt lgkmcnt(0)
    v_mfma_f32_32x32x16_bf16 v[128:143], v[48:51], v[64:67], v[128:143]
    ds_read_b64_tr_b16 v[56:57], v98 offset:4096
    ds_read_b64_tr_b16 v[58:59], v98 offset:5120
    ds_read_b64_tr_b16 v[60:61], v99 offset:4096
    v_mfma_f32_32x32x16_bf16 v[144:159], v[52:55], v[64:67], v[144:159]
    ds_read_b64_tr_b16 v[62:63], v99 offset:5120
    ds_read_b128 v[80:83], v101 offset:4096
    ds_read_b128 v[84:87], v101 offset:12288
    s_add_u32 s39, s40, 16384
    v_mfma_f32_32x32x16_bf16 v[160:175], v[48:51], v[68:71], v[160:175]
    ds_read_b128 v[88:91], v101 offset:20480
    v_mfma_f32_32x32x16_bf16 v[176:191], v[52:55], v[68:71], v[176:191]
    buffer_load_dword v21, v20, s[20:23], s39 offen
    v_mfma_f32_32x32x16_bf16 v[192:207], v[48:51], v[72:75], v[192:207]
    v_mfma_f32_32x32x16_bf16 v[208:223], v[52:55], v[72:75], v[208:223]
    s_waitcnt lgkmcnt(0)
    v_mfma_f32_32x32x16_bf16 v[128:143], v[56:59], v[80:83], v[128:143]
    ds_read_b64_tr_b16 v[48:49], v98 offset:8192
    ds_read_b64_tr_b16 v[50:51], v98 offset:9216
    ds_read_b64_tr_b16 v[52:53], v99 offset:8192
    v_mfma_f32_32x32x16_bf16 v[144:159], v[60:63], v[80:83], v[144:159]
    ds_read_b64_tr_b16 v[54:55], v99 offset:9216
    ds_read_b128 v[64:67], v102 offset:4096
    ds_read_b128 v[68:71], v102 offset:12288
    v_mfma_f32_32x32x16_bf16 v[160:175], v[56:59], v[84:87], v[160:175]
    ds_read_b128 v[72:75], v102 offset:20480
    v_mfma_f32_32x32x16_bf16 v[176:191], v[60:63], v[84:87], v[176:191]
    v_mfma_f32_32x32x16_bf16 v[192:207], v[56:59], v[88:91], v[192:207]
    v_mfma_f32_32x32x16_bf16 v[208:223], v[60:63], v[88:91], v[208:223]
    s_waitcnt lgkmcnt(0)
    v_mfma_f32_32x32x16_bf16 v[128:143], v[48:51], v[64:67], v[128:143]
    ds_read_b64_tr_b16 v[56:57], v98 offset:12288
    ds_read_b64_tr_b16 v[58:59], v98 offset:13312
    ds_read_b64_tr_b16 v[60:61], v99 offset:12288
    v_mfma_f32_32x32x16_bf16 v[144:159], v[52:55], v[64:67], v[144:159]
    ds_read_b64_tr_b16 v[62:63], v99 offset:13312
    ds_read_b128 v[80:83], v103 offset:4096
    ds_read_b128 v[84:87], v103 offset:12288
    v_mfma_f32_32x32x16_bf16 v[160:175], v[48:51], v[68:71], v[160:175]
    ds_read_b128 v[88:91], v103 offset:20480
    v_add_u32 v96, 40960, v96
    v_add_u32 v97, 40960, v97
    v_mfma_f32_32x32x16_bf16 v[176:191], v[52:55], v[68:71], v[176:191]
    v_add_u32 v98, 40960, v98
    v_add_u32 v99, 40960, v99
    v_mfma_f32_32x32x16_bf16 v[192:207], v[48:51], v[72:75], v[192:207]
    v_add_u32 v100, 40960, v100
    v_add_u32 v101, 40960, v101
    v_mfma_f32_32x32x16_bf16 v[208:223], v[52:55], v[72:75], v[208:223]
    v_add_u32 v102, 40960, v102
    v_add_u32 v103, 40960, v103
    s_waitcnt lgkmcnt(0)
    s_barrier
    v_mfma_f32_32x32x16_bf16 v[128:143], v[56:59], v[80:83], v[128:143]
    ds_read_b64_tr_b16 v[48:49], v98 offset:0
    ds_read_b64_tr_b16 v[50:51], v98 offset:1024
    ds_read_b64_tr_b16 v[52:53], v99 offset:0
    v_mfma_f32_32x32x16_bf16 v[144:159], v[60:63], v[80:83], v[144:159]
    ds_read_b64_tr_b16 v[54:55], v99 offset:1024
    ds_read_b128 v[64:67], v100 offset:4096
    ds_read_b128 v[68:71], v100 offset:12288
    v_mfma_f32_32x32x16_bf16 v[160:175], v[56:59], v[84:87], v[160:175]
    ds_read_b128 v[72:75], v100 offset:20480
    v_mfma_f32_32x32x16_bf16 v[176:191], v[60:63], v[84:87], v[176:191]
    v_mfma_f32_32x32x16_bf16 v[192:207], v[56:59], v[88:91], v[192:207]
    v_mfma_f32_32x32x16_bf16 v[208:223], v[60:63], v[88:91], v[208:223]
    s_waitcnt lgkmcnt(0)
    v_mfma_f32_32x32x16_bf16 v[128:143], v[48:51], v[64:67], v[128:143]
    ds_read_b64_tr_b16 v[56:57], v98 offset:4096
    ds_read_b64_tr_b16 v[58:59], v98 offset:5120
    ds_read_b64_tr_b16 v[60:61], v99 offset:4096
    v_mfma_f32_32x32x16_bf16 v[144:159], v[52:55], v[64:67], v[144:159]
    ds_read_b64_tr_b16 v[62:63], v99 offset:5120
    ds_read_b128 v[80:83], v101 offset:4096
    ds_read_b128 v[84:87], v101 offset:12288
    s_add_u32 s39, s40, 24576
    v_mfma_f32_32x32x16_bf16 v[160:175], v[48:51], v[68:71], v[160:175]
    ds_read_b128 v[88:91], v101 offset:20480
    v_mfma_f32_32x32x16_bf16 v[176:191], v[52:55], v[68:71], v[176:191]
    buffer_load_dword v21, v20, s[20:23], s39 offen
    v_mfma_f32_32x32x16_bf16 v[192:207], v[48:51], v[72:75], v[192:207]
    v_mfma_f32_32x32x16_bf16 v[208:223], v[52:55], v[72:75], v[208:223]
    s_waitcnt lgkmcnt(0)
    v_mfma_f32_32x32x16_bf16 v[128:143], v[56:59], v[80:83], v[128:143]
    ds_read_b64_tr_b16 v[48:49], v98 offset:8192
    ds_read_b64_tr_b16 v[50:51], v98 offset:9216
    ds_read_b64_tr_b16 v[52:53], v99 offset:8192
    v_mfma_f32_32x32x16_bf16 v[144:159], v[60:63], v[80:83], v[144:159]
    ds_read_b64_tr_b16 v[54:55], v99 offset:9216
    ds_read_b128 v[64:67], v102 offset:4096
    ds_read_b128 v[68:71], v102 offset:12288
    v_mfma_f32_32x32x16_bf16 v[160:175], v[56:59], v[84:87], v[160:175]
    ds_read_b128 v[72:75], v102 offset:20480
    v_mfma_f32_32x32x16_bf16 v[176:191], v[60:63], v[84:87], v[176:191]
    v_mfma_f32_32x32x16_bf16 v[192:207], v[56:59], v[88:91], v[192:207]
    v_mfma_f32_32x32x16_bf16 v[208:223], v[60:63], v[88:91], v[208:223]
    s_waitcnt lgkmcnt(0)
    v_mfma_f32_32x32x16_bf16 v[128:143], v[48:51], v[64:67], v[128:143]
    ds_read_b64_tr_b16 v[56:57], v98 offset:12288
    ds_read_b64_tr_b16 v[58:59], v98 offset:13312
    ds_read_b64_tr_b16 v[60:61], v99 offset:12288
    v_mfma_f32_32x32x16_bf16 v[144:159], v[52:55], v[64:67], v[144:159]
    ds_read_b64_tr_b16 v[62:63], v99 offset:13312
    ds_read_b128 v[80:83], v103 offset:4096
    ds_read_b128 v[84:87], v103 offset:12288
    v_mfma_f32_32x32x16_bf16 v[160:175], v[48:51], v[68:71], v[160:175]
    ds_read_b128 v[88:91], v103 offset:20480
    v_add_u32 v96, 40960, v96
    v_add_u32 v97, 40960, v97
    v_mfma_f32_32x32x16_bf16 v[176:191], v[52:55], v[68:71], v[176:191]
    v_add_u32 v98, 40960, v98
    v_add_u32 v99, 40960, v99
    v_mfma_f32_32x32x16_bf16 v[192:207], v[48:51], v[72:75], v[192:207]
    v_subrev_u32 v100, 90112, v100
    v_subrev_u32 v101, 90112, v101
    v_mfma_f32_32x32x16_bf16 v[208:223], v[52:55], v[72:75], v[208:223]
    v_subrev_u32 v102, 90112, v102
    v_subrev_u32 v103, 90112, v103
    s_waitcnt lgkmcnt(0)
    s_barrier
    v_mfma_f32_32x32x16_bf16 v[128:143], v[56:59], v[80:83], v[128:143]
    ds_read_b64_tr_b16 v[48:49], v98 offset:0
    ds_read_b64_tr_b16 v[50:51], v98 offset:1024
    ds_read_b64_tr_b16 v[52:53], v99 offset:0
    v_mfma_f32_32x32x16_bf16 v[144:159], v[60:63], v[80:83], v[144:159]
    ds_read_b64_tr_b16 v[54:55], v99 offset:1024
    ds_read_b128 v[64:67], v100 offset:4096
    ds_read_b128 v[68:71], v100 offset:12288
    v_mfma_f32_32x32x16_bf16 v[160:175], v[56:59], v[84:87], v[160:175]
    ds_read_b128 v[72:75], v100 offset:20480
    v_mfma_f32_32x32x16_bf16 v[176:191], v[60:63], v[84:87], v[176:191]
    v_mfma_f32_32x32x16_bf16 v[192:207], v[56:59], v[88:91], v[192:207]
    v_mfma_f32_32x32x16_bf16 v[208:223], v[60:63], v[88:91], v[208:223]
    s_waitcnt lgkmcnt(0)
    v_mfma_f32_32x32x16_bf16 v[128:143], v[48:51], v[64:67], v[128:143]
    ds_read_b64_tr_b16 v[56:57], v98 offset:4096
    ds_read_b64_tr_b16 v[58:59], v98 offset:5120
    ds_read_b64_tr_b16 v[60:61], v99 offset:4096
    v_mfma_f32_32x32x16_bf16 v[144:159], v[52:55], v[64:67], v[144:159]
    ds_read_b64_tr_b16 v[62:63], v99 offset:5120
    ds_read_b128 v[80:83], v101 offset:4096
    ds_read_b128 v[84:87], v101 offset:12288
    s_add_u32 s39, s40, 32768
    v_mfma_f32_32x32x16_bf16 v[160:175], v[48:51], v[68:71], v[160:175]
    ds_read_b128 v[88:91], v101 offset:20480
    v_mfma_f32_32x32x16_bf16 v[176:191], v[52:55], v[68:71], v[176:191]
    buffer_load_dword v21, v20, s[20:23], s39 offen
    v_mfma_f32_32x32x16_bf16 v[192:207], v[48:51], v[72:75], v[192:207]
    v_mfma_f32_32x32x16_bf16 v[208:223], v[52:55], v[72:75], v[208:223]
    s_waitcnt lgkmcnt(0)
    v_mfma_f32_32x32x16_bf16 v[128:143], v[56:59], v[80:83], v[128:143]
    ds_read_b64_tr_b16 v[48:49], v98 offset:8192
    ds_read_b64_tr_b16 v[50:51], v98 offset:9216
    ds_read_b64_tr_b16 v[52:53], v99 offset:8192
    v_mfma_f32_32x32x16_bf16 v[144:159], v[60:63], v[80:83], v[144:159]
    ds_read_b64_tr_b16 v[54:55], v99 offset:9216
    ds_read_b128 v[64:67], v102 offset:4096
    ds_read_b128 v[68:71], v102 offset:12288
    v_mfma_f32_32x32x16_bf16 v[160:175], v[56:59], v[84:87], v[160:175]
    ds_read_b128 v[72:75], v102 offset:20480
    v_mfma_f32_32x32x16_bf16 v[176:191], v[60:63], v[84:87], v[176:191]
    v_mfma_f32_32x32x16_bf16 v[192:207], v[56:59], v[88:91], v[192:207]
    v_mfma_f32_32x32x16_bf16 v[208:223], v[60:63], v[88:91], v[208:223]
    s_waitcnt lgkmcnt(0)
    v_mfma_f32_32x32x16_bf16 v[128:143], v[48:51], v[64:67], v[128:143]
    ds_read_b64_tr_b16 v[56:57], v98 offset:12288
    ds_read_b64_tr_b16 v[58:59], v98 offset:13312
    ds_read_b64_tr_b16 v[60:61], v99 offset:12288
    v_mfma_f32_32x32x16_bf16 v[144:159], v[52:55], v[64:67], v[144:159]
    ds_read_b64_tr_b16 v[62:63], v99 offset:13312
    ds_read_b128 v[80:83], v103 offset:4096
    ds_read_b128 v[84:87], v103 offset:12288
    v_mfma_f32_32x32x16_bf16 v[160:175], v[48:51], v[68:71], v[160:175]
    ds_read_b128 v[88:91], v103 offset:20480
    v_subrev_u32 v96, 81920, v96
    v_subrev_u32 v97, 81920, v97
    v_mfma_f32_32x32x16_bf16 v[176:191], v[52:55], v[68:71], v[176:191]
    v_subrev_u32 v98, 81920, v98
    v_subrev_u32 v99, 81920, v99
    v_mfma_f32_32x32x16_bf16 v[192:207], v[48:51], v[72:75], v[192:207]
    v_add_u32 v100, 49152, v100
    v_add_u32 v101, 49152, v101
    v_mfma_f32_32x32x16_bf16 v[208:223], v[52:55], v[72:75], v[208:223]
    v_add_u32 v102, 49152, v102
    v_add_u32 v103, 49152, v103
    s_waitcnt lgkmcnt(0)
    s_barrier
    v_mfma_f32_32x32x16_bf16 v[128:143], v[56:59], v[80:83], v[128:143]
    ds_read_b64_tr_b16 v[48:49], v98 offset:0
    ds_read_b64_tr_b16 v[50:51], v98 offset:1024
    ds_read_b64_tr_b16 v[52:53], v99 offset:0
    v_mfma_f32_32x32x16_bf16 v[144:159], v[60:63], v[80:83], v[144:159]
    ds_read_b64_tr_b16 v[54:55], v99 offset:1024
    ds_read_b128 v[64:67], v100 offset:4096
    ds_read_b128 v[68:71], v100 offset:12288
    v_mfma_f32_32x32x16_bf16 v[160:175], v[56:59], v[84:87], v[160:175]
    ds_read_b128 v[72:75], v100 offset:20480
    v_mfma_f32_32x32x16_bf16 v[176:191], v[60:63], v[84:87], v[176:191]
    v_mfma_f32_32x32x16_bf16 v[192:207], v[56:59], v[88:91], v[192:207]
    v_mfma_f32_32x32x16_bf16 v[208:223], v[60:63], v[88:91], v[208:223]
    s_waitcnt lgkmcnt(0)
    v_mfma_f32_32x32x16_bf16 v[128:143], v[48:51], v[64:67], v[128:143]
    ds_read_b64_tr_b16 v[56:57], v98 offset:4096
    ds_read_b64_tr_b16 v[58:59], v98 offset:5120
    ds_read_b64_tr_b16 v[60:61], v99 offset:4096
    v_mfma_f32_32x32x16_bf16 v[144:159], v[52:55], v[64:67], v[144:159]
    ds_read_b64_tr_b16 v[62:63], v99 offset:5120
    ds_read_b128 v[80:83], v101 offset:4096
    ds_read_b128 v[84:87], v101 offset:12288
    v_mfma_f32_32x32x16_bf16 v[160:175], v[48:51], v[68:71], v[160:175]
    ds_read_b128 v[88:91], v101 offset:20480
    v_mfma_f32_32x32x16_bf16 v[176:191], v[52:55], v[68:71], v[176:191]
    v_mfma_f32_32x32x16_bf16 v[192:207], v[48:51], v[72:75], v[192:207]
    v_mfma_f32_32x32x16_bf16 v[208:223], v[52:55], v[72:75], v[208:223]
    s_waitcnt lgkmcnt(0)
    v_mfma_f32_32x32x16_bf16 v[128:143], v[56:59], v[80:83], v[128:143]
    ds_read_b64_tr_b16 v[48:49], v98 offset:8192
    ds_read_b64_tr_b16 v[50:51], v98 offset:9216
    ds_read_b64_tr_b16 v[52:53], v99 offset:8192
    v_mfma_f32_32x32x16_bf16 v[144:159], v[60:63], v[80:83], v[144:159]
    ds_read_b64_tr_b16 v[54:55], v99 offset:9216
    ds_read_b128 v[64:67], v102 offset:4096
    ds_read_b128 v[68:71], v102 offset:12288
    v_mfma_f32_32x32x16_bf16 v[160:175], v[56:59], v[84:87], v[160:175]
    ds_read_b128 v[72:75], v102 offset:20480
    v_mfma_f32_32x32x16_bf16 v[176:191], v[60:63], v[84:87], v[176:191]
    v_mfma_f32_32x32x16_bf16 v[192:207], v[56:59], v[88:91], v[192:207]
    v_mfma_f32_32x32x16_bf16 v[208:223], v[60:63], v[88:91], v[208:223]
    s_waitcnt lgkmcnt(0)
    v_mfma_f32_32x32x16_bf16 v[128:143], v[48:51], v[64:67], v[128:143]
    ds_read_b64_tr_b16 v[56:57], v98 offset:12288
    ds_read_b64_tr_b16 v[58:59], v98 offset:13312
    ds_read_b64_tr_b16 v[60:61], v99 offset:12288
    v_mfma_f32_32x32x16_bf16 v[144:159], v[52:55], v[64:67], v[144:159]
    ds_read_b64_tr_b16 v[62:63], v99 offset:13312
    ds_read_b128 v[80:83], v103 offset:4096
    ds_read_b128 v[84:87], v103 offset:12288
    v_mfma_f32_32x32x16_bf16 v[160:175], v[48:51], v[68:71], v[160:175]
    ds_read_b128 v[88:91], v103 offset:20480
    v_add_u32 v96, 40960, v96
    v_add_u32 v97, 40960, v97
    v_mfma_f32_32x32x16_bf16 v[176:191], v[52:55], v[68:71], v[176:191]
    v_add_u32 v98, 40960, v98
    v_add_u32 v99, 40960, v99
    v_mfma_f32_32x32x16_bf16 v[192:207], v[48:51], v[72:75], v[192:207]
    v_add_u32 v100, 40960, v100
    v_add_u32 v101, 40960, v101
    v_mfma_f32_32x32x16_bf16 v[208:223], v[52:55], v[72:75], v[208:223]
    v_add_u32 v102, 40960, v102
    v_add_u32 v103, 40960, v103
    s_waitcnt lgkmcnt(0)
    s_cmp_eq_u32 s58, 15
    s_cselect_b32 s22, 0, s22
    s_barrier
    v_mfma_f32_32x32x16_bf16 v[128:143], v[56:59], v[80:83], v[128:143]
    ds_read_b64_tr_b16 v[48:49], v98 offset:0
    ds_read_b64_tr_b16 v[50:51], v98 offset:1024
    ds_read_b64_tr_b16 v[52:53], v99 offset:0
    v_mfma_f32_32x32x16_bf16 v[144:159], v[60:63], v[80:83], v[144:159]
    ds_read_b64_tr_b16 v[54:55], v99 offset:1024
    ds_read_b128 v[64:67], v100 offset:4096
    ds_read_b128 v[68:71], v100 offset:12288
    s_add_u32 s38, s97, 0
    s_and_b32 s38, s38, 262143
    s_add_u32 s38, s38, s45
    v_mfma_f32_32x32x16_bf16 v[160:175], v[56:59], v[84:87], v[160:175]
    ds_read_b128 v[72:75], v100 offset:20480
    s_mov_b32 m0, 32768
    s_add_u32 s39, s38, 0
    buffer_load_dwordx4 v16, s[12:15], s39 offen offset:0 sc1 nt lds
    v_mfma_f32_32x32x16_bf16 v[176:191], v[60:63], v[84:87], v[176:191]
    buffer_load_dwordx4 v16, s[12:15], s39 offen offset:1024 sc1 nt lds
    buffer_load_dwordx4 v16, s[12:15], s39 offen offset:2048 sc1 nt lds
    buffer_load_dwordx4 v16, s[12:15], s39 offen offset:3072 sc1 nt lds
    v_mfma_f32_32x32x16_bf16 v[192:207], v[56:59], v[88:91], v[192:207]
    s_mov_b32 m0, 36864
    s_add_u32 s39, s38, 4096
    buffer_load_dwordx4 v16, s[12:15], s39 offen offset:0 sc1 nt lds
    v_mfma_f32_32x32x16_bf16 v[208:223], v[60:63], v[88:91], v[208:223]
    buffer_load_dwordx4 v16, s[12:15], s39 offen offset:1024 sc1 nt lds
    buffer_load_dwordx4 v16, s[12:15], s39 offen offset:2048 sc1 nt lds
    buffer_load_dwordx4 v16, s[12:15], s39 offen offset:3072 sc1 nt lds
    s_waitcnt lgkmcnt(0)
    v_mfma_f32_32x32x16_bf16 v[128:143], v[48:51], v[64:67], v[128:143]
    ds_read_b64_tr_b16 v[56:57], v98 offset:4096
    ds_read_b64_tr_b16 v[58:59], v98 offset:5120
    ds_read_b64_tr_b16 v[60:61], v99 offset:4096
    v_mfma_f32_32x32x16_bf16 v[144:159], v[52:55], v[64:67], v[144:159]
    ds_read_b64_tr_b16 v[62:63], v99 offset:5120
    ds_read_b128 v[80:83], v101 offset:4096
    ds_read_b128 v[84:87], v101 offset:12288
    s_mov_b32 m0, 40960
    s_add_u32 s39, s38, 8192
    buffer_load_dwordx4 v16, s[12:15], s39 offen offset:0 sc1 nt lds
    v_mfma_f32_32x32x16_bf16 v[160:175], v[48:51], v[68:71], v[160:175]
    ds_read_b128 v[88:91], v101 offset:20480
    buffer_load_dwordx4 v16, s[12:15], s39 offen offset:1024 sc1 nt lds
    buffer_load_dwordx4 v16, s[12:15], s39 offen offset:2048 sc1 nt lds
    v_mfma_f32_32x32x16_bf16 v[176:191], v[52:55], v[68:71], v[176:191]
    buffer_load_dwordx4 v16, s[12:15], s39 offen offset:3072 sc1 nt lds
    s_mov_b32 m0, 45056
    s_add_u32 s39, s38, 12288
    v_mfma_f32_32x32x16_bf16 v[192:207], v[48:51], v[72:75], v[192:207]
    buffer_load_dwordx4 v16, s[12:15], s39 offen offset:0 sc1 nt lds
    buffer_load_dwordx4 v16, s[12:15], s39 offen offset:1024 sc1 nt lds
    v_mfma_f32_32x32x16_bf16 v[208:223], v[52:55], v[72:75], v[208:223]
    buffer_load_dwordx4 v16, s[12:15], s39 offen offset:2048 sc1 nt lds
    buffer_load_dwordx4 v16, s[12:15], s39 offen offset:3072 sc1 nt lds
    s_waitcnt lgkmcnt(0)
    s_waitcnt vmcnt(60)
    s_waitcnt vmcnt(53)
    v_mfma_f32_32x32x16_bf16 v[128:143], v[56:59], v[80:83], v[128:143]
    ds_read_b64_tr_b16 v[48:49], v98 offset:8192
    ds_read_b64_tr_b16 v[50:51], v98 offset:9216
    ds_read_b64_tr_b16 v[52:53], v99 offset:8192
    v_mfma_f32_32x32x16_bf16 v[144:159], v[60:63], v[80:83], v[144:159]
    ds_read_b64_tr_b16 v[54:55], v99 offset:9216
    ds_read_b128 v[64:67], v102 offset:4096
    ds_read_b128 v[68:71], v102 offset:12288
    s_add_u32 s38, s97, 32768
    s_and_b32 s38, s38, 262143
    s_add_u32 s38, s38, s45
    v_mfma_f32_32x32x16_bf16 v[160:175], v[56:59], v[84:87], v[160:175]
    ds_read_b128 v[72:75], v102 offset:20480
    s_mov_b32 m0, 49152
    s_add_u32 s39, s38, 0
    buffer_load_dwordx4 v24, s[8:11], s39 offen offset:0 sc1 nt lds
    v_mfma_f32_32x32x16_bf16 v[176:191], v[60:63], v[84:87], v[176:191]
    buffer_load_dwordx4 v25, s[8:11], s39 offen offset:1024 sc1 nt lds
    buffer_load_dwordx4 v26, s[8:11], s39 offen offset:2048 sc1 nt lds
    buffer_load_dwordx4 v27, s[8:11], s39 offen offset:3072 sc1 nt lds
    v_mfma_f32_32x32x16_bf16 v[192:207], v[56:59], v[88:91], v[192:207]
    s_mov_b32 m0, 53248
    s_add_u32 s39, s38, 4096
    buffer_load_dwordx4 v24, s[8:11], s39 offen offset:0 sc1 nt lds
    v_mfma_f32_32x32x16_bf16 v[208:223], v[60:63], v[88:91], v[208:223]
    buffer_load_dwordx4 v25, s[8:11], s39 offen offset:1024 sc1 nt lds
    buffer_load_dwordx4 v26, s[8:11], s39 offen offset:2048 sc1 nt lds
    buffer_load_dwordx4 v27, s[8:11], s39 offen offset:3072 sc1 nt lds
    s_waitcnt lgkmcnt(0)
    s_waitcnt vmcnt(57)
    s_waitcnt vmcnt(53)
    v_mfma_f32_32x32x16_bf16 v[128:143], v[48:51], v[64:67], v[128:143]
    ds_read_b64_tr_b16 v[56:57], v98 offset:12288
    ds_read_b64_tr_b16 v[58:59], v98 offset:13312
    ds_read_b64_tr_b16 v[60:61], v99 offset:12288
    v_mfma_f32_32x32x16_bf16 v[144:159], v[52:55], v[64:67], v[144:159]
    ds_read_b64_tr_b16 v[62:63], v99 offset:13312
    ds_read_b128 v[80:83], v103 offset:4096
    ds_read_b128 v[84:87], v103 offset:12288
    v_mfma_f32_32x32x16_bf16 v[160:175], v[48:51], v[68:71], v[160:175]
    ds_read_b128 v[88:91], v103 offset:20480
    s_mov_b32 m0, 57344
    s_add_u32 s39, s38, 8192
    buffer_load_dwordx4 v24, s[8:11], s39 offen offset:0 sc1 nt lds
    buffer_load_dwordx4 v25, s[8:11], s39 offen offset:1024 sc1 nt lds
    buffer_load_dwordx4 v26, s[8:11], s39 offen offset:2048 sc1 nt lds
    v_mfma_f32_32x32x16_bf16 v[176:191], v[52:55], v[68:71], v[176:191]
    buffer_load_dwordx4 v27, s[8:11], s39 offen offset:3072 sc1 nt lds
    s_mov_b32 m0, 61440
    s_add_u32 s39, s38, 12288
    buffer_load_dwordx4 v24, s[8:11], s39 offen offset:0 sc1 nt lds
    buffer_load_dwordx4 v25, s[8:11], s39 offen offset:1024 sc1 nt lds
    v_mfma_f32_32x32x16_bf16 v[192:207], v[48:51], v[72:75], v[192:207]
    buffer_load_dwordx4 v26, s[8:11], s39 offen offset:2048 sc1 nt lds
    buffer_load_dwordx4 v27, s[8:11], s39 offen offset:3072 sc1 nt lds
    v_add_u32 v96, 40960, v96
    v_add_u32 v97, 40960, v97
    v_add_u32 v98, 40960, v98
    v_mfma_f32_32x32x16_bf16 v[208:223], v[52:55], v[72:75], v[208:223]
    v_add_u32 v99, 40960, v99
    v_subrev_u32 v100, 90112, v100
    v_subrev_u32 v101, 90112, v101
    v_subrev_u32 v102, 90112, v102
    v_subrev_u32 v103, 90112, v103
    s_waitcnt lgkmcnt(0)
    s_barrier
    v_mfma_f32_32x32x16_bf16 v[128:143], v[56:59], v[80:83], v[128:143]
    ds_read_b64_tr_b16 v[48:49], v98 offset:0
    ds_read_b64_tr_b16 v[50:51], v98 offset:1024
    ds_read_b64_tr_b16 v[52:53], v99 offset:0
    v_mfma_f32_32x32x16_bf16 v[144:159], v[60:63], v[80:83], v[144:159]
    ds_read_b64_tr_b16 v[54:55], v99 offset:1024
    ds_read_b128 v[64:67], v100 offset:4096
    ds_read_b128 v[68:71], v100 offset:12288
    v_mfma_f32_32x32x16_bf16 v[160:175], v[56:59], v[84:87], v[160:175]
    ds_read_b128 v[72:75], v100 offset:20480
    v_mfma_f32_32x32x16_bf16 v[176:191], v[60:63], v[84:87], v[176:191]
    v_mfma_f32_32x32x16_bf16 v[192:207], v[56:59], v[88:91], v[192:207]
    v_mfma_f32_32x32x16_bf16 v[208:223], v[60:63], v[88:91], v[208:223]
    s_waitcnt lgkmcnt(0)
    v_mfma_f32_32x32x16_bf16 v[128:143], v[48:51], v[64:67], v[128:143]
    ds_read_b64_tr_b16 v[56:57], v98 offset:4096
    ds_read_b64_tr_b16 v[58:59], v98 offset:5120
    ds_read_b64_tr_b16 v[60:61], v99 offset:4096
    v_mfma_f32_32x32x16_bf16 v[144:159], v[52:55], v[64:67], v[144:159]
    ds_read_b64_tr_b16 v[62:63], v99 offset:5120
    ds_read_b128 v[80:83], v101 offset:4096
    ds_read_b128 v[84:87], v101 offset:12288
    v_mfma_f32_32x32x16_bf16 v[160:175], v[48:51], v[68:71], v[160:175]
    ds_read_b128 v[88:91], v101 offset:20480
    v_mfma_f32_32x32x16_bf16 v[176:191], v[52:55], v[68:71], v[176:191]
    v_mfma_f32_32x32x16_bf16 v[192:207], v[48:51], v[72:75], v[192:207]
    v_mfma_f32_32x32x16_bf16 v[208:223], v[52:55], v[72:75], v[208:223]
    s_waitcnt lgkmcnt(0)
    v_mfma_f32_32x32x16_bf16 v[128:143], v[56:59], v[80:83], v[128:143]
    ds_read_b64_tr_b16 v[48:49], v98 offset:8192
    ds_read_b64_tr_b16 v[50:51], v98 offset:9216
    ds_read_b64_tr_b16 v[52:53], v99 offset:8192
    v_mfma_f32_32x32x16_bf16 v[144:159], v[60:63], v[80:83], v[144:159]
    ds_read_b64_tr_b16 v[54:55], v99 offset:9216
    ds_read_b128 v[64:67], v102 offset:4096
    ds_read_b128 v[68:71], v102 offset:12288
    v_mfma_f32_32x32x16_bf16 v[160:175], v[56:59], v[84:87], v[160:175]
    ds_read_b128 v[72:75], v102 offset:20480
    v_mfma_f32_32x32x16_bf16 v[176:191], v[60:63], v[84:87], v[176:191]
    v_mfma_f32_32x32x16_bf16 v[192:207], v[56:59], v[88:91], v[192:207]
    v_mfma_f32_32x32x16_bf16 v[208:223], v[60:63], v[88:91], v[208:223]
    s_waitcnt lgkmcnt(0)
    v_mfma_f32_32x32x16_bf16 v[128:143], v[48:51], v[64:67], v[128:143]
    ds_read_b64_tr_b16 v[56:57], v98 offset:12288
    ds_read_b64_tr_b16 v[58:59], v98 offset:13312
    ds_read_b64_tr_b16 v[60:61], v99 offset:12288
    v_mfma_f32_32x32x16_bf16 v[144:159], v[52:55], v[64:67], v[144:159]
    ds_read_b64_tr_b16 v[62:63], v99 offset:13312
    ds_read_b128 v[80:83], v103 offset:4096
    ds_read_b128 v[84:87], v103 offset:12288
    v_mfma_f32_32x32x16_bf16 v[160:175], v[48:51], v[68:71], v[160:175]
    ds_read_b128 v[88:91], v103 offset:20480
    v_mfma_f32_32x32x16_bf16 v[176:191], v[52:55], v[68:71], v[176:191]
    v_mfma_f32_32x32x16_bf16 v[192:207], v[48:51], v[72:75], v[192:207]
    v_mfma_f32_32x32x16_bf16 v[208:223], v[52:55], v[72:75], v[208:223]
    s_waitcnt lgkmcnt(0)
    s_waitcnt vmcnt(37)
    s_barrier
    v_mfma_f32_32x32x16_bf16 v[128:143], v[56:59], v[80:83], v[128:143]
    v_mfma_f32_32x32x16_bf16 v[144:159], v[60:63], v[80:83], v[144:159]
    v_mfma_f32_32x32x16_bf16 v[160:175], v[56:59], v[84:87], v[160:175]
    v_mfma_f32_32x32x16_bf16 v[176:191], v[60:63], v[84:87], v[176:191]
    v_mfma_f32_32x32x16_bf16 v[192:207], v[56:59], v[88:91], v[192:207]
    v_mfma_f32_32x32x16_bf16 v[208:223], v[60:63], v[88:91], v[208:223]
    s_add_u32 s38, s97, 16384
    s_and_b32 s38, s38, 262143
    s_add_u32 s38, s38, s45
    s_mov_b32 m0, 65536
    s_add_u32 s39, s38, 0
    buffer_load_dwordx4 v16, s[12:15], s39 offen offset:0 sc1 nt lds
    buffer_load_dwordx4 v16, s[12:15], s39 offen offset:1024 sc1 nt lds
    buffer_load_dwordx4 v16, s[12:15], s39 offen offset:2048 sc1 nt lds
    buffer_load_dwordx4 v16, s[12:15], s39 offen offset:3072 sc1 nt lds
    s_mov_b32 m0, 69632
    s_add_u32 s39, s38, 4096
    buffer_load_dwordx4 v16, s[12:15], s39 offen offset:0 sc1 nt lds
    buffer_load_dwordx4 v16, s[12:15], s39 offen offset:1024 sc1 nt lds
    buffer_load_dwordx4 v16, s[12:15], s39 offen offset:2048 sc1 nt lds
    buffer_load_dwordx4 v16, s[12:15], s39 offen offset:3072 sc1 nt lds
    s_mov_b32 m0, 73728
    s_add_u32 s39, s38, 8192
    buffer_load_dwordx4 v16, s[12:15], s39 offen offset:0 sc1 nt lds
    buffer_load_dwordx4 v16, s[12:15], s39 offen offset:1024 sc1 nt lds
    buffer_load_dwordx4 v16, s[12:15], s39 offen offset:2048 sc1 nt lds
    buffer_load_dwordx4 v16, s[12:15], s39 offen offset:3072 sc1 nt lds
    s_mov_b32 m0, 77824
    s_add_u32 s39, s38, 12288
    buffer_load_dwordx4 v16, s[12:15], s39 offen offset:0 sc1 nt lds
    buffer_load_dwordx4 v16, s[12:15], s39 offen offset:1024 sc1 nt lds
    buffer_load_dwordx4 v16, s[12:15], s39 offen offset:2048 sc1 nt lds
    buffer_load_dwordx4 v16, s[12:15], s39 offen offset:3072 sc1 nt lds
    s_nop 7
    s_nop 3
    v_mul_f32 v128, s51, v128
    v_mul_f32 v129, s51, v129
    v_cvt_pk_bf16_f32 v128, v128, v129
    v_mul_f32 v130, s51, v130
    v_mul_f32 v131, s51, v131
    v_cvt_pk_bf16_f32 v129, v130, v131
    v_mul_f32 v132, s51, v132
    v_mul_f32 v133, s51, v133
    v_cvt_pk_bf16_f32 v130, v132, v133
    v_mul_f32 v134, s51, v134
    v_mul_f32 v135, s51, v135
    v_cvt_pk_bf16_f32 v131, v134, v135
    v_mul_f32 v136, s51, v136
    v_mul_f32 v137, s51, v137
    v_cvt_pk_bf16_f32 v132, v136, v137
    v_mul_f32 v138, s51, v138
    v_mul_f32 v139, s51, v139
    v_cvt_pk_bf16_f32 v133, v138, v139
    v_mul_f32 v140, s51, v140
    v_mul_f32 v141, s51, v141
    v_cvt_pk_bf16_f32 v134, v140, v141
    v_mul_f32 v142, s51, v142
    v_mul_f32 v143, s51, v143
    v_cvt_pk_bf16_f32 v135, v142, v143
    v_mul_f32 v144, s51, v144
    v_mul_f32 v145, s51, v145
    v_cvt_pk_bf16_f32 v136, v144, v145
    v_mul_f32 v146, s51, v146
    v_mul_f32 v147, s51, v147
    v_cvt_pk_bf16_f32 v137, v146, v147
    v_mul_f32 v148, s51, v148
    v_mul_f32 v149, s51, v149
    v_cvt_pk_bf16_f32 v138, v148, v149
    v_mul_f32 v150, s51, v150
    v_mul_f32 v151, s51, v151
    v_cvt_pk_bf16_f32 v139, v150, v151
    v_mul_f32 v152, s51, v152
    v_mul_f32 v153, s51, v153
    v_cvt_pk_bf16_f32 v140, v152, v153
    v_mul_f32 v154, s51, v154
    v_mul_f32 v155, s51, v155
    v_cvt_pk_bf16_f32 v141, v154, v155
    v_mul_f32 v156, s51, v156
    v_mul_f32 v157, s51, v157
    v_cvt_pk_bf16_f32 v142, v156, v157
    v_mul_f32 v158, s51, v158
    v_mul_f32 v159, s51, v159
    v_cvt_pk_bf16_f32 v143, v158, v159
    ds_write_b128 v28, v[128:131] offset:0
    ds_write_b128 v28, v[132:135] offset:1024
    ds_write_b128 v28, v[136:139] offset:2048
    ds_write_b128 v28, v[140:143] offset:3072
    v_mul_f32 v160, s51, v160
    v_mul_f32 v161, s51, v161
    v_cvt_pk_bf16_f32 v160, v160, v161
    v_mul_f32 v162, s51, v162
    v_mul_f32 v163, s51, v163
    v_cvt_pk_bf16_f32 v161, v162, v163
    v_mul_f32 v164, s51, v164
    v_mul_f32 v165, s51, v165
    v_cvt_pk_bf16_f32 v162, v164, v165
    v_mul_f32 v166, s51, v166
    v_mul_f32 v167, s51, v167
    v_cvt_pk_bf16_f32 v163, v166, v167
    v_mul_f32 v168, s51, v168
    v_mul_f32 v169, s51, v169
    v_cvt_pk_bf16_f32 v164, v168, v169
    v_mul_f32 v170, s51, v170
    v_mul_f32 v171, s51, v171
    v_cvt_pk_bf16_f32 v165, v170, v171
    v_mul_f32 v172, s51, v172
    v_mul_f32 v173, s51, v173
    v_cvt_pk_bf16_f32 v166, v172, v173
    v_mul_f32 v174, s51, v174
    v_mul_f32 v175, s51, v175
    v_cvt_pk_bf16_f32 v167, v174, v175
    v_mul_f32 v176, s51, v176
    v_mul_f32 v177, s51, v177
    v_cvt_pk_bf16_f32 v168, v176, v177
    v_mul_f32 v178, s51, v178
    v_mul_f32 v179, s51, v179
    v_cvt_pk_bf16_f32 v169, v178, v179
    v_mul_f32 v180, s51, v180
    v_mul_f32 v181, s51, v181
    v_cvt_pk_bf16_f32 v170, v180, v181
    v_mul_f32 v182, s51, v182
    v_mul_f32 v183, s51, v183
    v_cvt_pk_bf16_f32 v171, v182, v183
    v_mul_f32 v184, s51, v184
    v_mul_f32 v185, s51, v185
    v_cvt_pk_bf16_f32 v172, v184, v185
    v_mul_f32 v186, s51, v186
    v_mul_f32 v187, s51, v187
    v_cvt_pk_bf16_f32 v173, v186, v187
    v_mul_f32 v188, s51, v188
    v_mul_f32 v189, s51, v189
    v_cvt_pk_bf16_f32 v174, v188, v189
    v_mul_f32 v190, s51, v190
    v_mul_f32 v191, s51, v191
    v_cvt_pk_bf16_f32 v175, v190, v191
    ds_write_b128 v28, v[160:163] offset:8192
    ds_write_b128 v28, v[164:167] offset:9216
    ds_write_b128 v28, v[168:171] offset:10240
    ds_write_b128 v28, v[172:175] offset:11264
    v_mul_f32 v192, s51, v192
    v_mul_f32 v193, s51, v193
    v_cvt_pk_bf16_f32 v192, v192, v193
    v_mul_f32 v194, s51, v194
    v_mul_f32 v195, s51, v195
    v_cvt_pk_bf16_f32 v193, v194, v195
    v_mul_f32 v196, s51, v196
    v_mul_f32 v197, s51, v197
    v_cvt_pk_bf16_f32 v194, v196, v197
    v_mul_f32 v198, s51, v198
    v_mul_f32 v199, s51, v199
    v_cvt_pk_bf16_f32 v195, v198, v199
    v_mul_f32 v200, s51, v200
    v_mul_f32 v201, s51, v201
    v_cvt_pk_bf16_f32 v196, v200, v201
    v_mul_f32 v202, s51, v202
    v_mul_f32 v203, s51, v203
    v_cvt_pk_bf16_f32 v197, v202, v203
    v_mul_f32 v204, s51, v204
    v_mul_f32 v205, s51, v205
    v_cvt_pk_bf16_f32 v198, v204, v205
    v_mul_f32 v206, s51, v206
    v_mul_f32 v207, s51, v207
    v_cvt_pk_bf16_f32 v199, v206, v207
    v_mul_f32 v208, s51, v208
    v_mul_f32 v209, s51, v209
    v_cvt_pk_bf16_f32 v200, v208, v209
    v_mul_f32 v210, s51, v210
    v_mul_f32 v211, s51, v211
    v_cvt_pk_bf16_f32 v201, v210, v211
    v_mul_f32 v212, s51, v212
    v_mul_f32 v213, s51, v213
    v_cvt_pk_bf16_f32 v202, v212, v213
    v_mul_f32 v214, s51, v214
    v_mul_f32 v215, s51, v215
    v_cvt_pk_bf16_f32 v203, v214, v215
    v_mul_f32 v216, s51, v216
    v_mul_f32 v217, s51, v217
    v_cvt_pk_bf16_f32 v204, v216, v217
    v_mul_f32 v218, s51, v218
    v_mul_f32 v219, s51, v219
    v_cvt_pk_bf16_f32 v205, v218, v219
    v_mul_f32 v220, s51, v220
    v_mul_f32 v221, s51, v221
    v_cvt_pk_bf16_f32 v206, v220, v221
    v_mul_f32 v222, s51, v222
    v_mul_f32 v223, s51, v223
    v_cvt_pk_bf16_f32 v207, v222, v223
    ds_write_b128 v28, v[192:195] offset:16384
    ds_write_b128 v28, v[196:199] offset:17408
    ds_write_b128 v28, v[200:203] offset:18432
    ds_write_b128 v28, v[204:207] offset:19456
    s_waitcnt lgkmcnt(0)
    s_waitcnt vmcnt(52)
    s_waitcnt vmcnt(51)
    s_waitcnt vmcnt(50)
    s_waitcnt vmcnt(49)
    s_waitcnt vmcnt(48)
    s_waitcnt vmcnt(40)
    s_add_u32 s38, s97, 49152
    s_and_b32 s38, s38, 262143
    s_add_u32 s38, s38, s45
    s_mov_b32 m0, 81920
    s_add_u32 s39, s38, 0
    buffer_load_dwordx4 v24, s[8:11], s39 offen offset:0 sc1 nt lds
    buffer_load_dwordx4 v25, s[8:11], s39 offen offset:1024 sc1 nt lds
    buffer_load_dwordx4 v26, s[8:11], s39 offen offset:2048 sc1 nt lds
    buffer_load_dwordx4 v27, s[8:11], s39 offen offset:3072 sc1 nt lds
    s_mov_b32 m0, 86016
    s_add_u32 s39, s38, 4096
    buffer_load_dwordx4 v24, s[8:11], s39 offen offset:0 sc1 nt lds
    buffer_load_dwordx4 v25, s[8:11], s39 offen offset:1024 sc1 nt lds
    buffer_load_dwordx4 v26, s[8:11], s39 offen offset:2048 sc1 nt lds
    buffer_load_dwordx4 v27, s[8:11], s39 offen offset:3072 sc1 nt lds
    s_mov_b32 m0, 90112
    s_add_u32 s39, s38, 8192
    buffer_load_dwordx4 v24, s[8:11], s39 offen offset:0 sc1 nt lds
    buffer_load_dwordx4 v25, s[8:11], s39 offen offset:1024 sc1 nt lds
    buffer_load_dwordx4 v26, s[8:11], s39 offen offset:2048 sc1 nt lds
    buffer_load_dwordx4 v27, s[8:11], s39 offen offset:3072 sc1 nt lds
    s_mov_b32 m0, 94208
    s_add_u32 s39, s38, 12288
    buffer_load_dwordx4 v24, s[8:11], s39 offen offset:0 sc1 nt lds
    buffer_load_dwordx4 v25, s[8:11], s39 offen offset:1024 sc1 nt lds
    buffer_load_dwordx4 v26, s[8:11], s39 offen offset:2048 sc1 nt lds
    buffer_load_dwordx4 v27, s[8:11], s39 offen offset:3072 sc1 nt lds
    s_lshr_b32 s95, s2, 3
    s_mul_i32 s42, s95, 13
    s_lshr_b32 s42, s42, 6
    v_mul_u32_u24 v22, 1280, v1
    s_waitcnt vmcnt(48)
    s_barrier
    s_add_u32 s38, s97, 32768
    s_and_b32 s38, s38, 262143
    s_add_u32 s38, s38, s45
    s_mov_b32 m0, 98304
    s_add_u32 s39, s38, 0
    buffer_load_dwordx4 v16, s[12:15], s39 offen offset:0 sc1 nt lds
    buffer_load_dwordx4 v16, s[12:15], s39 offen offset:1024 sc1 nt lds
    buffer_load_dwordx4 v16, s[12:15], s39 offen offset:2048 sc1 nt lds
    buffer_load_dwordx4 v16, s[12:15], s39 offen offset:3072 sc1 nt lds
    s_waitcnt vmcnt(44)
    s_waitcnt vmcnt(36)
    s_waitcnt vmcnt(20)
    s_waitcnt vmcnt(4)
    s_mov_b32 m0, 102400
    s_add_u32 s39, s38, 4096
    buffer_load_dwordx4 v16, s[12:15], s39 offen offset:0 sc1 nt lds
    buffer_load_dwordx4 v16, s[12:15], s39 offen offset:1024 sc1 nt lds
    buffer_load_dwordx4 v16, s[12:15], s39 offen offset:2048 sc1 nt lds
    buffer_load_dwordx4 v16, s[12:15], s39 offen offset:3072 sc1 nt lds
    s_mov_b32 m0, 106496
    s_add_u32 s39, s38, 8192
    buffer_load_dwordx4 v16, s[12:15], s39 offen offset:0 sc1 nt lds
    buffer_load_dwordx4 v16, s[12:15], s39 offen offset:1024 sc1 nt lds
    buffer_load_dwordx4 v16, s[12:15], s39 offen offset:2048 sc1 nt lds
    buffer_load_dwordx4 v16, s[12:15], s39 offen offset:3072 sc1 nt lds
    s_mov_b32 m0, 110592
    s_add_u32 s39, s38, 12288
    buffer_load_dwordx4 v16, s[12:15], s39 offen offset:0 sc1 nt lds
    buffer_load_dwordx4 v16, s[12:15], s39 offen offset:1024 sc1 nt lds
    buffer_load_dwordx4 v16, s[12:15], s39 offen offset:2048 sc1 nt lds
    buffer_load_dwordx4 v16, s[12:15], s39 offen offset:3072 sc1 nt lds
    s_barrier
    global_load_dword v23, v19, s[32:33] sc1
    s_add_u32 s38, s97, 65536
    s_and_b32 s38, s38, 262143
    s_add_u32 s38, s38, s45
    s_mov_b32 m0, 114688
    s_add_u32 s39, s38, 0
    buffer_load_dwordx4 v24, s[8:11], s39 offen offset:0 sc1 nt lds
    buffer_load_dwordx4 v25, s[8:11], s39 offen offset:1024 sc1 nt lds
    buffer_load_dwordx4 v26, s[8:11], s39 offen offset:2048 sc1 nt lds
    buffer_load_dwordx4 v27, s[8:11], s39 offen offset:3072 sc1 nt lds
    s_waitcnt vmcnt(17)
    s_mov_b32 m0, 118784
    s_add_u32 s39, s38, 4096
    buffer_load_dwordx4 v24, s[8:11], s39 offen offset:0 sc1 nt lds
    buffer_load_dwordx4 v25, s[8:11], s39 offen offset:1024 sc1 nt lds
    buffer_load_dwordx4 v26, s[8:11], s39 offen offset:2048 sc1 nt lds
    buffer_load_dwordx4 v27, s[8:11], s39 offen offset:3072 sc1 nt lds
    s_waitcnt vmcnt(17)
    s_mov_b32 m0, 122880
    s_add_u32 s39, s38, 8192
    buffer_load_dwordx4 v24, s[8:11], s39 offen offset:0 sc1 nt lds
    buffer_load_dwordx4 v25, s[8:11], s39 offen offset:1024 sc1 nt lds
    buffer_load_dwordx4 v26, s[8:11], s39 offen offset:2048 sc1 nt lds
    buffer_load_dwordx4 v27, s[8:11], s39 offen offset:3072 sc1 nt lds
    s_waitcnt vmcnt(17)
    s_mov_b32 m0, 126976
    s_add_u32 s39, s38, 12288
    buffer_load_dwordx4 v24, s[8:11], s39 offen offset:0 sc1 nt lds
    buffer_load_dwordx4 v25, s[8:11], s39 offen offset:1024 sc1 nt lds
    buffer_load_dwordx4 v26, s[8:11], s39 offen offset:2048 sc1 nt lds
    buffer_load_dwordx4 v27, s[8:11], s39 offen offset:3072 sc1 nt lds
    s_waitcnt vmcnt(17)
    s_add_u32 s38, s97, 49152
    s_and_b32 s38, s38, 262143
    s_add_u32 s38, s38, s45
    s_mov_b32 m0, 131072
    s_add_u32 s39, s38, 0
    buffer_load_dwordx4 v16, s[12:15], s39 offen offset:0 sc1 nt lds
    buffer_load_dwordx4 v16, s[12:15], s39 offen offset:1024 sc1 nt lds
    buffer_load_dwordx4 v16, s[12:15], s39 offen offset:2048 sc1 nt lds
    buffer_load_dwordx4 v16, s[12:15], s39 offen offset:3072 sc1 nt lds
    s_waitcnt vmcnt(20)
    s_waitcnt vmcnt(16)
    s_mov_b32 m0, 135168
    s_add_u32 s39, s38, 4096
    buffer_load_dwordx4 v16, s[12:15], s39 offen offset:0 sc1 nt lds
    buffer_load_dwordx4 v16, s[12:15], s39 offen offset:1024 sc1 nt lds
    buffer_load_dwordx4 v16, s[12:15], s39 offen offset:2048 sc1 nt lds
    buffer_load_dwordx4 v16, s[12:15], s39 offen offset:3072 sc1 nt lds
    s_waitcnt vmcnt(16)
    s_mov_b32 m0, 139264
    s_add_u32 s39, s38, 8192
    buffer_load_dwordx4 v16, s[12:15], s39 offen offset:0 sc1 nt lds
    buffer_load_dwordx4 v16, s[12:15], s39 offen offset:1024 sc1 nt lds
    buffer_load_dwordx4 v16, s[12:15], s39 offen offset:2048 sc1 nt lds
    buffer_load_dwordx4 v16, s[12:15], s39 offen offset:3072 sc1 nt lds
    s_waitcnt vmcnt(16)
    s_mov_b32 m0, 143360
    s_add_u32 s39, s38, 12288
    buffer_load_dwordx4 v16, s[12:15], s39 offen offset:0 sc1 nt lds
    buffer_load_dwordx4 v16, s[12:15], s39 offen offset:1024 sc1 nt lds
    buffer_load_dwordx4 v16, s[12:15], s39 offen offset:2048 sc1 nt lds
    buffer_load_dwordx4 v16, s[12:15], s39 offen offset:3072 sc1 nt lds
    s_waitcnt vmcnt(16)
    v_cmp_ne_u32 vcc, 0, v23
    s_cmp_eq_u64 vcc, -1
    s_cbranch_scc1 L_polled_tag
    s_mov_b32 s93, 0x20000
L_poll_tag:
    s_sleep 4
    global_load_dword v23, v19, s[32:33] sc1
    s_waitcnt vmcnt(0)
    v_cmp_ne_u32 vcc, 0, v23
    s_cmp_eq_u64 vcc, -1
    s_cbranch_scc1 L_polled_tag
    s_sub_u32 s93, s93, 1
    s_cmp_lg_u32 s93, 0
    s_cbranch_scc1 L_poll_tag
L_polled_tag:
    v_readfirstlane_b32 s96, v23
    s_barrier
    s_and_b32 s38, s2, 7
    s_lshl_b32 s38, s38, 7
    s_add_u32 s38, s38, 12615680
    v_and_b32 v33, 31, v1
    v_lshlrev_b32 v33, 2, v33
    v_add_u32 v33, s38, v33
    s_lshr_b32 s40, s2, 3
    s_lshl_b32 s40, s40, 2
    s_add_u32 s38, s38, s40
    v_mov_b32 v32, s38
    s_mov_b32 s95, 0
    s_add_u32 s38, s96, 8
    v_mov_b32 v35, s38
    s_mov_b64 exec, 1
    buffer_store_dword v35, v32, s[28:31], 0 offen
    s_mov_b64 exec, -1
    buffer_load_dword v34, v33, s[28:31], 0 offen sc1
    s_add_u32 s38, s97, 81920
    s_and_b32 s38, s38, 262143
    s_add_u32 s38, s38, s45
    s_mov_b32 m0, 147456
    s_add_u32 s39, s38, 0
    buffer_load_dwordx4 v24, s[8:11], s39 offen offset:0 sc1 nt lds
    buffer_load_dwordx4 v25, s[8:11], s39 offen offset:1024 sc1 nt lds
    buffer_load_dwordx4 v26, s[8:11], s39 offen offset:2048 sc1 nt lds
    buffer_load_dwordx4 v27, s[8:11], s39 offen offset:3072 sc1 nt lds
    s_waitcnt vmcnt(18)
    s_mov_b32 m0, 151552
    s_add_u32 s39, s38, 4096
    buffer_load_dwordx4 v24, s[8:11], s39 offen offset:0 sc1 nt lds
    buffer_load_dwordx4 v25, s[8:11], s39 offen offset:1024 sc1 nt lds
    buffer_load_dwordx4 v26, s[8:11], s39 offen offset:2048 sc1 nt lds
    buffer_load_dwordx4 v27, s[8:11], s39 offen offset:3072 sc1 nt lds
    s_waitcnt vmcnt(18)
    s_mov_b32 m0, 155648
    s_add_u32 s39, s38, 8192
    buffer_load_dwordx4 v24, s[8:11], s39 offen offset:0 sc1 nt lds
    buffer_load_dwordx4 v25, s[8:11], s39 offen offset:1024 sc1 nt lds
    buffer_load_dwordx4 v26, s[8:11], s39 offen offset:2048 sc1 nt lds
    buffer_load_dwordx4 v27, s[8:11], s39 offen offset:3072 sc1 nt lds
    s_waitcnt vmcnt(18)
    s_mov_b32 m0, 159744
    s_add_u32 s39, s38, 12288
    buffer_load_dwordx4 v24, s[8:11], s39 offen offset:0 sc1 nt lds
    buffer_load_dwordx4 v25, s[8:11], s39 offen offset:1024 sc1 nt lds
    buffer_load_dwordx4 v26, s[8:11], s39 offen offset:2048 sc1 nt lds
    buffer_load_dwordx4 v27, s[8:11], s39 offen offset:3072 sc1 nt lds
    s_waitcnt vmcnt(18)
    s_add_u32 s38, s97, 65536
    s_and_b32 s38, s38, 262143
    s_add_u32 s38, s38, s45
    s_mov_b32 m0, 32768
    s_add_u32 s39, s38, 0
    buffer_load_dwordx4 v16, s[12:15], s39 offen offset:0 sc1 nt lds
    buffer_load_dwordx4 v16, s[12:15], s39 offen offset:1024 sc1 nt lds
    buffer_load_dwordx4 v16, s[12:15], s39 offen offset:2048 sc1 nt lds
    buffer_load_dwordx4 v16, s[12:15], s39 offen offset:3072 sc1 nt lds
    s_waitcnt vmcnt(21)
    s_waitcnt vmcnt(20)
    s_waitcnt vmcnt(16)
    s_mov_b32 m0, 36864
    s_add_u32 s39, s38, 4096
    buffer_load_dwordx4 v16, s[12:15], s39 offen offset:0 sc1 nt lds
    buffer_load_dwordx4 v16, s[12:15], s39 offen offset:1024 sc1 nt lds
    buffer_load_dwordx4 v16, s[12:15], s39 offen offset:2048 sc1 nt lds
    buffer_load_dwordx4 v16, s[12:15], s39 offen offset:3072 sc1 nt lds
    s_waitcnt vmcnt(16)
    s_mov_b32 m0, 40960
    s_add_u32 s39, s38, 8192
    buffer_load_dwordx4 v16, s[12:15], s39 offen offset:0 sc1 nt lds
    buffer_load_dwordx4 v16, s[12:15], s39 offen offset:1024 sc1 nt lds
    buffer_load_dwordx4 v16, s[12:15], s39 offen offset:2048 sc1 nt lds
    buffer_load_dwordx4 v16, s[12:15], s39 offen offset:3072 sc1 nt lds
    s_waitcnt vmcnt(16)
    s_mov_b32 m0, 45056
    s_add_u32 s39, s38, 12288
    buffer_load_dwordx4 v16, s[12:15], s39 offen offset:0 sc1 nt lds
    buffer_load_dwordx4 v16, s[12:15], s39 offen offset:1024 sc1 nt lds
    buffer_load_dwordx4 v16, s[12:15], s39 offen offset:2048 sc1 nt lds
    buffer_load_dwordx4 v16, s[12:15], s39 offen offset:3072 sc1 nt lds
    s_waitcnt vmcnt(16)
    s_waitcnt lgkmcnt(0)
    s_add_u32 s40, s90, 3932160
    s_add_u32 s38, s94, 0
    s_and_b32 s38, s38, 15
    s_mul_i32 s38, s38, 81920
    s_add_u32 s38, s38, s40
    s_mov_b32 m0, 24576
    s_add_u32 s39, s38, 0
    buffer_load_dwordx4 v12, s[20:23], s39 offen offset:0 sc1 lds
    buffer_load_dwordx4 v13, s[20:23], s39 offen offset:1024 sc1 lds
    buffer_load_dwordx4 v14, s[20:23], s39 offen offset:2048 sc1 lds
    buffer_load_dwordx4 v15, s[20:23], s39 offen offset:3072 sc1 lds
    s_mov_b32 m0, 28672
    s_add_u32 s39, s38, 40960
    buffer_load_dwordx4 v12, s[20:23], s39 offen offset:0 sc1 lds
    buffer_load_dwordx4 v13, s[20:23], s39 offen offset:1024 sc1 lds
    buffer_load_dwordx4 v14, s[20:23], s39 offen offset:2048 sc1 lds
    buffer_load_dwordx4 v15, s[20:23], s39 offen offset:3072 sc1 lds
    s_barrier
    s_add_u32 s38, s96, 12
    v_mov_b32 v35, s38
    s_mov_b64 exec, 1
    buffer_store_dword v35, v32, s[28:31], 0 offen
    s_mov_b64 exec, -1
    v_subrev_u32 v34, s96, v34
    v_subrev_u32 v34, 12, v34
    v_cmp_gt_u32 vcc, 64, v34
    s_bcnt1_i32_b32 s95, vcc_lo
    buffer_load_dword v34, v33, s[28:31], 0 offen sc1
    s_add_u32 s38, s97, 98304
    s_and_b32 s38, s38, 262143
    s_add_u32 s38, s38, s45
    s_mov_b32 m0, 49152
    s_add_u32 s39, s38, 0
    buffer_load_dwordx4 v24, s[8:11], s39 offen offset:0 sc1 nt lds
    buffer_load_dwordx4 v25, s[8:11], s39 offen offset:1024 sc1 nt lds
    buffer_load_dwordx4 v26, s[8:11], s39 offen offset:2048 sc1 nt lds
    buffer_load_dwordx4 v27, s[8:11], s39 offen offset:3072 sc1 nt lds
    s_cmp_ge_u32 s95, 4
    s_cbranch_scc1 L_deep11_4
    s_waitcnt vmcnt(28)
L_deep11_4:
    s_mov_b32 m0, 53248
    s_add_u32 s39, s38, 4096
    buffer_load_dwordx4 v24, s[8:11], s39 offen offset:0 sc1 nt lds
    buffer_load_dwordx4 v25, s[8:11], s39 offen offset:1024 sc1 nt lds
    buffer_load_dwordx4 v26, s[8:11], s39 offen offset:2048 sc1 nt lds
    buffer_load_dwordx4 v27, s[8:11], s39 offen offset:3072 sc1 nt lds
    s_cmp_ge_u32 s95, 4
    s_cbranch_scc1 L_deep11_8
    s_waitcnt vmcnt(28)
L_deep11_8:
    s_mov_b32 m0, 57344
    s_add_u32 s39, s38, 8192
    buffer_load_dwordx4 v24, s[8:11], s39 offen offset:0 sc1 nt lds
    buffer_load_dwordx4 v25, s[8:11], s39 offen offset:1024 sc1 nt lds
    buffer_load_dwordx4 v26, s[8:11], s39 offen offset:2048 sc1 nt lds
    buffer_load_dwordx4 v27, s[8:11], s39 offen offset:3072 sc1 nt lds
    s_cmp_ge_u32 s95, 4
    s_cbranch_scc1 L_deep11_12
    s_waitcnt vmcnt(28)
L_deep11_12:
    s_mov_b32 m0, 61440
    s_add_u32 s39, s38, 12288
    buffer_load_dwordx4 v24, s[8:11], s39 offen offset:0 sc1 nt lds
    buffer_load_dwordx4 v25, s[8:11], s39 offen offset:1024 sc1 nt lds
    buffer_load_dwordx4 v26, s[8:11], s39 offen offset:2048 sc1 nt lds
    buffer_load_dwordx4 v27, s[8:11], s39 offen offset:3072 sc1 nt lds
    s_cmp_ge_u32 s95, 4
    s_cbranch_scc1 L_deep11
    s_waitcnt vmcnt(28)
L_deep11:
    s_add_u32 s38, s97, 81920
    s_and_b32 s38, s38, 262143
    s_add_u32 s38, s38, s45
    s_mov_b32 m0, 65536
    s_add_u32 s39, s38, 0
    buffer_load_dwordx4 v16, s[12:15], s39 offen offset:0 sc1 nt lds
    buffer_load_dwordx4 v16, s[12:15], s39 offen offset:1024 sc1 nt lds
    buffer_load_dwordx4 v16, s[12:15], s39 offen offset:2048 sc1 nt lds
    buffer_load_dwordx4 v16, s[12:15], s39 offen offset:3072 sc1 nt lds
    s_waitcnt vmcnt(42)
    s_cmp_ge_u32 s95, 4
    s_cbranch_scc1 L_deep12_4
    s_waitcnt vmcnt(18)
L_deep12_4:
    s_mov_b32 m0, 69632
    s_add_u32 s39, s38, 4096
    buffer_load_dwordx4 v16, s[12:15], s39 offen offset:0 sc1 nt lds
    buffer_load_dwordx4 v16, s[12:15], s39 offen offset:1024 sc1 nt lds
    buffer_load_dwordx4 v16, s[12:15], s39 offen offset:2048 sc1 nt lds
    buffer_load_dwordx4 v16, s[12:15], s39 offen offset:3072 sc1 nt lds
    s_waitcnt vmcnt(42)
    s_cmp_ge_u32 s95, 4
    s_cbranch_scc1 L_deep12_8
    s_waitcnt vmcnt(18)
L_deep12_8:
    s_mov_b32 m0, 73728
    s_add_u32 s39, s38, 8192
    buffer_load_dwordx4 v16, s[12:15], s39 offen offset:0 sc1 nt lds
    buffer_load_dwordx4 v16, s[12:15], s39 offen offset:1024 sc1 nt lds
    buffer_load_dwordx4 v16, s[12:15], s39 offen offset:2048 sc1 nt lds
    buffer_load_dwordx4 v16, s[12:15], s39 offen offset:3072 sc1 nt lds
    s_waitcnt vmcnt(42)
    s_cmp_ge_u32 s95, 4
    s_cbranch_scc1 L_deep12_12
    s_waitcnt vmcnt(18)
L_deep12_12:
    s_mov_b32 m0, 77824
    s_add_u32 s39, s38, 12288
    buffer_load_dwordx4 v16, s[12:15], s39 offen offset:0 sc1 nt lds
    buffer_load_dwordx4 v16, s[12:15], s39 offen offset:1024 sc1 nt lds
    buffer_load_dwordx4 v16, s[12:15], s39 offen offset:2048 sc1 nt lds
    buffer_load_dwordx4 v16, s[12:15], s39 offen offset:3072 sc1 nt lds
    s_waitcnt vmcnt(42)
    s_cmp_ge_u32 s95, 4
    s_cbranch_scc1 L_deep12
    s_waitcnt vmcnt(18)
L_deep12:
    s_barrier
    s_add_u32 s38, s96, 16
    v_mov_b32 v35, s38
    s_mov_b64 exec, 1
    buffer_store_dword v35, v32, s[28:31], 0 offen
    s_mov_b64 exec, -1
    s_waitcnt vmcnt(33)
    v_subrev_u32 v34, s96, v34
    v_subrev_u32 v34, 16, v34
    v_cmp_gt_u32 vcc, 64, v34
    s_bcnt1_i32_b32 s95, vcc_lo
    buffer_load_dword v34, v33, s[28:31], 0 offen sc1
    s_add_u32 s38, s97, 114688
    s_and_b32 s38, s38, 262143
    s_add_u32 s38, s38, s45
    s_mov_b32 m0, 81920
    s_add_u32 s39, s38, 0
    buffer_load_dwordx4 v24, s[8:11], s39 offen offset:0 sc1 nt lds
    buffer_load_dwordx4 v25, s[8:11], s39 offen offset:1024 sc1 nt lds
    buffer_load_dwordx4 v26, s[8:11], s39 offen offset:2048 sc1 nt lds
    buffer_load_dwordx4 v27, s[8:11], s39 offen offset:3072 sc1 nt lds
    s_cmp_ge_u32 s95, 4
    s_cbranch_scc1 L_deep13_4
    s_waitcnt vmcnt(20)
L_deep13_4:
    s_mov_b32 m0, 86016
    s_add_u32 s39, s38, 4096
    buffer_load_dwordx4 v24, s[8:11], s39 offen offset:0 sc1 nt lds
    buffer_load_dwordx4 v25, s[8:11], s39 offen offset:1024 sc1 nt lds
    buffer_load_dwordx4 v26, s[8:11], s39 offen offset:2048 sc1 nt lds
    buffer_load_dwordx4 v27, s[8:11], s39 offen offset:3072 sc1 nt lds
    s_cmp_ge_u32 s95, 4
    s_cbranch_scc1 L_deep13_8
    s_waitcnt vmcnt(20)
L_deep13_8:
    s_mov_b32 m0, 90112
    s_add_u32 s39, s38, 8192
    buffer_load_dwordx4 v24, s[8:11], s39 offen offset:0 sc1 nt lds
    buffer_load_dwordx4 v25, s[8:11], s39 offen offset:1024 sc1 nt lds
    buffer_load_dwordx4 v26, s[8:11], s39 offen offset:2048 sc1 nt lds
    buffer_load_dwordx4 v27, s[8:11], s39 offen offset:3072 sc1 nt lds
    s_waitcnt vmcnt(42)
    s_cmp_ge_u32 s95, 4
    s_cbranch_scc1 L_deep13_12
    s_waitcnt vmcnt(20)
L_deep13_12:
    s_mov_b32 m0, 94208
    s_add_u32 s39, s38, 12288
    buffer_load_dwordx4 v24, s[8:11], s39 offen offset:0 sc1 nt lds
    buffer_load_dwordx4 v25, s[8:11], s39 offen offset:1024 sc1 nt lds
    buffer_load_dwordx4 v26, s[8:11], s39 offen offset:2048 sc1 nt lds
    buffer_load_dwordx4 v27, s[8:11], s39 offen offset:3072 sc1 nt lds
    s_waitcnt vmcnt(42)
    s_cmp_ge_u32 s95, 4
    s_cbranch_scc1 L_deep13
    s_waitcnt vmcnt(20)
L_deep13:
    s_add_u32 s38, s97, 98304
    s_and_b32 s38, s38, 262143
    s_add_u32 s38, s38, s45
    s_mov_b32 m0, 98304
    s_add_u32 s39, s38, 0
    buffer_load_dwordx4 v16, s[12:15], s39 offen offset:0 sc1 nt lds
    buffer_load_dwordx4 v16, s[12:15], s39 offen offset:1024 sc1 nt lds
    buffer_load_dwordx4 v16, s[12:15], s39 offen offset:2048 sc1 nt lds
    buffer_load_dwordx4 v16, s[12:15], s39 offen offset:3072 sc1 nt lds
    s_waitcnt vmcnt(42)
    s_cmp_ge_u32 s95, 4
    s_cbranch_scc1 L_deep14_4
    s_waitcnt vmcnt(18)
L_deep14_4:
    s_mov_b32 m0, 102400
    s_add_u32 s39, s38, 4096
    buffer_load_dwordx4 v16, s[12:15], s39 offen offset:0 sc1 nt lds
    buffer_load_dwordx4 v16, s[12:15], s39 offen offset:1024 sc1 nt lds
    buffer_load_dwordx4 v16, s[12:15], s39 offen offset:2048 sc1 nt lds
    buffer_load_dwordx4 v16, s[12:15], s39 offen offset:3072 sc1 nt lds
    s_waitcnt vmcnt(42)
    s_cmp_ge_u32 s95, 4
    s_cbranch_scc1 L_deep14_8
    s_waitcnt vmcnt(18)
L_deep14_8:
    s_mov_b32 m0, 106496
    s_add_u32 s39, s38, 8192
    buffer_load_dwordx4 v16, s[12:15], s39 offen offset:0 sc1 nt lds
    buffer_load_dwordx4 v16, s[12:15], s39 offen offset:1024 sc1 nt lds
    buffer_load_dwordx4 v16, s[12:15], s39 offen offset:2048 sc1 nt lds
    buffer_load_dwordx4 v16, s[12:15], s39 offen offset:3072 sc1 nt lds
    s_waitcnt vmcnt(42)
    s_cmp_ge_u32 s95, 4
    s_cbranch_scc1 L_deep14_12
    s_waitcnt vmcnt(18)
L_deep14_12:
    s_mov_b32 m0, 110592
    s_add_u32 s39, s38, 12288
    buffer_load_dwordx4 v16, s[12:15], s39 offen offset:0 sc1 nt lds
    buffer_load_dwordx4 v16, s[12:15], s39 offen offset:1024 sc1 nt lds
    buffer_load_dwordx4 v16, s[12:15], s39 offen offset:2048 sc1 nt lds
    buffer_load_dwordx4 v16, s[12:15], s39 offen offset:3072 sc1 nt lds
    s_waitcnt vmcnt(42)
    s_cmp_ge_u32 s95, 4
    s_cbranch_scc1 L_deep14
    s_waitcnt vmcnt(18)
L_deep14:
    s_waitcnt vmcnt(34)
    s_barrier
    ds_read_b64_tr_b16 a[64:65], v29 offset:0
    ds_read_b64_tr_b16 a[66:67], v29 offset:1024
    ds_read_b64_tr_b16 a[68:69], v30 offset:0
    ds_read_b64_tr_b16 a[70:71], v30 offset:1024
    ds_read_b64_tr_b16 a[72:73], v29 offset:2048
    ds_read_b64_tr_b16 a[74:75], v29 offset:3072
    ds_read_b64_tr_b16 a[76:77], v30 offset:2048
    ds_read_b64_tr_b16 a[78:79], v30 offset:3072
    ds_read_b64_tr_b16 a[80:81], v29 offset:4096
    ds_read_b64_tr_b16 a[82:83], v29 offset:5120
    ds_read_b64_tr_b16 a[84:85], v30 offset:4096
    ds_read_b64_tr_b16 a[86:87], v30 offset:5120
    ds_read_b64_tr_b16 a[88:89], v29 offset:6144
    ds_read_b64_tr_b16 a[90:91], v29 offset:7168
    ds_read_b64_tr_b16 a[92:93], v30 offset:6144
    ds_read_b64_tr_b16 a[94:95], v30 offset:7168
    s_add_u32 s38, s96, 20
    v_mov_b32 v35, s38
    s_mov_b64 exec, 1
    buffer_store_dword v35, v32, s[28:31], 0 offen
    s_mov_b64 exec, -1
    s_waitcnt vmcnt(33)
    v_subrev_u32 v34, s96, v34
    v_subrev_u32 v34, 20, v34
    v_cmp_gt_u32 vcc, 64, v34
    s_bcnt1_i32_b32 s95, vcc_lo
    buffer_load_dword v34, v33, s[28:31], 0 offen sc1
    s_add_u32 s38, s97, 131072
    s_and_b32 s38, s38, 262143
    s_add_u32 s38, s38, s45
    s_mov_b32 m0, 114688
    s_add_u32 s39, s38, 0
    buffer_load_dwordx4 v24, s[8:11], s39 offen offset:0 sc1 nt lds
    buffer_load_dwordx4 v25, s[8:11], s39 offen offset:1024 sc1 nt lds
    buffer_load_dwordx4 v26, s[8:11], s39 offen offset:2048 sc1 nt lds
    buffer_load_dwordx4 v27, s[8:11], s39 offen offset:3072 sc1 nt lds
    s_cmp_ge_u32 s95, 4
    s_cbranch_scc1 L_deep15_4
    s_waitcnt vmcnt(20)
L_deep15_4:
    s_mov_b32 m0, 118784
    s_add_u32 s39, s38, 4096
    buffer_load_dwordx4 v24, s[8:11], s39 offen offset:0 sc1 nt lds
    buffer_load_dwordx4 v25, s[8:11], s39 offen offset:1024 sc1 nt lds
    buffer_load_dwordx4 v26, s[8:11], s39 offen offset:2048 sc1 nt lds
    buffer_load_dwordx4 v27, s[8:11], s39 offen offset:3072 sc1 nt lds
    s_cmp_ge_u32 s95, 4
    s_cbranch_scc1 L_deep15_8
    s_waitcnt vmcnt(20)
L_deep15_8:
    s_mov_b32 m0, 122880
    s_add_u32 s39, s38, 8192
    buffer_load_dwordx4 v24, s[8:11], s39 offen offset:0 sc1 nt lds
    buffer_load_dwordx4 v25, s[8:11], s39 offen offset:1024 sc1 nt lds
    buffer_load_dwordx4 v26, s[8:11], s39 offen offset:2048 sc1 nt lds
    buffer_load_dwordx4 v27, s[8:11], s39 offen offset:3072 sc1 nt lds
    s_waitcnt vmcnt(42)
    s_cmp_ge_u32 s95, 4
    s_cbranch_scc1 L_deep15_12
    s_waitcnt vmcnt(20)
L_deep15_12:
    s_mov_b32 m0, 126976
    s_add_u32 s39, s38, 12288
    buffer_load_dwordx4 v24, s[8:11], s39 offen offset:0 sc1 nt lds
    buffer_load_dwordx4 v25, s[8:11], s39 offen offset:1024 sc1 nt lds
    buffer_load_dwordx4 v26, s[8:11], s39 offen offset:2048 sc1 nt lds
    buffer_load_dwordx4 v27, s[8:11], s39 offen offset:3072 sc1 nt lds
    s_waitcnt vmcnt(42)
    s_cmp_ge_u32 s95, 4
    s_cbranch_scc1 L_deep15
    s_waitcnt vmcnt(20)
L_deep15:
    s_add_u32 s38, s97, 114688
    s_and_b32 s38, s38, 262143
    s_add_u32 s38, s38, s45
    s_mov_b32 m0, 131072
    s_add_u32 s39, s38, 0
    buffer_load_dwordx4 v16, s[12:15], s39 offen offset:0 sc1 nt lds
    buffer_load_dwordx4 v16, s[12:15], s39 offen offset:1024 sc1 nt lds
    buffer_load_dwordx4 v16, s[12:15], s39 offen offset:2048 sc1 nt lds
    buffer_load_dwordx4 v16, s[12:15], s39 offen offset:3072 sc1 nt lds
    s_waitcnt vmcnt(42)
    s_cmp_ge_u32 s95, 4
    s_cbranch_scc1 L_deep16_4
    s_waitcnt vmcnt(18)
L_deep16_4:
    s_mov_b32 m0, 135168
    s_add_u32 s39, s38, 4096
    buffer_load_dwordx4 v16, s[12:15], s39 offen offset:0 sc1 nt lds
    buffer_load_dwordx4 v16, s[12:15], s39 offen offset:1024 sc1 nt lds
    buffer_load_dwordx4 v16, s[12:15], s39 offen offset:2048 sc1 nt lds
    buffer_load_dwordx4 v16, s[12:15], s39 offen offset:3072 sc1 nt lds
    s_waitcnt vmcnt(42)
    s_cmp_ge_u32 s95, 4
    s_cbranch_scc1 L_deep16_8
    s_waitcnt vmcnt(18)
L_deep16_8:
    s_mov_b32 m0, 139264
    s_add_u32 s39, s38, 8192
    buffer_load_dwordx4 v16, s[12:15], s39 offen offset:0 sc1 nt lds
    buffer_load_dwordx4 v16, s[12:15], s39 offen offset:1024 sc1 nt lds
    buffer_load_dwordx4 v16, s[12:15], s39 offen offset:2048 sc1 nt lds
    buffer_load_dwordx4 v16, s[12:15], s39 offen offset:3072 sc1 nt lds
    s_waitcnt vmcnt(42)
    s_cmp_ge_u32 s95, 4
    s_cbranch_scc1 L_deep16_12
    s_waitcnt vmcnt(18)
L_deep16_12:
    s_mov_b32 m0, 143360
    s_add_u32 s39, s38, 12288
    buffer_load_dwordx4 v16, s[12:15], s39 offen offset:0 sc1 nt lds
    buffer_load_dwordx4 v16, s[12:15], s39 offen offset:1024 sc1 nt lds
    buffer_load_dwordx4 v16, s[12:15], s39 offen offset:2048 sc1 nt lds
    buffer_load_dwordx4 v16, s[12:15], s39 offen offset:3072 sc1 nt lds
    s_waitcnt vmcnt(42)
    s_cmp_ge_u32 s95, 4
    s_cbranch_scc1 L_deep16
    s_waitcnt vmcnt(18)
L_deep16:
    s_waitcnt lgkmcnt(0)
    s_add_u32 s40, s90, 3932160
    s_add_u32 s38, s94, 1
    s_and_b32 s38, s38, 15
    s_mul_i32 s38, s38, 81920
    s_add_u32 s38, s38, s40
    s_mov_b32 m0, 24576
    s_add_u32 s39, s38, 0
    buffer_load_dwordx4 v12, s[20:23], s39 offen offset:0 sc1 lds
    buffer_load_dwordx4 v13, s[20:23], s39 offen offset:1024 sc1 lds
    buffer_load_dwordx4 v14, s[20:23], s39 offen offset:2048 sc1 lds
    buffer_load_dwordx4 v15, s[20:23], s39 offen offset:3072 sc1 lds
    s_mov_b32 m0, 28672
    s_add_u32 s39, s38, 40960
    buffer_load_dwordx4 v12, s[20:23], s39 offen offset:0 sc1 lds
    buffer_load_dwordx4 v13, s[20:23], s39 offen offset:1024 sc1 lds
    buffer_load_dwordx4 v14, s[20:23], s39 offen offset:2048 sc1 lds
    buffer_load_dwordx4 v15, s[20:23], s39 offen offset:3072 sc1 lds
    s_waitcnt vmcnt(42)
    s_barrier
    s_add_u32 s38, s96, 24
    v_mov_b32 v35, s38
    s_mov_b64 exec, 1
    buffer_store_dword v35, v32, s[28:31], 0 offen
    s_mov_b64 exec, -1
    s_waitcnt vmcnt(41)
    v_subrev_u32 v34, s96, v34
    v_subrev_u32 v34, 24, v34
    v_cmp_gt_u32 vcc, 64, v34
    s_bcnt1_i32_b32 s95, vcc_lo
    buffer_load_dword v34, v33, s[28:31], 0 offen sc1
    s_add_u32 s38, s97, 147456
    s_and_b32 s38, s38, 262143
    s_add_u32 s38, s38, s45
    s_mov_b32 m0, 147456
    s_add_u32 s39, s38, 0
    buffer_load_dwordx4 v24, s[8:11], s39 offen offset:0 sc1 nt lds
    buffer_load_dwordx4 v25, s[8:11], s39 offen offset:1024 sc1 nt lds
    buffer_load_dwordx4 v26, s[8:11], s39 offen offset:2048 sc1 nt lds
    buffer_load_dwordx4 v27, s[8:11], s39 offen offset:3072 sc1 nt lds
    s_waitcnt vmcnt(42)
    s_cmp_ge_u32 s95, 4
    s_cbranch_scc1 L_deep17_4
    s_waitcnt vmcnt(28)
L_deep17_4:
    s_mov_b32 m0, 151552
    s_add_u32 s39, s38, 4096
    buffer_load_dwordx4 v24, s[8:11], s39 offen offset:0 sc1 nt lds
    buffer_load_dwordx4 v25, s[8:11], s39 offen offset:1024 sc1 nt lds
    buffer_load_dwordx4 v26, s[8:11], s39 offen offset:2048 sc1 nt lds
    buffer_load_dwordx4 v27, s[8:11], s39 offen offset:3072 sc1 nt lds
    s_waitcnt vmcnt(42)
    s_cmp_ge_u32 s95, 4
    s_cbranch_scc1 L_deep17_8
    s_waitcnt vmcnt(28)
L_deep17_8:
    s_mov_b32 m0, 155648
    s_add_u32 s39, s38, 8192
    buffer_load_dwordx4 v24, s[8:11], s39 offen offset:0 sc1 nt lds
    buffer_load_dwordx4 v25, s[8:11], s39 offen offset:1024 sc1 nt lds
    buffer_load_dwordx4 v26, s[8:11], s39 offen offset:2048 sc1 nt lds
    buffer_load_dwordx4 v27, s[8:11], s39 offen offset:3072 sc1 nt lds
    s_waitcnt vmcnt(42)
    s_cmp_ge_u32 s95, 4
    s_cbranch_scc1 L_deep17_12
    s_waitcnt vmcnt(28)
L_deep17_12:
    s_mov_b32 m0, 159744
    s_add_u32 s39, s38, 12288
    buffer_load_dwordx4 v24, s[8:11], s39 offen offset:0 sc1 nt lds
    buffer_load_dwordx4 v25, s[8:11], s39 offen offset:1024 sc1 nt lds
    buffer_load_dwordx4 v26, s[8:11], s39 offen offset:2048 sc1 nt lds
    buffer_load_dwordx4 v27, s[8:11], s39 offen offset:3072 sc1 nt lds
    s_waitcnt vmcnt(42)
    s_cmp_ge_u32 s95, 4
    s_cbranch_scc1 L_deep17
    s_waitcnt vmcnt(28)
L_deep17:
    s_add_u32 s38, s97, 131072
    s_and_b32 s38, s38, 262143
    s_add_u32 s38, s38, s45
    s_mov_b32 m0, 32768
    s_add_u32 s39, s38, 0
    buffer_load_dwordx4 v16, s[12:15], s39 offen offset:0 sc1 nt lds
    buffer_load_dwordx4 v16, s[12:15], s39 offen offset:1024 sc1 nt lds
    buffer_load_dwordx4 v16, s[12:15], s39 offen offset:2048 sc1 nt lds
    buffer_load_dwordx4 v16, s[12:15], s39 offen offset:3072 sc1 nt lds
    s_waitcnt vmcnt(42)
    s_cmp_ge_u32 s95, 4
    s_cbranch_scc1 L_deep18_4
    s_waitcnt vmcnt(18)
L_deep18_4:
    s_mov_b32 m0, 36864
    s_add_u32 s39, s38, 4096
    buffer_load_dwordx4 v16, s[12:15], s39 offen offset:0 sc1 nt lds
    buffer_load_dwordx4 v16, s[12:15], s39 offen offset:1024 sc1 nt lds
    buffer_load_dwordx4 v16, s[12:15], s39 offen offset:2048 sc1 nt lds
    buffer_load_dwordx4 v16, s[12:15], s39 offen offset:3072 sc1 nt lds
    s_waitcnt vmcnt(42)
    s_cmp_ge_u32 s95, 4
    s_cbranch_scc1 L_deep18_8
    s_waitcnt vmcnt(18)
L_deep18_8:
    s_mov_b32 m0, 40960
    s_add_u32 s39, s38, 8192
    buffer_load_dwordx4 v16, s[12:15], s39 offen offset:0 sc1 nt lds
    buffer_load_dwordx4 v16, s[12:15], s39 offen offset:1024 sc1 nt lds
    buffer_load_dwordx4 v16, s[12:15], s39 offen offset:2048 sc1 nt lds
    buffer_load_dwordx4 v16, s[12:15], s39 offen offset:3072 sc1 nt lds
    s_waitcnt vmcnt(42)
    s_cmp_ge_u32 s95, 4
    s_cbranch_scc1 L_deep18_12
    s_waitcnt vmcnt(18)
L_deep18_12:
    s_mov_b32 m0, 45056
    s_add_u32 s39, s38, 12288
    buffer_load_dwordx4 v16, s[12:15], s39 offen offset:0 sc1 nt lds
    buffer_load_dwordx4 v16, s[12:15], s39 offen offset:1024 sc1 nt lds
    buffer_load_dwordx4 v16, s[12:15], s39 offen offset:2048 sc1 nt lds
    buffer_load_dwordx4 v16, s[12:15], s39 offen offset:3072 sc1 nt lds
    s_waitcnt vmcnt(42)
    s_cmp_ge_u32 s95, 4
    s_cbranch_scc1 L_deep18
    s_waitcnt vmcnt(18)
L_deep18:
    s_barrier
    s_add_u32 s38, s96, 28
    v_mov_b32 v35, s38
    s_mov_b64 exec, 1
    buffer_store_dword v35, v32, s[28:31], 0 offen
    s_mov_b64 exec, -1
    s_waitcnt vmcnt(33)
    v_subrev_u32 v34, s96, v34
    v_subrev_u32 v34, 28, v34
    v_cmp_gt_u32 vcc, 64, v34
    s_bcnt1_i32_b32 s95, vcc_lo
    buffer_load_dword v34, v33, s[28:31], 0 offen sc1
    s_add_u32 s38, s97, 163840
    s_and_b32 s38, s38, 262143
    s_add_u32 s38, s38, s45
    s_mov_b32 m0, 49152
    s_add_u32 s39, s38, 0
    buffer_load_dwordx4 v24, s[8:11], s39 offen offset:0 sc1 nt lds
    buffer_load_dwordx4 v25, s[8:11], s39 offen offset:1024 sc1 nt lds
    buffer_load_dwordx4 v26, s[8:11], s39 offen offset:2048 sc1 nt lds
    buffer_load_dwordx4 v27, s[8:11], s39 offen offset:3072 sc1 nt lds
    s_cmp_ge_u32 s95, 4
    s_cbranch_scc1 L_deep19_4
    s_waitcnt vmcnt(20)
L_deep19_4:
    s_mov_b32 m0, 53248
    s_add_u32 s39, s38, 4096
    buffer_load_dwordx4 v24, s[8:11], s39 offen offset:0 sc1 nt lds
    buffer_load_dwordx4 v25, s[8:11], s39 offen offset:1024 sc1 nt lds
    buffer_load_dwordx4 v26, s[8:11], s39 offen offset:2048 sc1 nt lds
    buffer_load_dwordx4 v27, s[8:11], s39 offen offset:3072 sc1 nt lds
    s_cmp_ge_u32 s95, 4
    s_cbranch_scc1 L_deep19_8
    s_waitcnt vmcnt(20)
L_deep19_8:
    s_mov_b32 m0, 57344
    s_add_u32 s39, s38, 8192
    buffer_load_dwordx4 v24, s[8:11], s39 offen offset:0 sc1 nt lds
    buffer_load_dwordx4 v25, s[8:11], s39 offen offset:1024 sc1 nt lds
    buffer_load_dwordx4 v26, s[8:11], s39 offen offset:2048 sc1 nt lds
    buffer_load_dwordx4 v27, s[8:11], s39 offen offset:3072 sc1 nt lds
    s_waitcnt vmcnt(42)
    s_cmp_ge_u32 s95, 4
    s_cbranch_scc1 L_deep19_12
    s_waitcnt vmcnt(20)
L_deep19_12:
    s_mov_b32 m0, 61440
    s_add_u32 s39, s38, 12288
    buffer_load_dwordx4 v24, s[8:11], s39 offen offset:0 sc1 nt lds
    buffer_load_dwordx4 v25, s[8:11], s39 offen offset:1024 sc1 nt lds
    buffer_load_dwordx4 v26, s[8:11], s39 offen offset:2048 sc1 nt lds
    buffer_load_dwordx4 v27, s[8:11], s39 offen offset:3072 sc1 nt lds
    s_waitcnt vmcnt(42)
    s_cmp_ge_u32 s95, 4
    s_cbranch_scc1 L_deep19
    s_waitcnt vmcnt(20)
L_deep19:
    s_add_u32 s38, s97, 147456
    s_and_b32 s38, s38, 262143
    s_add_u32 s38, s38, s45
    s_mov_b32 m0, 65536
    s_add_u32 s39, s38, 0
    buffer_load_dwordx4 v16, s[12:15], s39 offen offset:0 sc1 nt lds
    buffer_load_dwordx4 v16, s[12:15], s39 offen offset:1024 sc1 nt lds
    buffer_load_dwordx4 v16, s[12:15], s39 offen offset:2048 sc1 nt lds
    buffer_load_dwordx4 v16, s[12:15], s39 offen offset:3072 sc1 nt lds
    s_waitcnt vmcnt(42)
    s_cmp_ge_u32 s95, 4
    s_cbranch_scc1 L_deep20_4
    s_waitcnt vmcnt(18)
L_deep20_4:
    s_mov_b32 m0, 69632
    s_add_u32 s39, s38, 4096
    buffer_load_dwordx4 v16, s[12:15], s39 offen offset:0 sc1 nt lds
    buffer_load_dwordx4 v16, s[12:15], s39 offen offset:1024 sc1 nt lds
    buffer_load_dwordx4 v16, s[12:15], s39 offen offset:2048 sc1 nt lds
    buffer_load_dwordx4 v16, s[12:15], s39 offen offset:3072 sc1 nt lds
    s_waitcnt vmcnt(42)
    s_cmp_ge_u32 s95, 4
    s_cbranch_scc1 L_deep20_8
    s_waitcnt vmcnt(18)
L_deep20_8:
    s_mov_b32 m0, 73728
    s_add_u32 s39, s38, 8192
    buffer_load_dwordx4 v16, s[12:15], s39 offen offset:0 sc1 nt lds
    buffer_load_dwordx4 v16, s[12:15], s39 offen offset:1024 sc1 nt lds
    buffer_load_dwordx4 v16, s[12:15], s39 offen offset:2048 sc1 nt lds
    buffer_load_dwordx4 v16, s[12:15], s39 offen offset:3072 sc1 nt lds
    s_waitcnt vmcnt(42)
    s_cmp_ge_u32 s95, 4
    s_cbranch_scc1 L_deep20_12
    s_waitcnt vmcnt(18)
L_deep20_12:
    s_mov_b32 m0, 77824
    s_add_u32 s39, s38, 12288
    buffer_load_dwordx4 v16, s[12:15], s39 offen offset:0 sc1 nt lds
    buffer_load_dwordx4 v16, s[12:15], s39 offen offset:1024 sc1 nt lds
    buffer_load_dwordx4 v16, s[12:15], s39 offen offset:2048 sc1 nt lds
    buffer_load_dwordx4 v16, s[12:15], s39 offen offset:3072 sc1 nt lds
    s_waitcnt vmcnt(42)
    s_cmp_ge_u32 s95, 4
    s_cbranch_scc1 L_deep20
    s_waitcnt vmcnt(18)
L_deep20:
    s_waitcnt vmcnt(34)
    s_barrier
    ds_read_b64_tr_b16 a[96:97], v29 offset:0
    ds_read_b64_tr_b16 a[98:99], v29 offset:1024
    ds_read_b64_tr_b16 a[100:101], v30 offset:0
    ds_read_b64_tr_b16 a[102:103], v30 offset:1024
    ds_read_b64_tr_b16 a[104:105], v29 offset:2048
    ds_read_b64_tr_b16 a[106:107], v29 offset:3072
    ds_read_b64_tr_b16 a[108:109], v30 offset:2048
    ds_read_b64_tr_b16 a[110:111], v30 offset:3072
    ds_read_b64_tr_b16 a[112:113], v29 offset:4096
    ds_read_b64_tr_b16 a[114:115], v29 offset:5120
    ds_read_b64_tr_b16 a[116:117], v30 offset:4096
    ds_read_b64_tr_b16 a[118:119], v30 offset:5120
    ds_read_b64_tr_b16 a[120:121], v29 offset:6144
    ds_read_b64_tr_b16 a[122:123], v29 offset:7168
    ds_read_b64_tr_b16 a[124:125], v30 offset:6144
    ds_read_b64_tr_b16 a[126:127], v30 offset:7168
    s_add_u32 s38, s96, 32
    v_mov_b32 v35, s38
    s_mov_b64 exec, 1
    buffer_store_dword v35, v32, s[28:31], 0 offen
    s_mov_b64 exec, -1
    s_waitcnt vmcnt(33)
    v_subrev_u32 v34, s96, v34
    v_subrev_u32 v34, 32, v34
    v_cmp_gt_u32 vcc, 64, v34
    s_bcnt1_i32_b32 s95, vcc_lo
    buffer_load_dword v34, v33, s[28:31], 0 offen sc1
    s_add_u32 s38, s97, 180224
    s_and_b32 s38, s38, 262143
    s_add_u32 s38, s38, s45
    s_mov_b32 m0, 81920
    s_add_u32 s39, s38, 0
    buffer_load_dwordx4 v24, s[8:11], s39 offen offset:0 sc1 nt lds
    buffer_load_dwordx4 v25, s[8:11], s39 offen offset:1024 sc1 nt lds
    buffer_load_dwordx4 v26, s[8:11], s39 offen offset:2048 sc1 nt lds
    buffer_load_dwordx4 v27, s[8:11], s39 offen offset:3072 sc1 nt lds
    s_cmp_ge_u32 s95, 4
    s_cbranch_scc1 L_deep21_4
    s_waitcnt vmcnt(20)
L_deep21_4:
    s_mov_b32 m0, 86016
    s_add_u32 s39, s38, 4096
    buffer_load_dwordx4 v24, s[8:11], s39 offen offset:0 sc1 nt lds
    buffer_load_dwordx4 v25, s[8:11], s39 offen offset:1024 sc1 nt lds
    buffer_load_dwordx4 v26, s[8:11], s39 offen offset:2048 sc1 nt lds
    buffer_load_dwordx4 v27, s[8:11], s39 offen offset:3072 sc1 nt lds
    s_cmp_ge_u32 s95, 4
    s_cbranch_scc1 L_deep21_8
    s_waitcnt vmcnt(20)
L_deep21_8:
    s_mov_b32 m0, 90112
    s_add_u32 s39, s38, 8192
    buffer_load_dwordx4 v24, s[8:11], s39 offen offset:0 sc1 nt lds
    buffer_load_dwordx4 v25, s[8:11], s39 offen offset:1024 sc1 nt lds
    buffer_load_dwordx4 v26, s[8:11], s39 offen offset:2048 sc1 nt lds
    buffer_load_dwordx4 v27, s[8:11], s39 offen offset:3072 sc1 nt lds
    s_waitcnt vmcnt(42)
    s_cmp_ge_u32 s95, 4
    s_cbranch_scc1 L_deep21_12
    s_waitcnt vmcnt(20)
L_deep21_12:
    s_mov_b32 m0, 94208
    s_add_u32 s39, s38, 12288
    buffer_load_dwordx4 v24, s[8:11], s39 offen offset:0 sc1 nt lds
    buffer_load_dwordx4 v25, s[8:11], s39 offen offset:1024 sc1 nt lds
    buffer_load_dwordx4 v26, s[8:11], s39 offen offset:2048 sc1 nt lds
    buffer_load_dwordx4 v27, s[8:11], s39 offen offset:3072 sc1 nt lds
    s_waitcnt vmcnt(42)
    s_cmp_ge_u32 s95, 4
    s_cbranch_scc1 L_deep21
    s_waitcnt vmcnt(20)
L_deep21:
    s_add_u32 s38, s97, 163840
    s_and_b32 s38, s38, 262143
    s_add_u32 s38, s38, s45
    s_mov_b32 m0, 98304
    s_add_u32 s39, s38, 0
    buffer_load_dwordx4 v16, s[12:15], s39 offen offset:0 sc1 nt lds
    buffer_load_dwordx4 v16, s[12:15], s39 offen offset:1024 sc1 nt lds
    buffer_load_dwordx4 v16, s[12:15], s39 offen offset:2048 sc1 nt lds
    buffer_load_dwordx4 v16, s[12:15], s39 offen offset:3072 sc1 nt lds
    s_waitcnt vmcnt(42)
    s_cmp_ge_u32 s95, 4
    s_cbranch_scc1 L_deep22_4
    s_waitcnt vmcnt(18)
L_deep22_4:
    s_mov_b32 m0, 102400
    s_add_u32 s39, s38, 4096
    buffer_load_dwordx4 v16, s[12:15], s39 offen offset:0 sc1 nt lds
    buffer_load_dwordx4 v16, s[12:15], s39 offen offset:1024 sc1 nt lds
    buffer_load_dwordx4 v16, s[12:15], s39 offen offset:2048 sc1 nt lds
    buffer_load_dwordx4 v16, s[12:15], s39 offen offset:3072 sc1 nt lds
    s_waitcnt vmcnt(42)
    s_cmp_ge_u32 s95, 4
    s_cbranch_scc1 L_deep22_8
    s_waitcnt vmcnt(18)
L_deep22_8:
    s_mov_b32 m0, 106496
    s_add_u32 s39, s38, 8192
    buffer_load_dwordx4 v16, s[12:15], s39 offen offset:0 sc1 nt lds
    buffer_load_dwordx4 v16, s[12:15], s39 offen offset:1024 sc1 nt lds
    buffer_load_dwordx4 v16, s[12:15], s39 offen offset:2048 sc1 nt lds
    buffer_load_dwordx4 v16, s[12:15], s39 offen offset:3072 sc1 nt lds
    s_waitcnt vmcnt(42)
    s_cmp_ge_u32 s95, 4
    s_cbranch_scc1 L_deep22_12
    s_waitcnt vmcnt(18)
L_deep22_12:
    s_mov_b32 m0, 110592
    s_add_u32 s39, s38, 12288
    buffer_load_dwordx4 v16, s[12:15], s39 offen offset:0 sc1 nt lds
    buffer_load_dwordx4 v16, s[12:15], s39 offen offset:1024 sc1 nt lds
    buffer_load_dwordx4 v16, s[12:15], s39 offen offset:2048 sc1 nt lds
    buffer_load_dwordx4 v16, s[12:15], s39 offen offset:3072 sc1 nt lds
    s_waitcnt vmcnt(42)
    s_cmp_ge_u32 s95, 4
    s_cbranch_scc1 L_deep22
    s_waitcnt vmcnt(18)
L_deep22:
    s_waitcnt lgkmcnt(0)
    s_add_u32 s40, s90, 3932160
    s_add_u32 s38, s94, 2
    s_and_b32 s38, s38, 15
    s_mul_i32 s38, s38, 81920
    s_add_u32 s38, s38, s40
    s_mov_b32 m0, 24576
    s_add_u32 s39, s38, 0
    buffer_load_dwordx4 v12, s[20:23], s39 offen offset:0 sc1 lds
    buffer_load_dwordx4 v13, s[20:23], s39 offen offset:1024 sc1 lds
    buffer_load_dwordx4 v14, s[20:23], s39 offen offset:2048 sc1 lds
    buffer_load_dwordx4 v15, s[20:23], s39 offen offset:3072 sc1 lds
    s_mov_b32 m0, 28672
    s_add_u32 s39, s38, 40960
    buffer_load_dwordx4 v12, s[20:23], s39 offen offset:0 sc1 lds
    buffer_load_dwordx4 v13, s[20:23], s39 offen offset:1024 sc1 lds
    buffer_load_dwordx4 v14, s[20:23], s39 offen offset:2048 sc1 lds
    buffer_load_dwordx4 v15, s[20:23], s39 offen offset:3072 sc1 lds
    s_waitcnt vmcnt(42)
    s_barrier
    s_add_u32 s38, s96, 36
    v_mov_b32 v35, s38
    s_mov_b64 exec, 1
    buffer_store_dword v35, v32, s[28:31], 0 offen
    s_mov_b64 exec, -1
    s_waitcnt vmcnt(41)
    v_subrev_u32 v34, s96, v34
    v_subrev_u32 v34, 36, v34
    v_cmp_gt_u32 vcc, 64, v34
    s_bcnt1_i32_b32 s95, vcc_lo
    buffer_load_dword v34, v33, s[28:31], 0 offen sc1
    s_add_u32 s38, s97, 196608
    s_and_b32 s38, s38, 262143
    s_add_u32 s38, s38, s45
    s_mov_b32 m0, 114688
    s_add_u32 s39, s38, 0
    buffer_load_dwordx4 v24, s[8:11], s39 offen offset:0 sc1 nt lds
    buffer_load_dwordx4 v25, s[8:11], s39 offen offset:1024 sc1 nt lds
    buffer_load_dwordx4 v26, s[8:11], s39 offen offset:2048 sc1 nt lds
    buffer_load_dwordx4 v27, s[8:11], s39 offen offset:3072 sc1 nt lds
    s_waitcnt vmcnt(42)
    s_cmp_ge_u32 s95, 4
    s_cbranch_scc1 L_deep23_4
    s_waitcnt vmcnt(28)
L_deep23_4:
    s_mov_b32 m0, 118784
    s_add_u32 s39, s38, 4096
    buffer_load_dwordx4 v24, s[8:11], s39 offen offset:0 sc1 nt lds
    buffer_load_dwordx4 v25, s[8:11], s39 offen offset:1024 sc1 nt lds
    buffer_load_dwordx4 v26, s[8:11], s39 offen offset:2048 sc1 nt lds
    buffer_load_dwordx4 v27, s[8:11], s39 offen offset:3072 sc1 nt lds
    s_waitcnt vmcnt(42)
    s_cmp_ge_u32 s95, 4
    s_cbranch_scc1 L_deep23_8
    s_waitcnt vmcnt(28)
L_deep23_8:
    s_mov_b32 m0, 122880
    s_add_u32 s39, s38, 8192
    buffer_load_dwordx4 v24, s[8:11], s39 offen offset:0 sc1 nt lds
    buffer_load_dwordx4 v25, s[8:11], s39 offen offset:1024 sc1 nt lds
    buffer_load_dwordx4 v26, s[8:11], s39 offen offset:2048 sc1 nt lds
    buffer_load_dwordx4 v27, s[8:11], s39 offen offset:3072 sc1 nt lds
    s_waitcnt vmcnt(42)
    s_cmp_ge_u32 s95, 4
    s_cbranch_scc1 L_deep23_12
    s_waitcnt vmcnt(28)
L_deep23_12:
    s_mov_b32 m0, 126976
    s_add_u32 s39, s38, 12288
    buffer_load_dwordx4 v24, s[8:11], s39 offen offset:0 sc1 nt lds
    buffer_load_dwordx4 v25, s[8:11], s39 offen offset:1024 sc1 nt lds
    buffer_load_dwordx4 v26, s[8:11], s39 offen offset:2048 sc1 nt lds
    buffer_load_dwordx4 v27, s[8:11], s39 offen offset:3072 sc1 nt lds
    s_waitcnt vmcnt(42)
    s_cmp_ge_u32 s95, 4
    s_cbranch_scc1 L_deep23
    s_waitcnt vmcnt(28)
L_deep23:
    s_add_u32 s38, s97, 180224
    s_and_b32 s38, s38, 262143
    s_add_u32 s38, s38, s45
    s_mov_b32 m0, 131072
    s_add_u32 s39, s38, 0
    buffer_load_dwordx4 v16, s[12:15], s39 offen offset:0 sc1 nt lds
    buffer_load_dwordx4 v16, s[12:15], s39 offen offset:1024 sc1 nt lds
    buffer_load_dwordx4 v16, s[12:15], s39 offen offset:2048 sc1 nt lds
    buffer_load_dwordx4 v16, s[12:15], s39 offen offset:3072 sc1 nt lds
    s_waitcnt vmcnt(42)
    s_cmp_ge_u32 s95, 4
    s_cbranch_scc1 L_deep24_4
    s_waitcnt vmcnt(18)
L_deep24_4:
    s_mov_b32 m0, 135168
    s_add_u32 s39, s38, 4096
    buffer_load_dwordx4 v16, s[12:15], s39 offen offset:0 sc1 nt lds
    buffer_load_dwordx4 v16, s[12:15], s39 offen offset:1024 sc1 nt lds
    buffer_load_dwordx4 v16, s[12:15], s39 offen offset:2048 sc1 nt lds
    buffer_load_dwordx4 v16, s[12:15], s39 offen offset:3072 sc1 nt lds
    s_waitcnt vmcnt(42)
    s_cmp_ge_u32 s95, 4
    s_cbranch_scc1 L_deep24_8
    s_waitcnt vmcnt(18)
L_deep24_8:
    s_mov_b32 m0, 139264
    s_add_u32 s39, s38, 8192
    buffer_load_dwordx4 v16, s[12:15], s39 offen offset:0 sc1 nt lds
    buffer_load_dwordx4 v16, s[12:15], s39 offen offset:1024 sc1 nt lds
    buffer_load_dwordx4 v16, s[12:15], s39 offen offset:2048 sc1 nt lds
    buffer_load_dwordx4 v16, s[12:15], s39 offen offset:3072 sc1 nt lds
    s_waitcnt vmcnt(42)
    s_cmp_ge_u32 s95, 4
    s_cbranch_scc1 L_deep24_12
    s_waitcnt vmcnt(18)
L_deep24_12:
    s_mov_b32 m0, 143360
    s_add_u32 s39, s38, 12288
    buffer_load_dwordx4 v16, s[12:15], s39 offen offset:0 sc1 nt lds
    buffer_load_dwordx4 v16, s[12:15], s39 offen offset:1024 sc1 nt lds
    buffer_load_dwordx4 v16, s[12:15], s39 offen offset:2048 sc1 nt lds
    buffer_load_dwordx4 v16, s[12:15], s39 offen offset:3072 sc1 nt lds
    s_waitcnt vmcnt(42)
    s_cmp_ge_u32 s95, 4
    s_cbranch_scc1 L_deep24
    s_waitcnt vmcnt(18)
L_deep24:
    s_barrier
    s_add_u32 s38, s96, 40
    v_mov_b32 v35, s38
    s_mov_b64 exec, 1
    buffer_store_dword v35, v32, s[28:31], 0 offen
    s_mov_b64 exec, -1
    s_waitcnt vmcnt(33)
    v_subrev_u32 v34, s96, v34
    v_subrev_u32 v34, 40, v34
    v_cmp_gt_u32 vcc, 64, v34
    s_bcnt1_i32_b32 s95, vcc_lo
    buffer_load_dword v34, v33, s[28:31], 0 offen sc1
    s_add_u32 s38, s97, 212992
    s_and_b32 s38, s38, 262143
    s_add_u32 s38, s38, s45
    s_mov_b32 m0, 147456
    s_add_u32 s39, s38, 0
    buffer_load_dwordx4 v24, s[8:11], s39 offen offset:0 sc1 nt lds
    buffer_load_dwordx4 v25, s[8:11], s39 offen offset:1024 sc1 nt lds
    buffer_load_dwordx4 v26, s[8:11], s39 offen offset:2048 sc1 nt lds
    buffer_load_dwordx4 v27, s[8:11], s39 offen offset:3072 sc1 nt lds
    s_cmp_ge_u32 s95, 4
    s_cbranch_scc1 L_deep25_4
    s_waitcnt vmcnt(20)
L_deep25_4:
    s_mov_b32 m0, 151552
    s_add_u32 s39, s38, 4096
    buffer_load_dwordx4 v24, s[8:11], s39 offen offset:0 sc1 nt lds
    buffer_load_dwordx4 v25, s[8:11], s39 offen offset:1024 sc1 nt lds
    buffer_load_dwordx4 v26, s[8:11], s39 offen offset:2048 sc1 nt lds
    buffer_load_dwordx4 v27, s[8:11], s39 offen offset:3072 sc1 nt lds
    s_cmp_ge_u32 s95, 4
    s_cbranch_scc1 L_deep25_8
    s_waitcnt vmcnt(20)
L_deep25_8:
    s_mov_b32 m0, 155648
    s_add_u32 s39, s38, 8192
    buffer_load_dwordx4 v24, s[8:11], s39 offen offset:0 sc1 nt lds
    buffer_load_dwordx4 v25, s[8:11], s39 offen offset:1024 sc1 nt lds
    buffer_load_dwordx4 v26, s[8:11], s39 offen offset:2048 sc1 nt lds
    buffer_load_dwordx4 v27, s[8:11], s39 offen offset:3072 sc1 nt lds
    s_waitcnt vmcnt(42)
    s_cmp_ge_u32 s95, 4
    s_cbranch_scc1 L_deep25_12
    s_waitcnt vmcnt(20)
L_deep25_12:
    s_mov_b32 m0, 159744
    s_add_u32 s39, s38, 12288
    buffer_load_dwordx4 v24, s[8:11], s39 offen offset:0 sc1 nt lds
    buffer_load_dwordx4 v25, s[8:11], s39 offen offset:1024 sc1 nt lds
    buffer_load_dwordx4 v26, s[8:11], s39 offen offset:2048 sc1 nt lds
    buffer_load_dwordx4 v27, s[8:11], s39 offen offset:3072 sc1 nt lds
    s_waitcnt vmcnt(42)
    s_cmp_ge_u32 s95, 4
    s_cbranch_scc1 L_deep25
    s_waitcnt vmcnt(20)
L_deep25:
    s_add_u32 s38, s97, 196608
    s_and_b32 s38, s38, 262143
    s_add_u32 s38, s38, s45
    s_mov_b32 m0, 32768
    s_add_u32 s39, s38, 0
    buffer_load_dwordx4 v16, s[12:15], s39 offen offset:0 sc1 nt lds
    buffer_load_dwordx4 v16, s[12:15], s39 offen offset:1024 sc1 nt lds
    buffer_load_dwordx4 v16, s[12:15], s39 offen offset:2048 sc1 nt lds
    buffer_load_dwordx4 v16, s[12:15], s39 offen offset:3072 sc1 nt lds
    s_waitcnt vmcnt(42)
    s_cmp_ge_u32 s95, 4
    s_cbranch_scc1 L_deep26_4
    s_waitcnt vmcnt(18)
L_deep26_4:
    s_mov_b32 m0, 36864
    s_add_u32 s39, s38, 4096
    buffer_load_dwordx4 v16, s[12:15], s39 offen offset:0 sc1 nt lds
    buffer_load_dwordx4 v16, s[12:15], s39 offen offset:1024 sc1 nt lds
    buffer_load_dwordx4 v16, s[12:15], s39 offen offset:2048 sc1 nt lds
    buffer_load_dwordx4 v16, s[12:15], s39 offen offset:3072 sc1 nt lds
    s_waitcnt vmcnt(42)
    s_cmp_ge_u32 s95, 4
    s_cbranch_scc1 L_deep26_8
    s_waitcnt vmcnt(18)
L_deep26_8:
    s_mov_b32 m0, 40960
    s_add_u32 s39, s38, 8192
    buffer_load_dwordx4 v16, s[12:15], s39 offen offset:0 sc1 nt lds
    buffer_load_dwordx4 v16, s[12:15], s39 offen offset:1024 sc1 nt lds
    buffer_load_dwordx4 v16, s[12:15], s39 offen offset:2048 sc1 nt lds
    buffer_load_dwordx4 v16, s[12:15], s39 offen offset:3072 sc1 nt lds
    s_waitcnt vmcnt(42)
    s_cmp_ge_u32 s95, 4
    s_cbranch_scc1 L_deep26_12
    s_waitcnt vmcnt(18)
L_deep26_12:
    s_mov_b32 m0, 45056
    s_add_u32 s39, s38, 12288
    buffer_load_dwordx4 v16, s[12:15], s39 offen offset:0 sc1 nt lds
    buffer_load_dwordx4 v16, s[12:15], s39 offen offset:1024 sc1 nt lds
    buffer_load_dwordx4 v16, s[12:15], s39 offen offset:2048 sc1 nt lds
    buffer_load_dwordx4 v16, s[12:15], s39 offen offset:3072 sc1 nt lds
    s_waitcnt vmcnt(42)
    s_cmp_ge_u32 s95, 4
    s_cbranch_scc1 L_deep26
    s_waitcnt vmcnt(18)
L_deep26:
    s_waitcnt vmcnt(34)
    s_barrier
    ds_read_b64_tr_b16 a[128:129], v29 offset:0
    ds_read_b64_tr_b16 a[130:131], v29 offset:1024
    ds_read_b64_tr_b16 a[132:133], v30 offset:0
    ds_read_b64_tr_b16 a[134:135], v30 offset:1024
    ds_read_b64_tr_b16 a[136:137], v29 offset:2048
    ds_read_b64_tr_b16 a[138:139], v29 offset:3072
    ds_read_b64_tr_b16 a[140:141], v30 offset:2048
    ds_read_b64_tr_b16 a[142:143], v30 offset:3072
    ds_read_b64_tr_b16 a[144:145], v29 offset:4096
    ds_read_b64_tr_b16 a[146:147], v29 offset:5120
    ds_read_b64_tr_b16 a[148:149], v30 offset:4096
    ds_read_b64_tr_b16 a[150:151], v30 offset:5120
    ds_read_b64_tr_b16 a[152:153], v29 offset:6144
    ds_read_b64_tr_b16 a[154:155], v29 offset:7168
    ds_read_b64_tr_b16 a[156:157], v30 offset:6144
    ds_read_b64_tr_b16 a[158:159], v30 offset:7168
    s_add_u32 s38, s96, 44
    v_mov_b32 v35, s38
    s_mov_b64 exec, 1
    buffer_store_dword v35, v32, s[28:31], 0 offen
    s_mov_b64 exec, -1
    s_waitcnt vmcnt(33)
    v_subrev_u32 v34, s96, v34
    v_subrev_u32 v34, 44, v34
    v_cmp_gt_u32 vcc, 64, v34
    s_bcnt1_i32_b32 s95, vcc_lo
    buffer_load_dword v34, v33, s[28:31], 0 offen sc1
    s_add_u32 s38, s97, 229376
    s_and_b32 s38, s38, 262143
    s_add_u32 s38, s38, s45
    s_mov_b32 m0, 49152
    s_add_u32 s39, s38, 0
    buffer_load_dwordx4 v24, s[8:11], s39 offen offset:0 sc1 nt lds
    buffer_load_dwordx4 v25, s[8:11], s39 offen offset:1024 sc1 nt lds
    buffer_load_dwordx4 v26, s[8:11], s39 offen offset:2048 sc1 nt lds
    buffer_load_dwordx4 v27, s[8:11], s39 offen offset:3072 sc1 nt lds
    s_cmp_ge_u32 s95, 4
    s_cbranch_scc1 L_deep27_4
    s_waitcnt vmcnt(20)
L_deep27_4:
    s_mov_b32 m0, 53248
    s_add_u32 s39, s38, 4096
    buffer_load_dwordx4 v24, s[8:11], s39 offen offset:0 sc1 nt lds
    buffer_load_dwordx4 v25, s[8:11], s39 offen offset:1024 sc1 nt lds
    buffer_load_dwordx4 v26, s[8:11], s39 offen offset:2048 sc1 nt lds
    buffer_load_dwordx4 v27, s[8:11], s39 offen offset:3072 sc1 nt lds
    s_cmp_ge_u32 s95, 4
    s_cbranch_scc1 L_deep27_8
    s_waitcnt vmcnt(20)
L_deep27_8:
    s_mov_b32 m0, 57344
    s_add_u32 s39, s38, 8192
    buffer_load_dwordx4 v24, s[8:11], s39 offen offset:0 sc1 nt lds
    buffer_load_dwordx4 v25, s[8:11], s39 offen offset:1024 sc1 nt lds
    buffer_load_dwordx4 v26, s[8:11], s39 offen offset:2048 sc1 nt lds
    buffer_load_dwordx4 v27, s[8:11], s39 offen offset:3072 sc1 nt lds
    s_waitcnt vmcnt(42)
    s_cmp_ge_u32 s95, 4
    s_cbranch_scc1 L_deep27_12
    s_waitcnt vmcnt(20)
L_deep27_12:
    s_mov_b32 m0, 61440
    s_add_u32 s39, s38, 12288
    buffer_load_dwordx4 v24, s[8:11], s39 offen offset:0 sc1 nt lds
    buffer_load_dwordx4 v25, s[8:11], s39 offen offset:1024 sc1 nt lds
    buffer_load_dwordx4 v26, s[8:11], s39 offen offset:2048 sc1 nt lds
    buffer_load_dwordx4 v27, s[8:11], s39 offen offset:3072 sc1 nt lds
    s_waitcnt vmcnt(42)
    s_cmp_ge_u32 s95, 4
    s_cbranch_scc1 L_deep27
    s_waitcnt vmcnt(20)
L_deep27:
    s_add_u32 s38, s97, 212992
    s_and_b32 s38, s38, 262143
    s_add_u32 s38, s38, s45
    s_mov_b32 m0, 65536
    s_add_u32 s39, s38, 0
    buffer_load_dwordx4 v16, s[12:15], s39 offen offset:0 sc1 nt lds
    buffer_load_dwordx4 v16, s[12:15], s39 offen offset:1024 sc1 nt lds
    buffer_load_dwordx4 v16, s[12:15], s39 offen offset:2048 sc1 nt lds
    buffer_load_dwordx4 v16, s[12:15], s39 offen offset:3072 sc1 nt lds
    s_waitcnt vmcnt(42)
    s_cmp_ge_u32 s95, 4
    s_cbranch_scc1 L_deep28_4
    s_waitcnt vmcnt(18)
L_deep28_4:
    s_mov_b32 m0, 69632
    s_add_u32 s39, s38, 4096
    buffer_load_dwordx4 v16, s[12:15], s39 offen offset:0 sc1 nt lds
    buffer_load_dwordx4 v16, s[12:15], s39 offen offset:1024 sc1 nt lds
    buffer_load_dwordx4 v16, s[12:15], s39 offen offset:2048 sc1 nt lds
    buffer_load_dwordx4 v16, s[12:15], s39 offen offset:3072 sc1 nt lds
    s_waitcnt vmcnt(42)
    s_cmp_ge_u32 s95, 4
    s_cbranch_scc1 L_deep28_8
    s_waitcnt vmcnt(18)
L_deep28_8:
    s_mov_b32 m0, 73728
    s_add_u32 s39, s38, 8192
    buffer_load_dwordx4 v16, s[12:15], s39 offen offset:0 sc1 nt lds
    buffer_load_dwordx4 v16, s[12:15], s39 offen offset:1024 sc1 nt lds
    buffer_load_dwordx4 v16, s[12:15], s39 offen offset:2048 sc1 nt lds
    buffer_load_dwordx4 v16, s[12:15], s39 offen offset:3072 sc1 nt lds
    s_waitcnt vmcnt(42)
    s_cmp_ge_u32 s95, 4
    s_cbranch_scc1 L_deep28_12
    s_waitcnt vmcnt(18)
L_deep28_12:
    s_mov_b32 m0, 77824
    s_add_u32 s39, s38, 12288
    buffer_load_dwordx4 v16, s[12:15], s39 offen offset:0 sc1 nt lds
    buffer_load_dwordx4 v16, s[12:15], s39 offen offset:1024 sc1 nt lds
    buffer_load_dwordx4 v16, s[12:15], s39 offen offset:2048 sc1 nt lds
    buffer_load_dwordx4 v16, s[12:15], s39 offen offset:3072 sc1 nt lds
    s_waitcnt vmcnt(42)
    s_cmp_ge_u32 s95, 4
    s_cbranch_scc1 L_deep28
    s_waitcnt vmcnt(18)
L_deep28:
    s_waitcnt lgkmcnt(0)
    s_add_u32 s40, s90, 3932160
    s_add_u32 s38, s94, 3
    s_and_b32 s38, s38, 15
    s_mul_i32 s38, s38, 81920
    s_add_u32 s38, s38, s40
    s_mov_b32 m0, 24576
    s_add_u32 s39, s38, 0
    buffer_load_dwordx4 v12, s[20:23], s39 offen offset:0 sc1 lds
    buffer_load_dwordx4 v13, s[20:23], s39 offen offset:1024 sc1 lds
    buffer_load_dwordx4 v14, s[20:23], s39 offen offset:2048 sc1 lds
    buffer_load_dwordx4 v15, s[20:23], s39 offen offset:3072 sc1 lds
    s_mov_b32 m0, 28672
    s_add_u32 s39, s38, 40960
    buffer_load_dwordx4 v12, s[20:23], s39 offen offset:0 sc1 lds
    buffer_load_dwordx4 v13, s[20:23], s39 offen offset:1024 sc1 lds
    buffer_load_dwordx4 v14, s[20:23], s39 offen offset:2048 sc1 lds
    buffer_load_dwordx4 v15, s[20:23], s39 offen offset:3072 sc1 lds
    s_waitcnt vmcnt(42)
    s_barrier
    s_add_u32 s38, s96, 48
    v_mov_b32 v35, s38
    s_mov_b64 exec, 1
    buffer_store_dword v35, v32, s[28:31], 0 offen
    s_mov_b64 exec, -1
    s_waitcnt vmcnt(41)
    v_subrev_u32 v34, s96, v34
    v_subrev_u32 v34, 48, v34
    v_cmp_gt_u32 vcc, 64, v34
    s_bcnt1_i32_b32 s95, vcc_lo
    buffer_load_dword v34, v33, s[28:31], 0 offen sc1
    s_add_u32 s38, s97, 245760
    s_and_b32 s38, s38, 262143
    s_add_u32 s38, s38, s45
    s_mov_b32 m0, 81920
    s_add_u32 s39, s38, 0
    buffer_load_dwordx4 v24, s[8:11], s39 offen offset:0 sc1 nt lds
    buffer_load_dwordx4 v25, s[8:11], s39 offen offset:1024 sc1 nt lds
    buffer_load_dwordx4 v26, s[8:11], s39 offen offset:2048 sc1 nt lds
    buffer_load_dwordx4 v27, s[8:11], s39 offen offset:3072 sc1 nt lds
    s_waitcnt vmcnt(42)
    s_cmp_ge_u32 s95, 4
    s_cbranch_scc1 L_deep29_4
    s_waitcnt vmcnt(28)
L_deep29_4:
    s_mov_b32 m0, 86016
    s_add_u32 s39, s38, 4096
    buffer_load_dwordx4 v24, s[8:11], s39 offen offset:0 sc1 nt lds
    buffer_load_dwordx4 v25, s[8:11], s39 offen offset:1024 sc1 nt lds
    buffer_load_dwordx4 v26, s[8:11], s39 offen offset:2048 sc1 nt lds
    buffer_load_dwordx4 v27, s[8:11], s39 offen offset:3072 sc1 nt lds
    s_waitcnt vmcnt(42)
    s_cmp_ge_u32 s95, 4
    s_cbranch_scc1 L_deep29_8
    s_waitcnt vmcnt(28)
L_deep29_8:
    s_mov_b32 m0, 90112
    s_add_u32 s39, s38, 8192
    buffer_load_dwordx4 v24, s[8:11], s39 offen offset:0 sc1 nt lds
    buffer_load_dwordx4 v25, s[8:11], s39 offen offset:1024 sc1 nt lds
    buffer_load_dwordx4 v26, s[8:11], s39 offen offset:2048 sc1 nt lds
    buffer_load_dwordx4 v27, s[8:11], s39 offen offset:3072 sc1 nt lds
    s_waitcnt vmcnt(42)
    s_cmp_ge_u32 s95, 4
    s_cbranch_scc1 L_deep29_12
    s_waitcnt vmcnt(28)
L_deep29_12:
    s_mov_b32 m0, 94208
    s_add_u32 s39, s38, 12288
    buffer_load_dwordx4 v24, s[8:11], s39 offen offset:0 sc1 nt lds
    buffer_load_dwordx4 v25, s[8:11], s39 offen offset:1024 sc1 nt lds
    buffer_load_dwordx4 v26, s[8:11], s39 offen offset:2048 sc1 nt lds
    buffer_load_dwordx4 v27, s[8:11], s39 offen offset:3072 sc1 nt lds
    s_waitcnt vmcnt(42)
    s_cmp_ge_u32 s95, 4
    s_cbranch_scc1 L_deep29
    s_waitcnt vmcnt(28)
L_deep29:
    s_add_u32 s38, s97, 229376
    s_and_b32 s38, s38, 262143
    s_add_u32 s38, s38, s45
    s_mov_b32 m0, 98304
    s_add_u32 s39, s38, 0
    buffer_load_dwordx4 v16, s[12:15], s39 offen offset:0 sc1 nt lds
    buffer_load_dwordx4 v16, s[12:15], s39 offen offset:1024 sc1 nt lds
    buffer_load_dwordx4 v16, s[12:15], s39 offen offset:2048 sc1 nt lds
    buffer_load_dwordx4 v16, s[12:15], s39 offen offset:3072 sc1 nt lds
    s_waitcnt vmcnt(42)
    s_cmp_ge_u32 s95, 4
    s_cbranch_scc1 L_deep30_4
    s_waitcnt vmcnt(18)
L_deep30_4:
    s_mov_b32 m0, 102400
    s_add_u32 s39, s38, 4096
    buffer_load_dwordx4 v16, s[12:15], s39 offen offset:0 sc1 nt lds
    buffer_load_dwordx4 v16, s[12:15], s39 offen offset:1024 sc1 nt lds
    buffer_load_dwordx4 v16, s[12:15], s39 offen offset:2048 sc1 nt lds
    buffer_load_dwordx4 v16, s[12:15], s39 offen offset:3072 sc1 nt lds
    s_waitcnt vmcnt(42)
    s_cmp_ge_u32 s95, 4
    s_cbranch_scc1 L_deep30_8
    s_waitcnt vmcnt(18)
L_deep30_8:
    s_mov_b32 m0, 106496
    s_add_u32 s39, s38, 8192
    buffer_load_dwordx4 v16, s[12:15], s39 offen offset:0 sc1 nt lds
    buffer_load_dwordx4 v16, s[12:15], s39 offen offset:1024 sc1 nt lds
    buffer_load_dwordx4 v16, s[12:15], s39 offen offset:2048 sc1 nt lds
    buffer_load_dwordx4 v16, s[12:15], s39 offen offset:3072 sc1 nt lds
    s_waitcnt vmcnt(42)
    s_cmp_ge_u32 s95, 4
    s_cbranch_scc1 L_deep30_12
    s_waitcnt vmcnt(18)
L_deep30_12:
    s_mov_b32 m0, 110592
    s_add_u32 s39, s38, 12288
    buffer_load_dwordx4 v16, s[12:15], s39 offen offset:0 sc1 nt lds
    buffer_load_dwordx4 v16, s[12:15], s39 offen offset:1024 sc1 nt lds
    buffer_load_dwordx4 v16, s[12:15], s39 offen offset:2048 sc1 nt lds
    buffer_load_dwordx4 v16, s[12:15], s39 offen offset:3072 sc1 nt lds
    s_waitcnt vmcnt(42)
    s_cmp_ge_u32 s95, 4
    s_cbranch_scc1 L_deep30
    s_waitcnt vmcnt(18)
L_deep30:
    s_barrier
    s_add_u32 s38, s96, 52
    v_mov_b32 v35, s38
    s_mov_b64 exec, 1
    buffer_store_dword v35, v32, s[28:31], 0 offen
    s_mov_b64 exec, -1
    s_waitcnt vmcnt(33)
    v_subrev_u32 v34, s96, v34
    v_subrev_u32 v34, 52, v34
    v_cmp_gt_u32 vcc, 64, v34
    s_bcnt1_i32_b32 s95, vcc_lo
    buffer_load_dword v34, v33, s[28:31], 0 offen sc1
    s_add_u32 s38, s97, 0
    s_and_b32 s38, s38, 262143
    s_add_u32 s38, s38, s45
    s_mov_b32 m0, 114688
    s_add_u32 s39, s38, 33554432
    buffer_load_dwordx4 v24, s[8:11], s39 offen offset:0 sc1 nt lds
    buffer_load_dwordx4 v25, s[8:11], s39 offen offset:1024 sc1 nt lds
    buffer_load_dwordx4 v26, s[8:11], s39 offen offset:2048 sc1 nt lds
    buffer_load_dwordx4 v27, s[8:11], s39 offen offset:3072 sc1 nt lds
    s_cmp_ge_u32 s95, 4
    s_cbranch_scc1 L_deep31_4
    s_waitcnt vmcnt(20)
L_deep31_4:
    s_mov_b32 m0, 118784
    s_add_u32 s39, s38, 33558528
    buffer_load_dwordx4 v24, s[8:11], s39 offen offset:0 sc1 nt lds
    buffer_load_dwordx4 v25, s[8:11], s39 offen offset:1024 sc1 nt lds
    buffer_load_dwordx4 v26, s[8:11], s39 offen offset:2048 sc1 nt lds
    buffer_load_dwordx4 v27, s[8:11], s39 offen offset:3072 sc1 nt lds
    s_cmp_ge_u32 s95, 4
    s_cbranch_scc1 L_deep31_8
    s_waitcnt vmcnt(20)
L_deep31_8:
    s_mov_b32 m0, 122880
    s_add_u32 s39, s38, 33562624
    buffer_load_dwordx4 v24, s[8:11], s39 offen offset:0 sc1 nt lds
    buffer_load_dwordx4 v25, s[8:11], s39 offen offset:1024 sc1 nt lds
    buffer_load_dwordx4 v26, s[8:11], s39 offen offset:2048 sc1 nt lds
    buffer_load_dwordx4 v27, s[8:11], s39 offen offset:3072 sc1 nt lds
    s_waitcnt vmcnt(42)
    s_cmp_ge_u32 s95, 4
    s_cbranch_scc1 L_deep31_12
    s_waitcnt vmcnt(20)
L_deep31_12:
    s_mov_b32 m0, 126976
    s_add_u32 s39, s38, 33566720
    buffer_load_dwordx4 v24, s[8:11], s39 offen offset:0 sc1 nt lds
    buffer_load_dwordx4 v25, s[8:11], s39 offen offset:1024 sc1 nt lds
    buffer_load_dwordx4 v26, s[8:11], s39 offen offset:2048 sc1 nt lds
    buffer_load_dwordx4 v27, s[8:11], s39 offen offset:3072 sc1 nt lds
    s_waitcnt vmcnt(42)
    s_cmp_ge_u32 s95, 4
    s_cbranch_scc1 L_deep31
    s_waitcnt vmcnt(20)
L_deep31:
    s_add_u32 s38, s97, 245760
    s_and_b32 s38, s38, 262143
    s_add_u32 s38, s38, s45
    s_mov_b32 m0, 131072
    s_add_u32 s39, s38, 0
    buffer_load_dwordx4 v16, s[12:15], s39 offen offset:0 sc1 nt lds
    buffer_load_dwordx4 v16, s[12:15], s39 offen offset:1024 sc1 nt lds
    buffer_load_dwordx4 v16, s[12:15], s39 offen offset:2048 sc1 nt lds
    buffer_load_dwordx4 v16, s[12:15], s39 offen offset:3072 sc1 nt lds
    s_waitcnt vmcnt(42)
    s_cmp_ge_u32 s95, 4
    s_cbranch_scc1 L_deep32_4
    s_waitcnt vmcnt(18)
L_deep32_4:
    s_mov_b32 m0, 135168
    s_add_u32 s39, s38, 4096
    buffer_load_dwordx4 v16, s[12:15], s39 offen offset:0 sc1 nt lds
    buffer_load_dwordx4 v16, s[12:15], s39 offen offset:1024 sc1 nt lds
    buffer_load_dwordx4 v16, s[12:15], s39 offen offset:2048 sc1 nt lds
    buffer_load_dwordx4 v16, s[12:15], s39 offen offset:3072 sc1 nt lds
    s_waitcnt vmcnt(42)
    s_cmp_ge_u32 s95, 4
    s_cbranch_scc1 L_deep32_8
    s_waitcnt vmcnt(18)
L_deep32_8:
    s_mov_b32 m0, 139264
    s_add_u32 s39, s38, 8192
    buffer_load_dwordx4 v16, s[12:15], s39 offen offset:0 sc1 nt lds
    buffer_load_dwordx4 v16, s[12:15], s39 offen offset:1024 sc1 nt lds
    buffer_load_dwordx4 v16, s[12:15], s39 offen offset:2048 sc1 nt lds
    buffer_load_dwordx4 v16, s[12:15], s39 offen offset:3072 sc1 nt lds
    s_waitcnt vmcnt(42)
    s_cmp_ge_u32 s95, 4
    s_cbranch_scc1 L_deep32_12
    s_waitcnt vmcnt(18)
L_deep32_12:
    s_mov_b32 m0, 143360
    s_add_u32 s39, s38, 12288
    buffer_load_dwordx4 v16, s[12:15], s39 offen offset:0 sc1 nt lds
    buffer_load_dwordx4 v16, s[12:15], s39 offen offset:1024 sc1 nt lds
    buffer_load_dwordx4 v16, s[12:15], s39 offen offset:2048 sc1 nt lds
    buffer_load_dwordx4 v16, s[12:15], s39 offen offset:3072 sc1 nt lds
    s_waitcnt vmcnt(42)
    s_cmp_ge_u32 s95, 4
    s_cbranch_scc1 L_deep32
    s_waitcnt vmcnt(18)
L_deep32:
    s_waitcnt vmcnt(34)
    s_barrier
    ds_read_b64_tr_b16 a[160:161], v29 offset:0
    ds_read_b64_tr_b16 a[162:163], v29 offset:1024
    ds_read_b64_tr_b16 a[164:165], v30 offset:0
    ds_read_b64_tr_b16 a[166:167], v30 offset:1024
    ds_read_b64_tr_b16 a[168:169], v29 offset:2048
    ds_read_b64_tr_b16 a[170:171], v29 offset:3072
    ds_read_b64_tr_b16 a[172:173], v30 offset:2048
    ds_read_b64_tr_b16 a[174:175], v30 offset:3072
    ds_read_b64_tr_b16 a[176:177], v29 offset:4096
    ds_read_b64_tr_b16 a[178:179], v29 offset:5120
    ds_read_b64_tr_b16 a[180:181], v30 offset:4096
    ds_read_b64_tr_b16 a[182:183], v30 offset:5120
    ds_read_b64_tr_b16 a[184:185], v29 offset:6144
    ds_read_b64_tr_b16 a[186:187], v29 offset:7168
    ds_read_b64_tr_b16 a[188:189], v30 offset:6144
    ds_read_b64_tr_b16 a[190:191], v30 offset:7168
    s_add_u32 s38, s96, 56
    v_mov_b32 v35, s38
    s_mov_b64 exec, 1
    buffer_store_dword v35, v32, s[28:31], 0 offen
    s_mov_b64 exec, -1
    s_waitcnt vmcnt(33)
    v_subrev_u32 v34, s96, v34
    v_subrev_u32 v34, 56, v34
    v_cmp_gt_u32 vcc, 64, v34
    s_bcnt1_i32_b32 s95, vcc_lo
    buffer_load_dword v34, v33, s[28:31], 0 offen sc1
    s_add_u32 s38, s97, 16384
    s_and_b32 s38, s38, 262143
    s_add_u32 s38, s38, s45
    s_mov_b32 m0, 147456
    s_add_u32 s39, s38, 33554432
    buffer_load_dwordx4 v24, s[8:11], s39 offen offset:0 sc1 nt lds
    buffer_load_dwordx4 v25, s[8:11], s39 offen offset:1024 sc1 nt lds
    buffer_load_dwordx4 v26, s[8:11], s39 offen offset:2048 sc1 nt lds
    buffer_load_dwordx4 v27, s[8:11], s39 offen offset:3072 sc1 nt lds
    s_cmp_ge_u32 s95, 4
    s_cbranch_scc1 L_deep33_4
    s_waitcnt vmcnt(20)
L_deep33_4:
    s_mov_b32 m0, 151552
    s_add_u32 s39, s38, 33558528
    buffer_load_dwordx4 v24, s[8:11], s39 offen offset:0 sc1 nt lds
    buffer_load_dwordx4 v25, s[8:11], s39 offen offset:1024 sc1 nt lds
    buffer_load_dwordx4 v26, s[8:11], s39 offen offset:2048 sc1 nt lds
    buffer_load_dwordx4 v27, s[8:11], s39 offen offset:3072 sc1 nt lds
    s_cmp_ge_u32 s95, 4
    s_cbranch_scc1 L_deep33_8
    s_waitcnt vmcnt(20)
L_deep33_8:
    s_mov_b32 m0, 155648
    s_add_u32 s39, s38, 33562624
    buffer_load_dwordx4 v24, s[8:11], s39 offen offset:0 sc1 nt lds
    buffer_load_dwordx4 v25, s[8:11], s39 offen offset:1024 sc1 nt lds
    buffer_load_dwordx4 v26, s[8:11], s39 offen offset:2048 sc1 nt lds
    buffer_load_dwordx4 v27, s[8:11], s39 offen offset:3072 sc1 nt lds
    s_waitcnt vmcnt(42)
    s_cmp_ge_u32 s95, 4
    s_cbranch_scc1 L_deep33_12
    s_waitcnt vmcnt(20)
L_deep33_12:
    s_mov_b32 m0, 159744
    s_add_u32 s39, s38, 33566720
    buffer_load_dwordx4 v24, s[8:11], s39 offen offset:0 sc1 nt lds
    buffer_load_dwordx4 v25, s[8:11], s39 offen offset:1024 sc1 nt lds
    buffer_load_dwordx4 v26, s[8:11], s39 offen offset:2048 sc1 nt lds
    buffer_load_dwordx4 v27, s[8:11], s39 offen offset:3072 sc1 nt lds
    s_waitcnt vmcnt(42)
    s_cmp_ge_u32 s95, 4
    s_cbranch_scc1 L_deep33
    s_waitcnt vmcnt(20)
L_deep33:
    s_add_u32 s38, s97, 0
    s_and_b32 s38, s38, 262143
    s_add_u32 s38, s38, s45
    s_mov_b32 m0, 32768
    s_add_u32 s39, s38, 33554432
    buffer_load_dwordx4 v16, s[12:15], s39 offen offset:0 sc1 nt lds
    buffer_load_dwordx4 v16, s[12:15], s39 offen offset:1024 sc1 nt lds
    buffer_load_dwordx4 v16, s[12:15], s39 offen offset:2048 sc1 nt lds
    buffer_load_dwordx4 v16, s[12:15], s39 offen offset:3072 sc1 nt lds
    s_waitcnt vmcnt(42)
    s_cmp_ge_u32 s95, 4
    s_cbranch_scc1 L_deep34_4
    s_waitcnt vmcnt(18)
L_deep34_4:
    s_mov_b32 m0, 36864
    s_add_u32 s39, s38, 33558528
    buffer_load_dwordx4 v16, s[12:15], s39 offen offset:0 sc1 nt lds
    buffer_load_dwordx4 v16, s[12:15], s39 offen offset:1024 sc1 nt lds
    buffer_load_dwordx4 v16, s[12:15], s39 offen offset:2048 sc1 nt lds
    buffer_load_dwordx4 v16, s[12:15], s39 offen offset:3072 sc1 nt lds
    s_waitcnt vmcnt(42)
    s_cmp_ge_u32 s95, 4
    s_cbranch_scc1 L_deep34_8
    s_waitcnt vmcnt(18)
L_deep34_8:
    s_mov_b32 m0, 40960
    s_add_u32 s39, s38, 33562624
    buffer_load_dwordx4 v16, s[12:15], s39 offen offset:0 sc1 nt lds
    buffer_load_dwordx4 v16, s[12:15], s39 offen offset:1024 sc1 nt lds
    buffer_load_dwordx4 v16, s[12:15], s39 offen offset:2048 sc1 nt lds
    buffer_load_dwordx4 v16, s[12:15], s39 offen offset:3072 sc1 nt lds
    s_waitcnt vmcnt(42)
    s_cmp_ge_u32 s95, 4
    s_cbranch_scc1 L_deep34_12
    s_waitcnt vmcnt(18)
L_deep34_12:
    s_mov_b32 m0, 45056
    s_add_u32 s39, s38, 33566720
    buffer_load_dwordx4 v16, s[12:15], s39 offen offset:0 sc1 nt lds
    buffer_load_dwordx4 v16, s[12:15], s39 offen offset:1024 sc1 nt lds
    buffer_load_dwordx4 v16, s[12:15], s39 offen offset:2048 sc1 nt lds
    buffer_load_dwordx4 v16, s[12:15], s39 offen offset:3072 sc1 nt lds
    s_waitcnt vmcnt(42)
    s_cmp_ge_u32 s95, 4
    s_cbranch_scc1 L_deep34
    s_waitcnt vmcnt(18)
L_deep34:
    s_waitcnt lgkmcnt(0)
    s_add_u32 s40, s90, 3932160
    s_add_u32 s38, s94, 4
    s_and_b32 s38, s38, 15
    s_mul_i32 s38, s38, 81920
    s_add_u32 s38, s38, s40
    s_mov_b32 m0, 24576
    s_add_u32 s39, s38, 0
    buffer_load_dwordx4 v12, s[20:23], s39 offen offset:0 sc1 lds
    buffer_load_dwordx4 v13, s[20:23], s39 offen offset:1024 sc1 lds
    buffer_load_dwordx4 v14, s[20:23], s39 offen offset:2048 sc1 lds
    buffer_load_dwordx4 v15, s[20:23], s39 offen offset:3072 sc1 lds
    s_mov_b32 m0, 28672
    s_add_u32 s39, s38, 40960
    buffer_load_dwordx4 v12, s[20:23], s39 offen offset:0 sc1 lds
    buffer_load_dwordx4 v13, s[20:23], s39 offen offset:1024 sc1 lds
    buffer_load_dwordx4 v14, s[20:23], s39 offen offset:2048 sc1 lds
    buffer_load_dwordx4 v15, s[20:23], s39 offen offset:3072 sc1 lds
    s_waitcnt vmcnt(42)
    s_barrier
    s_add_u32 s38, s96, 60
    v_mov_b32 v35, s38
    s_mov_b64 exec, 1
    buffer_store_dword v35, v32, s[28:31], 0 offen
    s_mov_b64 exec, -1
    s_waitcnt vmcnt(41)
    v_subrev_u32 v34, s96, v34
    v_subrev_u32 v34, 60, v34
    v_cmp_gt_u32 vcc, 64, v34
    s_bcnt1_i32_b32 s95, vcc_lo
    buffer_load_dword v34, v33, s[28:31], 0 offen sc1
    s_add_u32 s38, s97, 32768
    s_and_b32 s38, s38, 262143
    s_add_u32 s38, s38, s45
    s_mov_b32 m0, 49152
    s_add_u32 s39, s38, 33554432
    buffer_load_dwordx4 v24, s[8:11], s39 offen offset:0 sc1 nt lds
    buffer_load_dwordx4 v25, s[8:11], s39 offen offset:1024 sc1 nt lds
    buffer_load_dwordx4 v26, s[8:11], s39 offen offset:2048 sc1 nt lds
    buffer_load_dwordx4 v27, s[8:11], s39 offen offset:3072 sc1 nt lds
    s_waitcnt vmcnt(42)
    s_cmp_ge_u32 s95, 4
    s_cbranch_scc1 L_deep35_4
    s_waitcnt vmcnt(28)
L_deep35_4:
    s_mov_b32 m0, 53248
    s_add_u32 s39, s38, 33558528
    buffer_load_dwordx4 v24, s[8:11], s39 offen offset:0 sc1 nt lds
    buffer_load_dwordx4 v25, s[8:11], s39 offen offset:1024 sc1 nt lds
    buffer_load_dwordx4 v26, s[8:11], s39 offen offset:2048 sc1 nt lds
    buffer_load_dwordx4 v27, s[8:11], s39 offen offset:3072 sc1 nt lds
    s_waitcnt vmcnt(42)
    s_cmp_ge_u32 s95, 4
    s_cbranch_scc1 L_deep35_8
    s_waitcnt vmcnt(28)
L_deep35_8:
    s_mov_b32 m0, 57344
    s_add_u32 s39, s38, 33562624
    buffer_load_dwordx4 v24, s[8:11], s39 offen offset:0 sc1 nt lds
    buffer_load_dwordx4 v25, s[8:11], s39 offen offset:1024 sc1 nt lds
    buffer_load_dwordx4 v26, s[8:11], s39 offen offset:2048 sc1 nt lds
    buffer_load_dwordx4 v27, s[8:11], s39 offen offset:3072 sc1 nt lds
    s_waitcnt vmcnt(42)
    s_cmp_ge_u32 s95, 4
    s_cbranch_scc1 L_deep35_12
    s_waitcnt vmcnt(28)
L_deep35_12:
    s_mov_b32 m0, 61440
    s_add_u32 s39, s38, 33566720
    buffer_load_dwordx4 v24, s[8:11], s39 offen offset:0 sc1 nt lds
    buffer_load_dwordx4 v25, s[8:11], s39 offen offset:1024 sc1 nt lds
    buffer_load_dwordx4 v26, s[8:11], s39 offen offset:2048 sc1 nt lds
    buffer_load_dwordx4 v27, s[8:11], s39 offen offset:3072 sc1 nt lds
    s_waitcnt vmcnt(42)
    s_cmp_ge_u32 s95, 4
    s_cbranch_scc1 L_deep35
    s_waitcnt vmcnt(28)
L_deep35:
    s_add_u32 s38, s97, 16384
    s_and_b32 s38, s38, 262143
    s_add_u32 s38, s38, s45
    s_mov_b32 m0, 65536
    s_add_u32 s39, s38, 33554432
    buffer_load_dwordx4 v16, s[12:15], s39 offen offset:0 sc1 nt lds
    buffer_load_dwordx4 v16, s[12:15], s39 offen offset:1024 sc1 nt lds
    buffer_load_dwordx4 v16, s[12:15], s39 offen offset:2048 sc1 nt lds
    buffer_load_dwordx4 v16, s[12:15], s39 offen offset:3072 sc1 nt lds
    s_waitcnt vmcnt(42)
    s_cmp_ge_u32 s95, 4
    s_cbranch_scc1 L_deep36_4
    s_waitcnt vmcnt(18)
L_deep36_4:
    s_mov_b32 m0, 69632
    s_add_u32 s39, s38, 33558528
    buffer_load_dwordx4 v16, s[12:15], s39 offen offset:0 sc1 nt lds
    buffer_load_dwordx4 v16, s[12:15], s39 offen offset:1024 sc1 nt lds
    buffer_load_dwordx4 v16, s[12:15], s39 offen offset:2048 sc1 nt lds
    buffer_load_dwordx4 v16, s[12:15], s39 offen offset:3072 sc1 nt lds
    s_waitcnt vmcnt(42)
    s_cmp_ge_u32 s95, 4
    s_cbranch_scc1 L_deep36_8
    s_waitcnt vmcnt(18)
L_deep36_8:
    s_mov_b32 m0, 73728
    s_add_u32 s39, s38, 33562624
    buffer_load_dwordx4 v16, s[12:15], s39 offen offset:0 sc1 nt lds
    buffer_load_dwordx4 v16, s[12:15], s39 offen offset:1024 sc1 nt lds
    buffer_load_dwordx4 v16, s[12:15], s39 offen offset:2048 sc1 nt lds
    buffer_load_dwordx4 v16, s[12:15], s39 offen offset:3072 sc1 nt lds
    s_waitcnt vmcnt(42)
    s_cmp_ge_u32 s95, 4
    s_cbranch_scc1 L_deep36_12
    s_waitcnt vmcnt(18)
L_deep36_12:
    s_mov_b32 m0, 77824
    s_add_u32 s39, s38, 33566720
    buffer_load_dwordx4 v16, s[12:15], s39 offen offset:0 sc1 nt lds
    buffer_load_dwordx4 v16, s[12:15], s39 offen offset:1024 sc1 nt lds
    buffer_load_dwordx4 v16, s[12:15], s39 offen offset:2048 sc1 nt lds
    buffer_load_dwordx4 v16, s[12:15], s39 offen offset:3072 sc1 nt lds
    s_waitcnt vmcnt(42)
    s_cmp_ge_u32 s95, 4
    s_cbranch_scc1 L_deep36
    s_waitcnt vmcnt(18)
L_deep36:
    s_barrier
    s_add_u32 s38, s96, 64
    v_mov_b32 v35, s38
    s_mov_b64 exec, 1
    buffer_store_dword v35, v32, s[28:31], 0 offen
    s_mov_b64 exec, -1
    s_waitcnt vmcnt(33)
    v_subrev_u32 v34, s96, v34
    v_subrev_u32 v34, 64, v34
    v_cmp_gt_u32 vcc, 64, v34
    s_bcnt1_i32_b32 s95, vcc_lo
    buffer_load_dword v34, v33, s[28:31], 0 offen sc1
    s_add_u32 s38, s97, 49152
    s_and_b32 s38, s38, 262143
    s_add_u32 s38, s38, s45
    s_mov_b32 m0, 81920
    s_add_u32 s39, s38, 33554432
    buffer_load_dwordx4 v24, s[8:11], s39 offen offset:0 sc1 nt lds
    buffer_load_dwordx4 v25, s[8:11], s39 offen offset:1024 sc1 nt lds
    buffer_load_dwordx4 v26, s[8:11], s39 offen offset:2048 sc1 nt lds
    buffer_load_dwordx4 v27, s[8:11], s39 offen offset:3072 sc1 nt lds
    s_cmp_ge_u32 s95, 4
    s_cbranch_scc1 L_deep37_4
    s_waitcnt vmcnt(20)
L_deep37_4:
    s_mov_b32 m0, 86016
    s_add_u32 s39, s38, 33558528
    buffer_load_dwordx4 v24, s[8:11], s39 offen offset:0 sc1 nt lds
    buffer_load_dwordx4 v25, s[8:11], s39 offen offset:1024 sc1 nt lds
    buffer_load_dwordx4 v26, s[8:11], s39 offen offset:2048 sc1 nt lds
    buffer_load_dwordx4 v27, s[8:11], s39 offen offset:3072 sc1 nt lds
    s_cmp_ge_u32 s95, 4
    s_cbranch_scc1 L_deep37_8
    s_waitcnt vmcnt(20)
L_deep37_8:
    s_mov_b32 m0, 90112
    s_add_u32 s39, s38, 33562624
    buffer_load_dwordx4 v24, s[8:11], s39 offen offset:0 sc1 nt lds
    buffer_load_dwordx4 v25, s[8:11], s39 offen offset:1024 sc1 nt lds
    buffer_load_dwordx4 v26, s[8:11], s39 offen offset:2048 sc1 nt lds
    buffer_load_dwordx4 v27, s[8:11], s39 offen offset:3072 sc1 nt lds
    s_waitcnt vmcnt(42)
    s_cmp_ge_u32 s95, 4
    s_cbranch_scc1 L_deep37_12
    s_waitcnt vmcnt(20)
L_deep37_12:
    s_mov_b32 m0, 94208
    s_add_u32 s39, s38, 33566720
    buffer_load_dwordx4 v24, s[8:11], s39 offen offset:0 sc1 nt lds
    buffer_load_dwordx4 v25, s[8:11], s39 offen offset:1024 sc1 nt lds
    buffer_load_dwordx4 v26, s[8:11], s39 offen offset:2048 sc1 nt lds
    buffer_load_dwordx4 v27, s[8:11], s39 offen offset:3072 sc1 nt lds
    s_waitcnt vmcnt(42)
    s_cmp_ge_u32 s95, 4
    s_cbranch_scc1 L_deep37
    s_waitcnt vmcnt(20)
L_deep37:
    s_add_u32 s38, s97, 32768
    s_and_b32 s38, s38, 262143
    s_add_u32 s38, s38, s45
    s_mov_b32 m0, 98304
    s_add_u32 s39, s38, 33554432
    buffer_load_dwordx4 v16, s[12:15], s39 offen offset:0 sc1 nt lds
    buffer_load_dwordx4 v16, s[12:15], s39 offen offset:1024 sc1 nt lds
    buffer_load_dwordx4 v16, s[12:15], s39 offen offset:2048 sc1 nt lds
    buffer_load_dwordx4 v16, s[12:15], s39 offen offset:3072 sc1 nt lds
    s_waitcnt vmcnt(42)
    s_cmp_ge_u32 s95, 4
    s_cbranch_scc1 L_deep38_4
    s_waitcnt vmcnt(18)
L_deep38_4:
    s_mov_b32 m0, 102400
    s_add_u32 s39, s38, 33558528
    buffer_load_dwordx4 v16, s[12:15], s39 offen offset:0 sc1 nt lds
    buffer_load_dwordx4 v16, s[12:15], s39 offen offset:1024 sc1 nt lds
    buffer_load_dwordx4 v16, s[12:15], s39 offen offset:2048 sc1 nt lds
    buffer_load_dwordx4 v16, s[12:15], s39 offen offset:3072 sc1 nt lds
    s_waitcnt vmcnt(42)
    s_cmp_ge_u32 s95, 4
    s_cbranch_scc1 L_deep38_8
    s_waitcnt vmcnt(18)
L_deep38_8:
    s_mov_b32 m0, 106496
    s_add_u32 s39, s38, 33562624
    buffer_load_dwordx4 v16, s[12:15], s39 offen offset:0 sc1 nt lds
    buffer_load_dwordx4 v16, s[12:15], s39 offen offset:1024 sc1 nt lds
    buffer_load_dwordx4 v16, s[12:15], s39 offen offset:2048 sc1 nt lds
    buffer_load_dwordx4 v16, s[12:15], s39 offen offset:3072 sc1 nt lds
    s_waitcnt vmcnt(42)
    s_cmp_ge_u32 s95, 4
    s_cbranch_scc1 L_deep38_12
    s_waitcnt vmcnt(18)
L_deep38_12:
    s_mov_b32 m0, 110592
    s_add_u32 s39, s38, 33566720
    buffer_load_dwordx4 v16, s[12:15], s39 offen offset:0 sc1 nt lds
    buffer_load_dwordx4 v16, s[12:15], s39 offen offset:1024 sc1 nt lds
    buffer_load_dwordx4 v16, s[12:15], s39 offen offset:2048 sc1 nt lds
    buffer_load_dwordx4 v16, s[12:15], s39 offen offset:3072 sc1 nt lds
    s_waitcnt vmcnt(42)
    s_cmp_ge_u32 s95, 4
    s_cbranch_scc1 L_deep38
    s_waitcnt vmcnt(18)
L_deep38:
    s_waitcnt vmcnt(34)
    s_barrier
    ds_read_b64_tr_b16 a[192:193], v29 offset:0
    ds_read_b64_tr_b16 a[194:195], v29 offset:1024
    ds_read_b64_tr_b16 a[196:197], v30 offset:0
    ds_read_b64_tr_b16 a[198:199], v30 offset:1024
    ds_read_b64_tr_b16 a[200:201], v29 offset:2048
    ds_read_b64_tr_b16 a[202:203], v29 offset:3072
    ds_read_b64_tr_b16 a[204:205], v30 offset:2048
    ds_read_b64_tr_b16 a[206:207], v30 offset:3072
    ds_read_b64_tr_b16 a[208:209], v29 offset:4096
    ds_read_b64_tr_b16 a[210:211], v29 offset:5120
    ds_read_b64_tr_b16 a[212:213], v30 offset:4096
    ds_read_b64_tr_b16 a[214:215], v30 offset:5120
    ds_read_b64_tr_b16 a[216:217], v29 offset:6144
    ds_read_b64_tr_b16 a[218:219], v29 offset:7168
    ds_read_b64_tr_b16 a[220:221], v30 offset:6144
    ds_read_b64_tr_b16 a[222:223], v30 offset:7168
    s_add_u32 s38, s96, 68
    v_mov_b32 v35, s38
    s_mov_b64 exec, 1
    buffer_store_dword v35, v32, s[28:31], 0 offen
    s_mov_b64 exec, -1
    s_waitcnt vmcnt(33)
    v_subrev_u32 v34, s96, v34
    v_subrev_u32 v34, 68, v34
    v_cmp_gt_u32 vcc, 64, v34
    s_bcnt1_i32_b32 s95, vcc_lo
    buffer_load_dword v34, v33, s[28:31], 0 offen sc1
    s_add_u32 s38, s97, 65536
    s_and_b32 s38, s38, 262143
    s_add_u32 s38, s38, s45
    s_mov_b32 m0, 114688
    s_add_u32 s39, s38, 33554432
    buffer_load_dwordx4 v24, s[8:11], s39 offen offset:0 sc1 nt lds
    buffer_load_dwordx4 v25, s[8:11], s39 offen offset:1024 sc1 nt lds
    buffer_load_dwordx4 v26, s[8:11], s39 offen offset:2048 sc1 nt lds
    buffer_load_dwordx4 v27, s[8:11], s39 offen offset:3072 sc1 nt lds
    s_cmp_ge_u32 s95, 4
    s_cbranch_scc1 L_deep39_4
    s_waitcnt vmcnt(20)
L_deep39_4:
    s_mov_b32 m0, 118784
    s_add_u32 s39, s38, 33558528
    buffer_load_dwordx4 v24, s[8:11], s39 offen offset:0 sc1 nt lds
    buffer_load_dwordx4 v25, s[8:11], s39 offen offset:1024 sc1 nt lds
    buffer_load_dwordx4 v26, s[8:11], s39 offen offset:2048 sc1 nt lds
    buffer_load_dwordx4 v27, s[8:11], s39 offen offset:3072 sc1 nt lds
    s_cmp_ge_u32 s95, 4
    s_cbranch_scc1 L_deep39_8
    s_waitcnt vmcnt(20)
L_deep39_8:
    s_mov_b32 m0, 122880
    s_add_u32 s39, s38, 33562624
    buffer_load_dwordx4 v24, s[8:11], s39 offen offset:0 sc1 nt lds
    buffer_load_dwordx4 v25, s[8:11], s39 offen offset:1024 sc1 nt lds
    buffer_load_dwordx4 v26, s[8:11], s39 offen offset:2048 sc1 nt lds
    buffer_load_dwordx4 v27, s[8:11], s39 offen offset:3072 sc1 nt lds
    s_waitcnt vmcnt(42)
    s_cmp_ge_u32 s95, 4
    s_cbranch_scc1 L_deep39_12
    s_waitcnt vmcnt(20)
L_deep39_12:
    s_mov_b32 m0, 126976
    s_add_u32 s39, s38, 33566720
    buffer_load_dwordx4 v24, s[8:11], s39 offen offset:0 sc1 nt lds
    buffer_load_dwordx4 v25, s[8:11], s39 offen offset:1024 sc1 nt lds
    buffer_load_dwordx4 v26, s[8:11], s39 offen offset:2048 sc1 nt lds
    buffer_load_dwordx4 v27, s[8:11], s39 offen offset:3072 sc1 nt lds
    s_waitcnt vmcnt(42)
    s_cmp_ge_u32 s95, 4
    s_cbranch_scc1 L_deep39
    s_waitcnt vmcnt(20)
L_deep39:
    s_add_u32 s38, s97, 49152
    s_and_b32 s38, s38, 262143
    s_add_u32 s38, s38, s45
    s_mov_b32 m0, 131072
    s_add_u32 s39, s38, 33554432
    buffer_load_dwordx4 v16, s[12:15], s39 offen offset:0 sc1 nt lds
    buffer_load_dwordx4 v16, s[12:15], s39 offen offset:1024 sc1 nt lds
    buffer_load_dwordx4 v16, s[12:15], s39 offen offset:2048 sc1 nt lds
    buffer_load_dwordx4 v16, s[12:15], s39 offen offset:3072 sc1 nt lds
    s_waitcnt vmcnt(42)
    s_cmp_ge_u32 s95, 4
    s_cbranch_scc1 L_deep40_4
    s_waitcnt vmcnt(18)
L_deep40_4:
    s_mov_b32 m0, 135168
    s_add_u32 s39, s38, 33558528
    buffer_load_dwordx4 v16, s[12:15], s39 offen offset:0 sc1 nt lds
    buffer_load_dwordx4 v16, s[12:15], s39 offen offset:1024 sc1 nt lds
    buffer_load_dwordx4 v16, s[12:15], s39 offen offset:2048 sc1 nt lds
    buffer_load_dwordx4 v16, s[12:15], s39 offen offset:3072 sc1 nt lds
    s_waitcnt vmcnt(42)
    s_cmp_ge_u32 s95, 4
    s_cbranch_scc1 L_deep40_8
    s_waitcnt vmcnt(18)
L_deep40_8:
    s_mov_b32 m0, 139264
    s_add_u32 s39, s38, 33562624
    buffer_load_dwordx4 v16, s[12:15], s39 offen offset:0 sc1 nt lds
    buffer_load_dwordx4 v16, s[12:15], s39 offen offset:1024 sc1 nt lds
    buffer_load_dwordx4 v16, s[12:15], s39 offen offset:2048 sc1 nt lds
    buffer_load_dwordx4 v16, s[12:15], s39 offen offset:3072 sc1 nt lds
    s_waitcnt vmcnt(42)
    s_cmp_ge_u32 s95, 4
    s_cbranch_scc1 L_deep40_12
    s_waitcnt vmcnt(18)
L_deep40_12:
    s_mov_b32 m0, 143360
    s_add_u32 s39, s38, 33566720
    buffer_load_dwordx4 v16, s[12:15], s39 offen offset:0 sc1 nt lds
    buffer_load_dwordx4 v16, s[12:15], s39 offen offset:1024 sc1 nt lds
    buffer_load_dwordx4 v16, s[12:15], s39 offen offset:2048 sc1 nt lds
    buffer_load_dwordx4 v16, s[12:15], s39 offen offset:3072 sc1 nt lds
    s_waitcnt vmcnt(42)
    s_cmp_ge_u32 s95, 4
    s_cbranch_scc1 L_deep40
    s_waitcnt vmcnt(18)
L_deep40:
    s_waitcnt lgkmcnt(0)
    s_add_u32 s40, s90, 3932160
    s_add_u32 s38, s94, 5
    s_and_b32 s38, s38, 15
    s_mul_i32 s38, s38, 81920
    s_add_u32 s38, s38, s40
    s_mov_b32 m0, 24576
    s_add_u32 s39, s38, 0
    buffer_load_dwordx4 v12, s[20:23], s39 offen offset:0 sc1 lds
    buffer_load_dwordx4 v13, s[20:23], s39 offen offset:1024 sc1 lds
    buffer_load_dwordx4 v14, s[20:23], s39 offen offset:2048 sc1 lds
    buffer_load_dwordx4 v15, s[20:23], s39 offen offset:3072 sc1 lds
    s_mov_b32 m0, 28672
    s_add_u32 s39, s38, 40960
    buffer_load_dwordx4 v12, s[20:23], s39 offen offset:0 sc1 lds
    buffer_load_dwordx4 v13, s[20:23], s39 offen offset:1024 sc1 lds
    buffer_load_dwordx4 v14, s[20:23], s39 offen offset:2048 sc1 lds
    buffer_load_dwordx4 v15, s[20:23], s39 offen offset:3072 sc1 lds
    s_waitcnt vmcnt(42)
    s_barrier
    s_add_u32 s38, s96, 1
    v_mov_b32 v4, s38
    s_mov_b64 exec, 1
    buffer_store_dword v4, v19, s[28:31], s63 offen sc1
    s_mov_b64 exec, -1
    s_add_u32 s38, s96, 72
    v_mov_b32 v35, s38
    s_mov_b64 exec, 1
    buffer_store_dword v35, v32, s[28:31], 0 offen
    s_mov_b64 exec, -1
    s_waitcnt vmcnt(42)
    v_subrev_u32 v34, s96, v34
    v_subrev_u32 v34, 72, v34
    v_cmp_gt_u32 vcc, 64, v34
    s_bcnt1_i32_b32 s95, vcc_lo
    buffer_load_dword v34, v33, s[28:31], 0 offen sc1
    s_add_u32 s38, s97, 81920
    s_and_b32 s38, s38, 262143
    s_add_u32 s38, s38, s45
    s_mov_b32 m0, 147456
    s_add_u32 s39, s38, 33554432
    buffer_load_dwordx4 v24, s[8:11], s39 offen offset:0 sc1 nt lds
    buffer_load_dwordx4 v25, s[8:11], s39 offen offset:1024 sc1 nt lds
    buffer_load_dwordx4 v26, s[8:11], s39 offen offset:2048 sc1 nt lds
    buffer_load_dwordx4 v27, s[8:11], s39 offen offset:3072 sc1 nt lds
    s_waitcnt vmcnt(43)
    s_waitcnt vmcnt(39)
    s_cmp_ge_u32 s95, 4
    s_cbranch_scc1 L_deep41_4
    s_waitcnt vmcnt(29)
L_deep41_4:
    s_mov_b32 m0, 151552
    s_add_u32 s39, s38, 33558528
    buffer_load_dwordx4 v24, s[8:11], s39 offen offset:0 sc1 nt lds
    buffer_load_dwordx4 v25, s[8:11], s39 offen offset:1024 sc1 nt lds
    buffer_load_dwordx4 v26, s[8:11], s39 offen offset:2048 sc1 nt lds
    buffer_load_dwordx4 v27, s[8:11], s39 offen offset:3072 sc1 nt lds
    s_waitcnt vmcnt(39)
    s_cmp_ge_u32 s95, 4
    s_cbranch_scc1 L_deep41_8
    s_waitcnt vmcnt(29)
L_deep41_8:
    s_mov_b32 m0, 155648
    s_add_u32 s39, s38, 33562624
    buffer_load_dwordx4 v24, s[8:11], s39 offen offset:0 sc1 nt lds
    buffer_load_dwordx4 v25, s[8:11], s39 offen offset:1024 sc1 nt lds
    buffer_load_dwordx4 v26, s[8:11], s39 offen offset:2048 sc1 nt lds
    buffer_load_dwordx4 v27, s[8:11], s39 offen offset:3072 sc1 nt lds
    s_waitcnt vmcnt(39)
    s_cmp_ge_u32 s95, 4
    s_cbranch_scc1 L_deep41_12
    s_waitcnt vmcnt(29)
L_deep41_12:
    s_mov_b32 m0, 159744
    s_add_u32 s39, s38, 33566720
    buffer_load_dwordx4 v24, s[8:11], s39 offen offset:0 sc1 nt lds
    buffer_load_dwordx4 v25, s[8:11], s39 offen offset:1024 sc1 nt lds
    buffer_load_dwordx4 v26, s[8:11], s39 offen offset:2048 sc1 nt lds
    buffer_load_dwordx4 v27, s[8:11], s39 offen offset:3072 sc1 nt lds
    s_waitcnt vmcnt(39)
    s_cmp_ge_u32 s95, 4
    s_cbranch_scc1 L_deep41
    s_waitcnt vmcnt(29)
L_deep41:
    s_add_u32 s38, s97, 65536
    s_and_b32 s38, s38, 262143
    s_add_u32 s38, s38, s45
    s_mov_b32 m0, 32768
    s_add_u32 s39, s38, 33554432
    buffer_load_dwordx4 v16, s[12:15], s39 offen offset:0 sc1 nt lds
    buffer_load_dwordx4 v16, s[12:15], s39 offen offset:1024 sc1 nt lds
    buffer_load_dwordx4 v16, s[12:15], s39 offen offset:2048 sc1 nt lds
    buffer_load_dwordx4 v16, s[12:15], s39 offen offset:3072 sc1 nt lds
    s_waitcnt vmcnt(39)
    s_cmp_ge_u32 s95, 4
    s_cbranch_scc1 L_deep42_4
    s_waitcnt vmcnt(18)
L_deep42_4:
    s_mov_b32 m0, 36864
    s_add_u32 s39, s38, 33558528
    buffer_load_dwordx4 v16, s[12:15], s39 offen offset:0 sc1 nt lds
    buffer_load_dwordx4 v16, s[12:15], s39 offen offset:1024 sc1 nt lds
    buffer_load_dwordx4 v16, s[12:15], s39 offen offset:2048 sc1 nt lds
    buffer_load_dwordx4 v16, s[12:15], s39 offen offset:3072 sc1 nt lds
    s_waitcnt vmcnt(39)
    s_cmp_ge_u32 s95, 4
    s_cbranch_scc1 L_deep42_8
    s_waitcnt vmcnt(18)
L_deep42_8:
    s_mov_b32 m0, 40960
    s_add_u32 s39, s38, 33562624
    buffer_load_dwordx4 v16, s[12:15], s39 offen offset:0 sc1 nt lds
    buffer_load_dwordx4 v16, s[12:15], s39 offen offset:1024 sc1 nt lds
    buffer_load_dwordx4 v16, s[12:15], s39 offen offset:2048 sc1 nt lds
    buffer_load_dwordx4 v16, s[12:15], s39 offen offset:3072 sc1 nt lds
    s_waitcnt vmcnt(39)
    s_cmp_ge_u32 s95, 4
    s_cbranch_scc1 L_deep42_12
    s_waitcnt vmcnt(18)
L_deep42_12:
    s_mov_b32 m0, 45056
    s_add_u32 s39, s38, 33566720
    buffer_load_dwordx4 v16, s[12:15], s39 offen offset:0 sc1 nt lds
    buffer_load_dwordx4 v16, s[12:15], s39 offen offset:1024 sc1 nt lds
    buffer_load_dwordx4 v16, s[12:15], s39 offen offset:2048 sc1 nt lds
    buffer_load_dwordx4 v16, s[12:15], s39 offen offset:3072 sc1 nt lds
    s_waitcnt vmcnt(35)
    s_cmp_ge_u32 s95, 4
    s_cbranch_scc1 L_deep42
    s_waitcnt vmcnt(18)
L_deep42:
    s_barrier
    s_add_u32 s38, s96, 76
    v_mov_b32 v35, s38
    s_mov_b64 exec, 1
    buffer_store_dword v35, v32, s[28:31], 0 offen
    s_mov_b64 exec, -1
    s_waitcnt vmcnt(33)
    v_subrev_u32 v34, s96, v34
    v_subrev_u32 v34, 76, v34
    v_cmp_gt_u32 vcc, 64, v34
    s_bcnt1_i32_b32 s95, vcc_lo
    buffer_load_dword v34, v33, s[28:31], 0 offen sc1
    s_add_u32 s38, s97, 98304
    s_and_b32 s38, s38, 262143
    s_add_u32 s38, s38, s45
    s_mov_b32 m0, 49152
    s_add_u32 s39, s38, 33554432
    buffer_load_dwordx4 v24, s[8:11], s39 offen offset:0 sc1 nt lds
    buffer_load_dwordx4 v25, s[8:11], s39 offen offset:1024 sc1 nt lds
    buffer_load_dwordx4 v26, s[8:11], s39 offen offset:2048 sc1 nt lds
    buffer_load_dwordx4 v27, s[8:11], s39 offen offset:3072 sc1 nt lds
    s_cmp_ge_u32 s95, 4
    s_cbranch_scc1 L_deep43_4
    s_waitcnt vmcnt(20)
L_deep43_4:
    s_mov_b32 m0, 53248
    s_add_u32 s39, s38, 33558528
    buffer_load_dwordx4 v24, s[8:11], s39 offen offset:0 sc1 nt lds
    buffer_load_dwordx4 v25, s[8:11], s39 offen offset:1024 sc1 nt lds
    buffer_load_dwordx4 v26, s[8:11], s39 offen offset:2048 sc1 nt lds
    buffer_load_dwordx4 v27, s[8:11], s39 offen offset:3072 sc1 nt lds
    s_cmp_ge_u32 s95, 4
    s_cbranch_scc1 L_deep43_8
    s_waitcnt vmcnt(20)
L_deep43_8:
    s_mov_b32 m0, 57344
    s_add_u32 s39, s38, 33562624
    buffer_load_dwordx4 v24, s[8:11], s39 offen offset:0 sc1 nt lds
    buffer_load_dwordx4 v25, s[8:11], s39 offen offset:1024 sc1 nt lds
    buffer_load_dwordx4 v26, s[8:11], s39 offen offset:2048 sc1 nt lds
    buffer_load_dwordx4 v27, s[8:11], s39 offen offset:3072 sc1 nt lds
    s_waitcnt vmcnt(42)
    s_cmp_ge_u32 s95, 4
    s_cbranch_scc1 L_deep43_12
    s_waitcnt vmcnt(20)
L_deep43_12:
    s_mov_b32 m0, 61440
    s_add_u32 s39, s38, 33566720
    buffer_load_dwordx4 v24, s[8:11], s39 offen offset:0 sc1 nt lds
    buffer_load_dwordx4 v25, s[8:11], s39 offen offset:1024 sc1 nt lds
    buffer_load_dwordx4 v26, s[8:11], s39 offen offset:2048 sc1 nt lds
    buffer_load_dwordx4 v27, s[8:11], s39 offen offset:3072 sc1 nt lds
    s_waitcnt vmcnt(42)
    s_cmp_ge_u32 s95, 4
    s_cbranch_scc1 L_deep43
    s_waitcnt vmcnt(20)
L_deep43:
    s_add_u32 s38, s97, 81920
    s_and_b32 s38, s38, 262143
    s_add_u32 s38, s38, s45
    s_mov_b32 m0, 65536
    s_add_u32 s39, s38, 33554432
    buffer_load_dwordx4 v16, s[12:15], s39 offen offset:0 sc1 nt lds
    buffer_load_dwordx4 v16, s[12:15], s39 offen offset:1024 sc1 nt lds
    buffer_load_dwordx4 v16, s[12:15], s39 offen offset:2048 sc1 nt lds
    buffer_load_dwordx4 v16, s[12:15], s39 offen offset:3072 sc1 nt lds
    s_waitcnt vmcnt(42)
    s_cmp_ge_u32 s95, 4
    s_cbranch_scc1 L_deep44_4
    s_waitcnt vmcnt(18)
L_deep44_4:
    s_mov_b32 m0, 69632
    s_add_u32 s39, s38, 33558528
    buffer_load_dwordx4 v16, s[12:15], s39 offen offset:0 sc1 nt lds
    buffer_load_dwordx4 v16, s[12:15], s39 offen offset:1024 sc1 nt lds
    buffer_load_dwordx4 v16, s[12:15], s39 offen offset:2048 sc1 nt lds
    buffer_load_dwordx4 v16, s[12:15], s39 offen offset:3072 sc1 nt lds
    s_waitcnt vmcnt(42)
    s_cmp_ge_u32 s95, 4
    s_cbranch_scc1 L_deep44_8
    s_waitcnt vmcnt(18)
L_deep44_8:
    s_mov_b32 m0, 73728
    s_add_u32 s39, s38, 33562624
    buffer_load_dwordx4 v16, s[12:15], s39 offen offset:0 sc1 nt lds
    buffer_load_dwordx4 v16, s[12:15], s39 offen offset:1024 sc1 nt lds
    buffer_load_dwordx4 v16, s[12:15], s39 offen offset:2048 sc1 nt lds
    buffer_load_dwordx4 v16, s[12:15], s39 offen offset:3072 sc1 nt lds
    s_waitcnt vmcnt(42)
    s_cmp_ge_u32 s95, 4
    s_cbranch_scc1 L_deep44_12
    s_waitcnt vmcnt(18)
L_deep44_12:
    s_mov_b32 m0, 77824
    s_add_u32 s39, s38, 33566720
    buffer_load_dwordx4 v16, s[12:15], s39 offen offset:0 sc1 nt lds
    buffer_load_dwordx4 v16, s[12:15], s39 offen offset:1024 sc1 nt lds
    buffer_load_dwordx4 v16, s[12:15], s39 offen offset:2048 sc1 nt lds
    buffer_load_dwordx4 v16, s[12:15], s39 offen offset:3072 sc1 nt lds
    s_waitcnt vmcnt(42)
    s_cmp_ge_u32 s95, 4
    s_cbranch_scc1 L_deep44
    s_waitcnt vmcnt(18)
L_deep44:
    s_waitcnt vmcnt(34)
    s_barrier
    ds_read_b64_tr_b16 a[224:225], v29 offset:0
    ds_read_b64_tr_b16 a[226:227], v29 offset:1024
    ds_read_b64_tr_b16 a[228:229], v30 offset:0
    ds_read_b64_tr_b16 a[230:231], v30 offset:1024
    ds_read_b64_tr_b16 a[232:233], v29 offset:2048
    ds_read_b64_tr_b16 a[234:235], v29 offset:3072
    ds_read_b64_tr_b16 a[236:237], v30 offset:2048
    ds_read_b64_tr_b16 a[238:239], v30 offset:3072
    ds_read_b64_tr_b16 a[240:241], v29 offset:4096
    ds_read_b64_tr_b16 a[242:243], v29 offset:5120
    ds_read_b64_tr_b16 a[244:245], v30 offset:4096
    ds_read_b64_tr_b16 a[246:247], v30 offset:5120
    ds_read_b64_tr_b16 a[248:249], v29 offset:6144
    ds_read_b64_tr_b16 a[250:251], v29 offset:7168
    ds_read_b64_tr_b16 a[252:253], v30 offset:6144
    ds_read_b64_tr_b16 a[254:255], v30 offset:7168
    s_add_u32 s38, s96, 80
    v_mov_b32 v35, s38
    s_mov_b64 exec, 1
    buffer_store_dword v35, v32, s[28:31], 0 offen
    s_mov_b64 exec, -1
    s_waitcnt vmcnt(33)
    v_subrev_u32 v34, s96, v34
    v_subrev_u32 v34, 80, v34
    v_cmp_gt_u32 vcc, 64, v34
    s_bcnt1_i32_b32 s95, vcc_lo
    buffer_load_dword v34, v33, s[28:31], 0 offen sc1
    s_add_u32 s38, s97, 114688
    s_and_b32 s38, s38, 262143
    s_add_u32 s38, s38, s45
    s_mov_b32 m0, 81920
    s_add_u32 s39, s38, 33554432
    buffer_load_dwordx4 v24, s[8:11], s39 offen offset:0 sc1 nt lds
    buffer_load_dwordx4 v25, s[8:11], s39 offen offset:1024 sc1 nt lds
    buffer_load_dwordx4 v26, s[8:11], s39 offen offset:2048 sc1 nt lds
    buffer_load_dwordx4 v27, s[8:11], s39 offen offset:3072 sc1 nt lds
    s_cmp_ge_u32 s95, 4
    s_cbranch_scc1 L_deep45_4
    s_waitcnt vmcnt(20)
L_deep45_4:
    s_mov_b32 m0, 86016
    s_add_u32 s39, s38, 33558528
    buffer_load_dwordx4 v24, s[8:11], s39 offen offset:0 sc1 nt lds
    buffer_load_dwordx4 v25, s[8:11], s39 offen offset:1024 sc1 nt lds
    buffer_load_dwordx4 v26, s[8:11], s39 offen offset:2048 sc1 nt lds
    buffer_load_dwordx4 v27, s[8:11], s39 offen offset:3072 sc1 nt lds
    s_cmp_ge_u32 s95, 4
    s_cbranch_scc1 L_deep45_8
    s_waitcnt vmcnt(20)
L_deep45_8:
    s_mov_b32 m0, 90112
    s_add_u32 s39, s38, 33562624
    buffer_load_dwordx4 v24, s[8:11], s39 offen offset:0 sc1 nt lds
    buffer_load_dwordx4 v25, s[8:11], s39 offen offset:1024 sc1 nt lds
    buffer_load_dwordx4 v26, s[8:11], s39 offen offset:2048 sc1 nt lds
    buffer_load_dwordx4 v27, s[8:11], s39 offen offset:3072 sc1 nt lds
    s_waitcnt vmcnt(42)
    s_cmp_ge_u32 s95, 4
    s_cbranch_scc1 L_deep45_12
    s_waitcnt vmcnt(20)
L_deep45_12:
    s_mov_b32 m0, 94208
    s_add_u32 s39, s38, 33566720
    buffer_load_dwordx4 v24, s[8:11], s39 offen offset:0 sc1 nt lds
    buffer_load_dwordx4 v25, s[8:11], s39 offen offset:1024 sc1 nt lds
    buffer_load_dwordx4 v26, s[8:11], s39 offen offset:2048 sc1 nt lds
    buffer_load_dwordx4 v27, s[8:11], s39 offen offset:3072 sc1 nt lds
    s_waitcnt vmcnt(42)
    s_cmp_ge_u32 s95, 4
    s_cbranch_scc1 L_deep45
    s_waitcnt vmcnt(20)
L_deep45:
    s_add_u32 s38, s97, 98304
    s_and_b32 s38, s38, 262143
    s_add_u32 s38, s38, s45
    s_mov_b32 m0, 98304
    s_add_u32 s39, s38, 33554432
    buffer_load_dwordx4 v16, s[12:15], s39 offen offset:0 sc1 nt lds
    buffer_load_dwordx4 v16, s[12:15], s39 offen offset:1024 sc1 nt lds
    buffer_load_dwordx4 v16, s[12:15], s39 offen offset:2048 sc1 nt lds
    buffer_load_dwordx4 v16, s[12:15], s39 offen offset:3072 sc1 nt lds
    s_waitcnt vmcnt(42)
    s_cmp_ge_u32 s95, 4
    s_cbranch_scc1 L_deep46_4
    s_waitcnt vmcnt(18)
L_deep46_4:
    s_mov_b32 m0, 102400
    s_add_u32 s39, s38, 33558528
    buffer_load_dwordx4 v16, s[12:15], s39 offen offset:0 sc1 nt lds
    buffer_load_dwordx4 v16, s[12:15], s39 offen offset:1024 sc1 nt lds
    buffer_load_dwordx4 v16, s[12:15], s39 offen offset:2048 sc1 nt lds
    buffer_load_dwordx4 v16, s[12:15], s39 offen offset:3072 sc1 nt lds
    s_waitcnt vmcnt(42)
    s_cmp_ge_u32 s95, 4
    s_cbranch_scc1 L_deep46_8
    s_waitcnt vmcnt(18)
L_deep46_8:
    s_mov_b32 m0, 106496
    s_add_u32 s39, s38, 33562624
    buffer_load_dwordx4 v16, s[12:15], s39 offen offset:0 sc1 nt lds
    buffer_load_dwordx4 v16, s[12:15], s39 offen offset:1024 sc1 nt lds
    buffer_load_dwordx4 v16, s[12:15], s39 offen offset:2048 sc1 nt lds
    buffer_load_dwordx4 v16, s[12:15], s39 offen offset:3072 sc1 nt lds
    s_waitcnt vmcnt(42)
    s_cmp_ge_u32 s95, 4
    s_cbranch_scc1 L_deep46_12
    s_waitcnt vmcnt(18)
L_deep46_12:
    s_mov_b32 m0, 110592
    s_add_u32 s39, s38, 33566720
    buffer_load_dwordx4 v16, s[12:15], s39 offen offset:0 sc1 nt lds
    buffer_load_dwordx4 v16, s[12:15], s39 offen offset:1024 sc1 nt lds
    buffer_load_dwordx4 v16, s[12:15], s39 offen offset:2048 sc1 nt lds
    buffer_load_dwordx4 v16, s[12:15], s39 offen offset:3072 sc1 nt lds
    s_waitcnt vmcnt(42)
    s_cmp_ge_u32 s95, 4
    s_cbranch_scc1 L_deep46
    s_waitcnt vmcnt(18)
L_deep46:
    s_waitcnt lgkmcnt(0)
    s_add_u32 s40, s90, 3932160
    s_add_u32 s38, s94, 6
    s_and_b32 s38, s38, 15
    s_mul_i32 s38, s38, 81920
    s_add_u32 s38, s38, s40
    s_mov_b32 m0, 24576
    s_add_u32 s39, s38, 0
    buffer_load_dwordx4 v12, s[20:23], s39 offen offset:0 sc1 lds
    buffer_load_dwordx4 v13, s[20:23], s39 offen offset:1024 sc1 lds
    buffer_load_dwordx4 v14, s[20:23], s39 offen offset:2048 sc1 lds
    buffer_load_dwordx4 v15, s[20:23], s39 offen offset:3072 sc1 lds
    s_mov_b32 m0, 28672
    s_add_u32 s39, s38, 40960
    buffer_load_dwordx4 v12, s[20:23], s39 offen offset:0 sc1 lds
    buffer_load_dwordx4 v13, s[20:23], s39 offen offset:1024 sc1 lds
    buffer_load_dwordx4 v14, s[20:23], s39 offen offset:2048 sc1 lds
    buffer_load_dwordx4 v15, s[20:23], s39 offen offset:3072 sc1 lds
    s_waitcnt vmcnt(42)
    s_barrier
    s_add_u32 s38, s96, 84
    v_mov_b32 v35, s38
    s_mov_b64 exec, 1
    buffer_store_dword v35, v32, s[28:31], 0 offen
    s_mov_b64 exec, -1
    s_waitcnt vmcnt(41)
    v_subrev_u32 v34, s96, v34
    v_subrev_u32 v34, 84, v34
    v_cmp_gt_u32 vcc, 64, v34
    s_bcnt1_i32_b32 s95, vcc_lo
    buffer_load_dword v34, v33, s[28:31], 0 offen sc1
    s_add_u32 s38, s97, 131072
    s_and_b32 s38, s38, 262143
    s_add_u32 s38, s38, s45
    s_mov_b32 m0, 114688
    s_add_u32 s39, s38, 33554432
    buffer_load_dwordx4 v24, s[8:11], s39 offen offset:0 sc1 nt lds
    buffer_load_dwordx4 v25, s[8:11], s39 offen offset:1024 sc1 nt lds
    buffer_load_dwordx4 v26, s[8:11], s39 offen offset:2048 sc1 nt lds
    buffer_load_dwordx4 v27, s[8:11], s39 offen offset:3072 sc1 nt lds
    s_waitcnt vmcnt(42)
    s_cmp_ge_u32 s95, 4
    s_cbranch_scc1 L_deep47_4
    s_waitcnt vmcnt(28)
L_deep47_4:
    s_mov_b32 m0, 118784
    s_add_u32 s39, s38, 33558528
    buffer_load_dwordx4 v24, s[8:11], s39 offen offset:0 sc1 nt lds
    buffer_load_dwordx4 v25, s[8:11], s39 offen offset:1024 sc1 nt lds
    buffer_load_dwordx4 v26, s[8:11], s39 offen offset:2048 sc1 nt lds
    buffer_load_dwordx4 v27, s[8:11], s39 offen offset:3072 sc1 nt lds
    s_waitcnt vmcnt(42)
    s_cmp_ge_u32 s95, 4
    s_cbranch_scc1 L_deep47_8
    s_waitcnt vmcnt(28)
L_deep47_8:
    s_mov_b32 m0, 122880
    s_add_u32 s39, s38, 33562624
    buffer_load_dwordx4 v24, s[8:11], s39 offen offset:0 sc1 nt lds
    buffer_load_dwordx4 v25, s[8:11], s39 offen offset:1024 sc1 nt lds
    buffer_load_dwordx4 v26, s[8:11], s39 offen offset:2048 sc1 nt lds
    buffer_load_dwordx4 v27, s[8:11], s39 offen offset:3072 sc1 nt lds
    s_waitcnt vmcnt(42)
    s_cmp_ge_u32 s95, 4
    s_cbranch_scc1 L_deep47_12
    s_waitcnt vmcnt(28)
L_deep47_12:
    s_mov_b32 m0, 126976
    s_add_u32 s39, s38, 33566720
    buffer_load_dwordx4 v24, s[8:11], s39 offen offset:0 sc1 nt lds
    buffer_load_dwordx4 v25, s[8:11], s39 offen offset:1024 sc1 nt lds
    buffer_load_dwordx4 v26, s[8:11], s39 offen offset:2048 sc1 nt lds
    buffer_load_dwordx4 v27, s[8:11], s39 offen offset:3072 sc1 nt lds
    s_waitcnt vmcnt(42)
    s_cmp_ge_u32 s95, 4
    s_cbranch_scc1 L_deep47
    s_waitcnt vmcnt(28)
L_deep47:
    s_add_u32 s38, s97, 114688
    s_and_b32 s38, s38, 262143
    s_add_u32 s38, s38, s45
    s_mov_b32 m0, 131072
    s_add_u32 s39, s38, 33554432
    buffer_load_dwordx4 v16, s[12:15], s39 offen offset:0 sc1 nt lds
    buffer_load_dwordx4 v16, s[12:15], s39 offen offset:1024 sc1 nt lds
    buffer_load_dwordx4 v16, s[12:15], s39 offen offset:2048 sc1 nt lds
    buffer_load_dwordx4 v16, s[12:15], s39 offen offset:3072 sc1 nt lds
    s_waitcnt vmcnt(42)
    s_cmp_ge_u32 s95, 4
    s_cbranch_scc1 L_deep48_4
    s_waitcnt vmcnt(18)
L_deep48_4:
    s_mov_b32 m0, 135168
    s_add_u32 s39, s38, 33558528
    buffer_load_dwordx4 v16, s[12:15], s39 offen offset:0 sc1 nt lds
    buffer_load_dwordx4 v16, s[12:15], s39 offen offset:1024 sc1 nt lds
    buffer_load_dwordx4 v16, s[12:15], s39 offen offset:2048 sc1 nt lds
    buffer_load_dwordx4 v16, s[12:15], s39 offen offset:3072 sc1 nt lds
    s_waitcnt vmcnt(42)
    s_cmp_ge_u32 s95, 4
    s_cbranch_scc1 L_deep48_8
    s_waitcnt vmcnt(18)
L_deep48_8:
    s_mov_b32 m0, 139264
    s_add_u32 s39, s38, 33562624
    buffer_load_dwordx4 v16, s[12:15], s39 offen offset:0 sc1 nt lds
    buffer_load_dwordx4 v16, s[12:15], s39 offen offset:1024 sc1 nt lds
    buffer_load_dwordx4 v16, s[12:15], s39 offen offset:2048 sc1 nt lds
    buffer_load_dwordx4 v16, s[12:15], s39 offen offset:3072 sc1 nt lds
    s_waitcnt vmcnt(42)
    s_cmp_ge_u32 s95, 4
    s_cbranch_scc1 L_deep48_12
    s_waitcnt vmcnt(18)
L_deep48_12:
    s_mov_b32 m0, 143360
    s_add_u32 s39, s38, 33566720
    buffer_load_dwordx4 v16, s[12:15], s39 offen offset:0 sc1 nt lds
    buffer_load_dwordx4 v16, s[12:15], s39 offen offset:1024 sc1 nt lds
    buffer_load_dwordx4 v16, s[12:15], s39 offen offset:2048 sc1 nt lds
    buffer_load_dwordx4 v16, s[12:15], s39 offen offset:3072 sc1 nt lds
    s_waitcnt vmcnt(42)
    s_cmp_ge_u32 s95, 4
    s_cbranch_scc1 L_deep48
    s_waitcnt vmcnt(18)
L_deep48:
    s_barrier
    s_add_u32 s38, s96, 88
    v_mov_b32 v35, s38
    s_mov_b64 exec, 1
    buffer_store_dword v35, v32, s[28:31], 0 offen
    s_mov_b64 exec, -1
    s_waitcnt vmcnt(33)
    v_subrev_u32 v34, s96, v34
    v_subrev_u32 v34, 88, v34
    v_cmp_gt_u32 vcc, 64, v34
    s_bcnt1_i32_b32 s95, vcc_lo
    buffer_load_dword v34, v33, s[28:31], 0 offen sc1
    s_add_u32 s38, s97, 147456
    s_and_b32 s38, s38, 262143
    s_add_u32 s38, s38, s45
    s_mov_b32 m0, 147456
    s_add_u32 s39, s38, 33554432
    buffer_load_dwordx4 v24, s[8:11], s39 offen offset:0 sc1 nt lds
    buffer_load_dwordx4 v25, s[8:11], s39 offen offset:1024 sc1 nt lds
    buffer_load_dwordx4 v26, s[8:11], s39 offen offset:2048 sc1 nt lds
    buffer_load_dwordx4 v27, s[8:11], s39 offen offset:3072 sc1 nt lds
    s_cmp_ge_u32 s95, 4
    s_cbranch_scc1 L_deep49_4
    s_waitcnt vmcnt(20)
L_deep49_4:
    s_mov_b32 m0, 151552
    s_add_u32 s39, s38, 33558528
    buffer_load_dwordx4 v24, s[8:11], s39 offen offset:0 sc1 nt lds
    buffer_load_dwordx4 v25, s[8:11], s39 offen offset:1024 sc1 nt lds
    buffer_load_dwordx4 v26, s[8:11], s39 offen offset:2048 sc1 nt lds
    buffer_load_dwordx4 v27, s[8:11], s39 offen offset:3072 sc1 nt lds
    s_cmp_ge_u32 s95, 4
    s_cbranch_scc1 L_deep49_8
    s_waitcnt vmcnt(20)
L_deep49_8:
    s_mov_b32 m0, 155648
    s_add_u32 s39, s38, 33562624
    buffer_load_dwordx4 v24, s[8:11], s39 offen offset:0 sc1 nt lds
    buffer_load_dwordx4 v25, s[8:11], s39 offen offset:1024 sc1 nt lds
    buffer_load_dwordx4 v26, s[8:11], s39 offen offset:2048 sc1 nt lds
    buffer_load_dwordx4 v27, s[8:11], s39 offen offset:3072 sc1 nt lds
    s_waitcnt vmcnt(42)
    s_cmp_ge_u32 s95, 4
    s_cbranch_scc1 L_deep49_12
    s_waitcnt vmcnt(20)
L_deep49_12:
    s_mov_b32 m0, 159744
    s_add_u32 s39, s38, 33566720
    buffer_load_dwordx4 v24, s[8:11], s39 offen offset:0 sc1 nt lds
    buffer_load_dwordx4 v25, s[8:11], s39 offen offset:1024 sc1 nt lds
    buffer_load_dwordx4 v26, s[8:11], s39 offen offset:2048 sc1 nt lds
    buffer_load_dwordx4 v27, s[8:11], s39 offen offset:3072 sc1 nt lds
    s_waitcnt vmcnt(42)
    s_cmp_ge_u32 s95, 4
    s_cbranch_scc1 L_deep49
    s_waitcnt vmcnt(20)
L_deep49:
    s_add_u32 s38, s97, 131072
    s_and_b32 s38, s38, 262143
    s_add_u32 s38, s38, s45
    s_mov_b32 m0, 32768
    s_add_u32 s39, s38, 33554432
    buffer_load_dwordx4 v16, s[12:15], s39 offen offset:0 sc1 nt lds
    buffer_load_dwordx4 v16, s[12:15], s39 offen offset:1024 sc1 nt lds
    buffer_load_dwordx4 v16, s[12:15], s39 offen offset:2048 sc1 nt lds
    buffer_load_dwordx4 v16, s[12:15], s39 offen offset:3072 sc1 nt lds
    s_waitcnt vmcnt(42)
    s_cmp_ge_u32 s95, 4
    s_cbranch_scc1 L_deep50_4
    s_waitcnt vmcnt(18)
L_deep50_4:
    s_mov_b32 m0, 36864
    s_add_u32 s39, s38, 33558528
    buffer_load_dwordx4 v16, s[12:15], s39 offen offset:0 sc1 nt lds
    buffer_load_dwordx4 v16, s[12:15], s39 offen offset:1024 sc1 nt lds
    buffer_load_dwordx4 v16, s[12:15], s39 offen offset:2048 sc1 nt lds
    buffer_load_dwordx4 v16, s[12:15], s39 offen offset:3072 sc1 nt lds
    s_waitcnt vmcnt(42)
    s_cmp_ge_u32 s95, 4
    s_cbranch_scc1 L_deep50_8
    s_waitcnt vmcnt(18)
L_deep50_8:
    s_mov_b32 m0, 40960
    s_add_u32 s39, s38, 33562624
    buffer_load_dwordx4 v16, s[12:15], s39 offen offset:0 sc1 nt lds
    buffer_load_dwordx4 v16, s[12:15], s39 offen offset:1024 sc1 nt lds
    buffer_load_dwordx4 v16, s[12:15], s39 offen offset:2048 sc1 nt lds
    buffer_load_dwordx4 v16, s[12:15], s39 offen offset:3072 sc1 nt lds
    s_waitcnt vmcnt(42)
    s_cmp_ge_u32 s95, 4
    s_cbranch_scc1 L_deep50_12
    s_waitcnt vmcnt(18)
L_deep50_12:
    s_mov_b32 m0, 45056
    s_add_u32 s39, s38, 33566720
    buffer_load_dwordx4 v16, s[12:15], s39 offen offset:0 sc1 nt lds
    buffer_load_dwordx4 v16, s[12:15], s39 offen offset:1024 sc1 nt lds
    buffer_load_dwordx4 v16, s[12:15], s39 offen offset:2048 sc1 nt lds
    buffer_load_dwordx4 v16, s[12:15], s39 offen offset:3072 sc1 nt lds
    s_waitcnt vmcnt(42)
    s_cmp_ge_u32 s95, 4
    s_cbranch_scc1 L_deep50
    s_waitcnt vmcnt(18)
L_deep50:
    s_waitcnt vmcnt(34)
    s_barrier
    ds_read_b64_tr_b16 v[192:193], v29 offset:0
    ds_read_b64_tr_b16 v[194:195], v29 offset:1024
    ds_read_b64_tr_b16 v[196:197], v30 offset:0
    ds_read_b64_tr_b16 v[198:199], v30 offset:1024
    ds_read_b64_tr_b16 v[200:201], v29 offset:2048
    ds_read_b64_tr_b16 v[202:203], v29 offset:3072
    ds_read_b64_tr_b16 v[204:205], v30 offset:2048
    ds_read_b64_tr_b16 v[206:207], v30 offset:3072
    ds_read_b64_tr_b16 v[208:209], v29 offset:4096
    ds_read_b64_tr_b16 v[210:211], v29 offset:5120
    ds_read_b64_tr_b16 v[212:213], v30 offset:4096
    ds_read_b64_tr_b16 v[214:215], v30 offset:5120
    ds_read_b64_tr_b16 v[216:217], v29 offset:6144
    ds_read_b64_tr_b16 v[218:219], v29 offset:7168
    ds_read_b64_tr_b16 v[220:221], v30 offset:6144
    ds_read_b64_tr_b16 v[222:223], v30 offset:7168
    s_add_u32 s38, s96, 92
    v_mov_b32 v35, s38
    s_mov_b64 exec, 1
    buffer_store_dword v35, v32, s[28:31], 0 offen
    s_mov_b64 exec, -1
    s_waitcnt vmcnt(33)
    v_subrev_u32 v34, s96, v34
    v_subrev_u32 v34, 92, v34
    v_cmp_gt_u32 vcc, 64, v34
    s_bcnt1_i32_b32 s95, vcc_lo
    buffer_load_dword v34, v33, s[28:31], 0 offen sc1
    s_add_u32 s38, s97, 163840
    s_and_b32 s38, s38, 262143
    s_add_u32 s38, s38, s45
    s_mov_b32 m0, 49152
    s_add_u32 s39, s38, 33554432
    buffer_load_dwordx4 v24, s[8:11], s39 offen offset:0 sc1 nt lds
    buffer_load_dwordx4 v25, s[8:11], s39 offen offset:1024 sc1 nt lds
    buffer_load_dwordx4 v26, s[8:11], s39 offen offset:2048 sc1 nt lds
    buffer_load_dwordx4 v27, s[8:11], s39 offen offset:3072 sc1 nt lds
    s_cmp_ge_u32 s95, 4
    s_cbranch_scc1 L_deep51_4
    s_waitcnt vmcnt(20)
L_deep51_4:
    s_mov_b32 m0, 53248
    s_add_u32 s39, s38, 33558528
    buffer_load_dwordx4 v24, s[8:11], s39 offen offset:0 sc1 nt lds
    buffer_load_dwordx4 v25, s[8:11], s39 offen offset:1024 sc1 nt lds
    buffer_load_dwordx4 v26, s[8:11], s39 offen offset:2048 sc1 nt lds
    buffer_load_dwordx4 v27, s[8:11], s39 offen offset:3072 sc1 nt lds
    s_cmp_ge_u32 s95, 4
    s_cbranch_scc1 L_deep51_8
    s_waitcnt vmcnt(20)
L_deep51_8:
    s_mov_b32 m0, 57344
    s_add_u32 s39, s38, 33562624
    buffer_load_dwordx4 v24, s[8:11], s39 offen offset:0 sc1 nt lds
    buffer_load_dwordx4 v25, s[8:11], s39 offen offset:1024 sc1 nt lds
    buffer_load_dwordx4 v26, s[8:11], s39 offen offset:2048 sc1 nt lds
    buffer_load_dwordx4 v27, s[8:11], s39 offen offset:3072 sc1 nt lds
    s_waitcnt vmcnt(42)
    s_cmp_ge_u32 s95, 4
    s_cbranch_scc1 L_deep51_12
    s_waitcnt vmcnt(20)
L_deep51_12:
    s_mov_b32 m0, 61440
    s_add_u32 s39, s38, 33566720
    buffer_load_dwordx4 v24, s[8:11], s39 offen offset:0 sc1 nt lds
    buffer_load_dwordx4 v25, s[8:11], s39 offen offset:1024 sc1 nt lds
    buffer_load_dwordx4 v26, s[8:11], s39 offen offset:2048 sc1 nt lds
    buffer_load_dwordx4 v27, s[8:11], s39 offen offset:3072 sc1 nt lds
    s_waitcnt vmcnt(42)
    s_cmp_ge_u32 s95, 4
    s_cbranch_scc1 L_deep51
    s_waitcnt vmcnt(20)
L_deep51:
    s_add_u32 s38, s97, 147456
    s_and_b32 s38, s38, 262143
    s_add_u32 s38, s38, s45
    s_mov_b32 m0, 65536
    s_add_u32 s39, s38, 33554432
    buffer_load_dwordx4 v16, s[12:15], s39 offen offset:0 sc1 nt lds
    buffer_load_dwordx4 v16, s[12:15], s39 offen offset:1024 sc1 nt lds
    buffer_load_dwordx4 v16, s[12:15], s39 offen offset:2048 sc1 nt lds
    buffer_load_dwordx4 v16, s[12:15], s39 offen offset:3072 sc1 nt lds
    s_waitcnt vmcnt(42)
    s_cmp_ge_u32 s95, 4
    s_cbranch_scc1 L_deep52_4
    s_waitcnt vmcnt(18)
L_deep52_4:
    s_mov_b32 m0, 69632
    s_add_u32 s39, s38, 33558528
    buffer_load_dwordx4 v16, s[12:15], s39 offen offset:0 sc1 nt lds
    buffer_load_dwordx4 v16, s[12:15], s39 offen offset:1024 sc1 nt lds
    buffer_load_dwordx4 v16, s[12:15], s39 offen offset:2048 sc1 nt lds
    buffer_load_dwordx4 v16, s[12:15], s39 offen offset:3072 sc1 nt lds
    s_waitcnt vmcnt(42)
    s_cmp_ge_u32 s95, 4
    s_cbranch_scc1 L_deep52_8
    s_waitcnt vmcnt(18)
L_deep52_8:
    s_mov_b32 m0, 73728
    s_add_u32 s39, s38, 33562624
    buffer_load_dwordx4 v16, s[12:15], s39 offen offset:0 sc1 nt lds
    buffer_load_dwordx4 v16, s[12:15], s39 offen offset:1024 sc1 nt lds
    buffer_load_dwordx4 v16, s[12:15], s39 offen offset:2048 sc1 nt lds
    buffer_load_dwordx4 v16, s[12:15], s39 offen offset:3072 sc1 nt lds
    s_waitcnt vmcnt(42)
    s_cmp_ge_u32 s95, 4
    s_cbranch_scc1 L_deep52_12
    s_waitcnt vmcnt(18)
L_deep52_12:
    s_mov_b32 m0, 77824
    s_add_u32 s39, s38, 33566720
    buffer_load_dwordx4 v16, s[12:15], s39 offen offset:0 sc1 nt lds
    buffer_load_dwordx4 v16, s[12:15], s39 offen offset:1024 sc1 nt lds
    buffer_load_dwordx4 v16, s[12:15], s39 offen offset:2048 sc1 nt lds
    buffer_load_dwordx4 v16, s[12:15], s39 offen offset:3072 sc1 nt lds
    s_waitcnt vmcnt(42)
    s_cmp_ge_u32 s95, 4
    s_cbranch_scc1 L_deep52
    s_waitcnt vmcnt(18)
L_deep52:
    s_waitcnt lgkmcnt(0)
    s_add_u32 s40, s90, 3932160
    s_add_u32 s38, s94, 7
    s_and_b32 s38, s38, 15
    s_mul_i32 s38, s38, 81920
    s_add_u32 s38, s38, s40
    s_mov_b32 m0, 24576
    s_add_u32 s39, s38, 0
    buffer_load_dwordx4 v12, s[20:23], s39 offen offset:0 sc1 lds
    buffer_load_dwordx4 v13, s[20:23], s39 offen offset:1024 sc1 lds
    buffer_load_dwordx4 v14, s[20:23], s39 offen offset:2048 sc1 lds
    buffer_load_dwordx4 v15, s[20:23], s39 offen offset:3072 sc1 lds
    s_mov_b32 m0, 28672
    s_add_u32 s39, s38, 40960
    buffer_load_dwordx4 v12, s[20:23], s39 offen offset:0 sc1 lds
    buffer_load_dwordx4 v13, s[20:23], s39 offen offset:1024 sc1 lds
    buffer_load_dwordx4 v14, s[20:23], s39 offen offset:2048 sc1 lds
    buffer_load_dwordx4 v15, s[20:23], s39 offen offset:3072 sc1 lds
    s_waitcnt vmcnt(42)
    s_barrier
    s_add_u32 s38, s96, 96
    v_mov_b32 v35, s38
    s_mov_b64 exec, 1
    buffer_store_dword v35, v32, s[28:31], 0 offen
    s_mov_b64 exec, -1
    s_waitcnt vmcnt(41)
    v_subrev_u32 v34, s96, v34
    v_subrev_u32 v34, 96, v34
    v_cmp_gt_u32 vcc, 64, v34
    s_bcnt1_i32_b32 s95, vcc_lo
    buffer_load_dword v34, v33, s[28:31], 0 offen sc1
    s_add_u32 s38, s97, 180224
    s_and_b32 s38, s38, 262143
    s_add_u32 s38, s38, s45
    s_mov_b32 m0, 81920
    s_add_u32 s39, s38, 33554432
    buffer_load_dwordx4 v24, s[8:11], s39 offen offset:0 sc1 nt lds
    buffer_load_dwordx4 v25, s[8:11], s39 offen offset:1024 sc1 nt lds
    buffer_load_dwordx4 v26, s[8:11], s39 offen offset:2048 sc1 nt lds
    buffer_load_dwordx4 v27, s[8:11], s39 offen offset:3072 sc1 nt lds
    s_waitcnt vmcnt(42)
    s_cmp_ge_u32 s95, 4
    s_cbranch_scc1 L_deep53_4
    s_waitcnt vmcnt(28)
L_deep53_4:
    s_mov_b32 m0, 86016
    s_add_u32 s39, s38, 33558528
    buffer_load_dwordx4 v24, s[8:11], s39 offen offset:0 sc1 nt lds
    buffer_load_dwordx4 v25, s[8:11], s39 offen offset:1024 sc1 nt lds
    buffer_load_dwordx4 v26, s[8:11], s39 offen offset:2048 sc1 nt lds
    buffer_load_dwordx4 v27, s[8:11], s39 offen offset:3072 sc1 nt lds
    s_waitcnt vmcnt(42)
    s_cmp_ge_u32 s95, 4
    s_cbranch_scc1 L_deep53_8
    s_waitcnt vmcnt(28)
L_deep53_8:
    s_mov_b32 m0, 90112
    s_add_u32 s39, s38, 33562624
    buffer_load_dwordx4 v24, s[8:11], s39 offen offset:0 sc1 nt lds
    buffer_load_dwordx4 v25, s[8:11], s39 offen offset:1024 sc1 nt lds
    buffer_load_dwordx4 v26, s[8:11], s39 offen offset:2048 sc1 nt lds
    buffer_load_dwordx4 v27, s[8:11], s39 offen offset:3072 sc1 nt lds
    s_waitcnt vmcnt(42)
    s_cmp_ge_u32 s95, 4
    s_cbranch_scc1 L_deep53_12
    s_waitcnt vmcnt(28)
L_deep53_12:
    s_mov_b32 m0, 94208
    s_add_u32 s39, s38, 33566720
    buffer_load_dwordx4 v24, s[8:11], s39 offen offset:0 sc1 nt lds
    buffer_load_dwordx4 v25, s[8:11], s39 offen offset:1024 sc1 nt lds
    buffer_load_dwordx4 v26, s[8:11], s39 offen offset:2048 sc1 nt lds
    buffer_load_dwordx4 v27, s[8:11], s39 offen offset:3072 sc1 nt lds
    s_waitcnt vmcnt(42)
    s_cmp_ge_u32 s95, 4
    s_cbranch_scc1 L_deep53
    s_waitcnt vmcnt(28)
L_deep53:
    s_add_u32 s38, s97, 163840
    s_and_b32 s38, s38, 262143
    s_add_u32 s38, s38, s45
    s_mov_b32 m0, 98304
    s_add_u32 s39, s38, 33554432
    buffer_load_dwordx4 v16, s[12:15], s39 offen offset:0 sc1 nt lds
    buffer_load_dwordx4 v16, s[12:15], s39 offen offset:1024 sc1 nt lds
    buffer_load_dwordx4 v16, s[12:15], s39 offen offset:2048 sc1 nt lds
    buffer_load_dwordx4 v16, s[12:15], s39 offen offset:3072 sc1 nt lds
    s_waitcnt vmcnt(42)
    s_cmp_ge_u32 s95, 4
    s_cbranch_scc1 L_deep54_4
    s_waitcnt vmcnt(18)
L_deep54_4:
    s_mov_b32 m0, 102400
    s_add_u32 s39, s38, 33558528
    buffer_load_dwordx4 v16, s[12:15], s39 offen offset:0 sc1 nt lds
    buffer_load_dwordx4 v16, s[12:15], s39 offen offset:1024 sc1 nt lds
    buffer_load_dwordx4 v16, s[12:15], s39 offen offset:2048 sc1 nt lds
    buffer_load_dwordx4 v16, s[12:15], s39 offen offset:3072 sc1 nt lds
    s_waitcnt vmcnt(42)
    s_cmp_ge_u32 s95, 4
    s_cbranch_scc1 L_deep54_8
    s_waitcnt vmcnt(18)
L_deep54_8:
    s_mov_b32 m0, 106496
    s_add_u32 s39, s38, 33562624
    buffer_load_dwordx4 v16, s[12:15], s39 offen offset:0 sc1 nt lds
    buffer_load_dwordx4 v16, s[12:15], s39 offen offset:1024 sc1 nt lds
    buffer_load_dwordx4 v16, s[12:15], s39 offen offset:2048 sc1 nt lds
    buffer_load_dwordx4 v16, s[12:15], s39 offen offset:3072 sc1 nt lds
    s_waitcnt vmcnt(42)
    s_cmp_ge_u32 s95, 4
    s_cbranch_scc1 L_deep54_12
    s_waitcnt vmcnt(18)
L_deep54_12:
    s_mov_b32 m0, 110592
    s_add_u32 s39, s38, 33566720
    buffer_load_dwordx4 v16, s[12:15], s39 offen offset:0 sc1 nt lds
    buffer_load_dwordx4 v16, s[12:15], s39 offen offset:1024 sc1 nt lds
    buffer_load_dwordx4 v16, s[12:15], s39 offen offset:2048 sc1 nt lds
    buffer_load_dwordx4 v16, s[12:15], s39 offen offset:3072 sc1 nt lds
    s_waitcnt vmcnt(42)
    s_cmp_ge_u32 s95, 4
    s_cbranch_scc1 L_deep54
    s_waitcnt vmcnt(18)
L_deep54:
    s_barrier
    s_add_u32 s38, s96, 100
    v_mov_b32 v35, s38
    s_mov_b64 exec, 1
    buffer_store_dword v35, v32, s[28:31], 0 offen
    s_mov_b64 exec, -1
    s_waitcnt vmcnt(33)
    v_subrev_u32 v34, s96, v34
    v_subrev_u32 v34, 100, v34
    v_cmp_gt_u32 vcc, 64, v34
    s_bcnt1_i32_b32 s95, vcc_lo
    buffer_load_dword v34, v33, s[28:31], 0 offen sc1
    s_add_u32 s38, s97, 196608
    s_and_b32 s38, s38, 262143
    s_add_u32 s38, s38, s45
    s_mov_b32 m0, 114688
    s_add_u32 s39, s38, 33554432
    buffer_load_dwordx4 v24, s[8:11], s39 offen offset:0 sc1 nt lds
    buffer_load_dwordx4 v25, s[8:11], s39 offen offset:1024 sc1 nt lds
    buffer_load_dwordx4 v26, s[8:11], s39 offen offset:2048 sc1 nt lds
    buffer_load_dwordx4 v27, s[8:11], s39 offen offset:3072 sc1 nt lds
    s_cmp_ge_u32 s95, 4
    s_cbranch_scc1 L_deep55_4
    s_waitcnt vmcnt(20)
L_deep55_4:
    s_mov_b32 m0, 118784
    s_add_u32 s39, s38, 33558528
    buffer_load_dwordx4 v24, s[8:11], s39 offen offset:0 sc1 nt lds
    buffer_load_dwordx4 v25, s[8:11], s39 offen offset:1024 sc1 nt lds
    buffer_load_dwordx4 v26, s[8:11], s39 offen offset:2048 sc1 nt lds
    buffer_load_dwordx4 v27, s[8:11], s39 offen offset:3072 sc1 nt lds
    s_cmp_ge_u32 s95, 4
    s_cbranch_scc1 L_deep55_8
    s_waitcnt vmcnt(20)
L_deep55_8:
    s_mov_b32 m0, 122880
    s_add_u32 s39, s38, 33562624
    buffer_load_dwordx4 v24, s[8:11], s39 offen offset:0 sc1 nt lds
    buffer_load_dwordx4 v25, s[8:11], s39 offen offset:1024 sc1 nt lds
    buffer_load_dwordx4 v26, s[8:11], s39 offen offset:2048 sc1 nt lds
    buffer_load_dwordx4 v27, s[8:11], s39 offen offset:3072 sc1 nt lds
    s_waitcnt vmcnt(42)
    s_cmp_ge_u32 s95, 4
    s_cbranch_scc1 L_deep55_12
    s_waitcnt vmcnt(20)
L_deep55_12:
    s_mov_b32 m0, 126976
    s_add_u32 s39, s38, 33566720
    buffer_load_dwordx4 v24, s[8:11], s39 offen offset:0 sc1 nt lds
    buffer_load_dwordx4 v25, s[8:11], s39 offen offset:1024 sc1 nt lds
    buffer_load_dwordx4 v26, s[8:11], s39 offen offset:2048 sc1 nt lds
    buffer_load_dwordx4 v27, s[8:11], s39 offen offset:3072 sc1 nt lds
    s_waitcnt vmcnt(42)
    s_cmp_ge_u32 s95, 4
    s_cbranch_scc1 L_deep55
    s_waitcnt vmcnt(20)
L_deep55:
    s_add_u32 s38, s97, 180224
    s_and_b32 s38, s38, 262143
    s_add_u32 s38, s38, s45
    s_mov_b32 m0, 131072
    s_add_u32 s39, s38, 33554432
    buffer_load_dwordx4 v16, s[12:15], s39 offen offset:0 sc1 nt lds
    buffer_load_dwordx4 v16, s[12:15], s39 offen offset:1024 sc1 nt lds
    buffer_load_dwordx4 v16, s[12:15], s39 offen offset:2048 sc1 nt lds
    buffer_load_dwordx4 v16, s[12:15], s39 offen offset:3072 sc1 nt lds
    s_waitcnt vmcnt(42)
    s_cmp_ge_u32 s95, 4
    s_cbranch_scc1 L_deep56_4
    s_waitcnt vmcnt(18)
L_deep56_4:
    s_mov_b32 m0, 135168
    s_add_u32 s39, s38, 33558528
    buffer_load_dwordx4 v16, s[12:15], s39 offen offset:0 sc1 nt lds
    buffer_load_dwordx4 v16, s[12:15], s39 offen offset:1024 sc1 nt lds
    buffer_load_dwordx4 v16, s[12:15], s39 offen offset:2048 sc1 nt lds
    buffer_load_dwordx4 v16, s[12:15], s39 offen offset:3072 sc1 nt lds
    s_waitcnt vmcnt(42)
    s_cmp_ge_u32 s95, 4
    s_cbranch_scc1 L_deep56_8
    s_waitcnt vmcnt(18)
L_deep56_8:
    s_mov_b32 m0, 139264
    s_add_u32 s39, s38, 33562624
    buffer_load_dwordx4 v16, s[12:15], s39 offen offset:0 sc1 nt lds
    buffer_load_dwordx4 v16, s[12:15], s39 offen offset:1024 sc1 nt lds
    buffer_load_dwordx4 v16, s[12:15], s39 offen offset:2048 sc1 nt lds
    buffer_load_dwordx4 v16, s[12:15], s39 offen offset:3072 sc1 nt lds
    s_waitcnt vmcnt(42)
    s_cmp_ge_u32 s95, 4
    s_cbranch_scc1 L_deep56_12
    s_waitcnt vmcnt(18)
L_deep56_12:
    s_mov_b32 m0, 143360
    s_add_u32 s39, s38, 33566720
    buffer_load_dwordx4 v16, s[12:15], s39 offen offset:0 sc1 nt lds
    buffer_load_dwordx4 v16, s[12:15], s39 offen offset:1024 sc1 nt lds
    buffer_load_dwordx4 v16, s[12:15], s39 offen offset:2048 sc1 nt lds
    buffer_load_dwordx4 v16, s[12:15], s39 offen offset:3072 sc1 nt lds
    s_waitcnt vmcnt(42)
    s_cmp_ge_u32 s95, 4
    s_cbranch_scc1 L_deep56
    s_waitcnt vmcnt(18)
L_deep56:
    s_waitcnt vmcnt(34)
    s_barrier
    ds_read_b64_tr_b16 v[224:225], v29 offset:0
    ds_read_b64_tr_b16 v[226:227], v29 offset:1024
    ds_read_b64_tr_b16 v[228:229], v30 offset:0
    ds_read_b64_tr_b16 v[230:231], v30 offset:1024
    ds_read_b64_tr_b16 v[232:233], v29 offset:2048
    ds_read_b64_tr_b16 v[234:235], v29 offset:3072
    ds_read_b64_tr_b16 v[236:237], v30 offset:2048
    ds_read_b64_tr_b16 v[238:239], v30 offset:3072
    ds_read_b64_tr_b16 v[240:241], v29 offset:4096
    ds_read_b64_tr_b16 v[242:243], v29 offset:5120
    ds_read_b64_tr_b16 v[244:245], v30 offset:4096
    ds_read_b64_tr_b16 v[246:247], v30 offset:5120
    ds_read_b64_tr_b16 v[248:249], v29 offset:6144
    ds_read_b64_tr_b16 v[250:251], v29 offset:7168
    ds_read_b64_tr_b16 v[252:253], v30 offset:6144
    ds_read_b64_tr_b16 v[254:255], v30 offset:7168
    s_add_u32 s38, s96, 104
    v_mov_b32 v35, s38
    s_mov_b64 exec, 1
    buffer_store_dword v35, v32, s[28:31], 0 offen
    s_mov_b64 exec, -1
    s_waitcnt vmcnt(33)
    v_subrev_u32 v34, s96, v34
    v_subrev_u32 v34, 104, v34
    v_cmp_gt_u32 vcc, 64, v34
    s_bcnt1_i32_b32 s95, vcc_lo
    buffer_load_dword v34, v33, s[28:31], 0 offen sc1
    s_add_u32 s38, s97, 212992
    s_and_b32 s38, s38, 262143
    s_add_u32 s38, s38, s45
    s_mov_b32 m0, 147456
    s_add_u32 s39, s38, 33554432
    buffer_load_dwordx4 v24, s[8:11], s39 offen offset:0 sc1 nt lds
    buffer_load_dwordx4 v25, s[8:11], s39 offen offset:1024 sc1 nt lds
    buffer_load_dwordx4 v26, s[8:11], s39 offen offset:2048 sc1 nt lds
    buffer_load_dwordx4 v27, s[8:11], s39 offen offset:3072 sc1 nt lds
    s_cmp_ge_u32 s95, 4
    s_cbranch_scc1 L_deep57_4
    s_waitcnt vmcnt(20)
L_deep57_4:
    s_mov_b32 m0, 151552
    s_add_u32 s39, s38, 33558528
    buffer_load_dwordx4 v24, s[8:11], s39 offen offset:0 sc1 nt lds
    buffer_load_dwordx4 v25, s[8:11], s39 offen offset:1024 sc1 nt lds
    buffer_load_dwordx4 v26, s[8:11], s39 offen offset:2048 sc1 nt lds
    buffer_load_dwordx4 v27, s[8:11], s39 offen offset:3072 sc1 nt lds
    s_cmp_ge_u32 s95, 4
    s_cbranch_scc1 L_deep57_8
    s_waitcnt vmcnt(20)
L_deep57_8:
    s_mov_b32 m0, 155648
    s_add_u32 s39, s38, 33562624
    buffer_load_dwordx4 v24, s[8:11], s39 offen offset:0 sc1 nt lds
    buffer_load_dwordx4 v25, s[8:11], s39 offen offset:1024 sc1 nt lds
    buffer_load_dwordx4 v26, s[8:11], s39 offen offset:2048 sc1 nt lds
    buffer_load_dwordx4 v27, s[8:11], s39 offen offset:3072 sc1 nt lds
    s_waitcnt vmcnt(42)
    s_cmp_ge_u32 s95, 4
    s_cbranch_scc1 L_deep57_12
    s_waitcnt vmcnt(20)
L_deep57_12:
    s_mov_b32 m0, 159744
    s_add_u32 s39, s38, 33566720
    buffer_load_dwordx4 v24, s[8:11], s39 offen offset:0 sc1 nt lds
    buffer_load_dwordx4 v25, s[8:11], s39 offen offset:1024 sc1 nt lds
    buffer_load_dwordx4 v26, s[8:11], s39 offen offset:2048 sc1 nt lds
    buffer_load_dwordx4 v27, s[8:11], s39 offen offset:3072 sc1 nt lds
    s_waitcnt vmcnt(42)
    s_cmp_ge_u32 s95, 4
    s_cbranch_scc1 L_deep57
    s_waitcnt vmcnt(20)
L_deep57:
    s_add_u32 s38, s97, 196608
    s_and_b32 s38, s38, 262143
    s_add_u32 s38, s38, s45
    s_mov_b32 m0, 32768
    s_add_u32 s39, s38, 33554432
    buffer_load_dwordx4 v16, s[12:15], s39 offen offset:0 sc1 nt lds
    buffer_load_dwordx4 v16, s[12:15], s39 offen offset:1024 sc1 nt lds
    buffer_load_dwordx4 v16, s[12:15], s39 offen offset:2048 sc1 nt lds
    buffer_load_dwordx4 v16, s[12:15], s39 offen offset:3072 sc1 nt lds
    s_waitcnt vmcnt(42)
    s_cmp_ge_u32 s95, 4
    s_cbranch_scc1 L_deep58_4
    s_waitcnt vmcnt(18)
L_deep58_4:
    s_mov_b32 m0, 36864
    s_add_u32 s39, s38, 33558528
    buffer_load_dwordx4 v16, s[12:15], s39 offen offset:0 sc1 nt lds
    buffer_load_dwordx4 v16, s[12:15], s39 offen offset:1024 sc1 nt lds
    buffer_load_dwordx4 v16, s[12:15], s39 offen offset:2048 sc1 nt lds
    buffer_load_dwordx4 v16, s[12:15], s39 offen offset:3072 sc1 nt lds
    s_waitcnt vmcnt(42)
    s_cmp_ge_u32 s95, 4
    s_cbranch_scc1 L_deep58_8
    s_waitcnt vmcnt(18)
L_deep58_8:
    s_mov_b32 m0, 40960
    s_add_u32 s39, s38, 33562624
    buffer_load_dwordx4 v16, s[12:15], s39 offen offset:0 sc1 nt lds
    buffer_load_dwordx4 v16, s[12:15], s39 offen offset:1024 sc1 nt lds
    buffer_load_dwordx4 v16, s[12:15], s39 offen offset:2048 sc1 nt lds
    buffer_load_dwordx4 v16, s[12:15], s39 offen offset:3072 sc1 nt lds
    s_waitcnt vmcnt(42)
    s_cmp_ge_u32 s95, 4
    s_cbranch_scc1 L_deep58_12
    s_waitcnt vmcnt(18)
L_deep58_12:
    s_mov_b32 m0, 45056
    s_add_u32 s39, s38, 33566720
    buffer_load_dwordx4 v16, s[12:15], s39 offen offset:0 sc1 nt lds
    buffer_load_dwordx4 v16, s[12:15], s39 offen offset:1024 sc1 nt lds
    buffer_load_dwordx4 v16, s[12:15], s39 offen offset:2048 sc1 nt lds
    buffer_load_dwordx4 v16, s[12:15], s39 offen offset:3072 sc1 nt lds
    s_waitcnt vmcnt(42)
    s_cmp_ge_u32 s95, 4
    s_cbranch_scc1 L_deep58
    s_waitcnt vmcnt(18)
L_deep58:
    s_waitcnt lgkmcnt(0)
    s_add_u32 s40, s90, 3932160
    s_add_u32 s38, s94, 8
    s_and_b32 s38, s38, 15
    s_mul_i32 s38, s38, 81920
    s_add_u32 s38, s38, s40
    s_mov_b32 m0, 24576
    s_add_u32 s39, s38, 0
    buffer_load_dwordx4 v12, s[20:23], s39 offen offset:0 sc1 lds
    buffer_load_dwordx4 v13, s[20:23], s39 offen offset:1024 sc1 lds
    buffer_load_dwordx4 v14, s[20:23], s39 offen offset:2048 sc1 lds
    buffer_load_dwordx4 v15, s[20:23], s39 offen offset:3072 sc1 lds
    s_mov_b32 m0, 28672
    s_add_u32 s39, s38, 40960
    buffer_load_dwordx4 v12, s[20:23], s39 offen offset:0 sc1 lds
    buffer_load_dwordx4 v13, s[20:23], s39 offen offset:1024 sc1 lds
    buffer_load_dwordx4 v14, s[20:23], s39 offen offset:2048 sc1 lds
    buffer_load_dwordx4 v15, s[20:23], s39 offen offset:3072 sc1 lds
    s_waitcnt vmcnt(42)
    s_barrier
    s_add_u32 s38, s96, 108
    v_mov_b32 v35, s38
    s_mov_b64 exec, 1
    buffer_store_dword v35, v32, s[28:31], 0 offen
    s_mov_b64 exec, -1
    s_waitcnt vmcnt(41)
    v_subrev_u32 v34, s96, v34
    v_subrev_u32 v34, 108, v34
    v_cmp_gt_u32 vcc, 64, v34
    s_bcnt1_i32_b32 s95, vcc_lo
    s_add_u32 s38, s97, 229376
    s_and_b32 s38, s38, 262143
    s_add_u32 s38, s38, s45
    s_mov_b32 m0, 49152
    s_add_u32 s39, s38, 33554432
    buffer_load_dwordx4 v24, s[8:11], s39 offen offset:0 sc1 nt lds
    buffer_load_dwordx4 v25, s[8:11], s39 offen offset:1024 sc1 nt lds
    buffer_load_dwordx4 v26, s[8:11], s39 offen offset:2048 sc1 nt lds
    buffer_load_dwordx4 v27, s[8:11], s39 offen offset:3072 sc1 nt lds
    s_waitcnt vmcnt(41)
    s_cmp_ge_u32 s95, 4
    s_cbranch_scc1 L_deep59_4
    s_waitcnt vmcnt(27)
L_deep59_4:
    s_mov_b32 m0, 53248
    s_add_u32 s39, s38, 33558528
    buffer_load_dwordx4 v24, s[8:11], s39 offen offset:0 sc1 nt lds
    buffer_load_dwordx4 v25, s[8:11], s39 offen offset:1024 sc1 nt lds
    buffer_load_dwordx4 v26, s[8:11], s39 offen offset:2048 sc1 nt lds
    buffer_load_dwordx4 v27, s[8:11], s39 offen offset:3072 sc1 nt lds
    s_waitcnt vmcnt(41)
    s_cmp_ge_u32 s95, 4
    s_cbranch_scc1 L_deep59_8
    s_waitcnt vmcnt(27)
L_deep59_8:
    s_mov_b32 m0, 57344
    s_add_u32 s39, s38, 33562624
    buffer_load_dwordx4 v24, s[8:11], s39 offen offset:0 sc1 nt lds
    buffer_load_dwordx4 v25, s[8:11], s39 offen offset:1024 sc1 nt lds
    buffer_load_dwordx4 v26, s[8:11], s39 offen offset:2048 sc1 nt lds
    buffer_load_dwordx4 v27, s[8:11], s39 offen offset:3072 sc1 nt lds
    s_waitcnt vmcnt(41)
    s_cmp_ge_u32 s95, 4
    s_cbranch_scc1 L_deep59_12
    s_waitcnt vmcnt(27)
L_deep59_12:
    s_mov_b32 m0, 61440
    s_add_u32 s39, s38, 33566720
    buffer_load_dwordx4 v24, s[8:11], s39 offen offset:0 sc1 nt lds
    buffer_load_dwordx4 v25, s[8:11], s39 offen offset:1024 sc1 nt lds
    buffer_load_dwordx4 v26, s[8:11], s39 offen offset:2048 sc1 nt lds
    buffer_load_dwordx4 v27, s[8:11], s39 offen offset:3072 sc1 nt lds
    s_waitcnt vmcnt(41)
    s_cmp_ge_u32 s95, 4
    s_cbranch_scc1 L_deep59
    s_waitcnt vmcnt(27)
L_deep59:
    s_add_u32 s38, s97, 212992
    s_and_b32 s38, s38, 262143
    s_add_u32 s38, s38, s45
    s_mov_b32 m0, 65536
    s_add_u32 s39, s38, 33554432
    buffer_load_dwordx4 v16, s[12:15], s39 offen offset:0 sc1 nt lds
    buffer_load_dwordx4 v16, s[12:15], s39 offen offset:1024 sc1 nt lds
    buffer_load_dwordx4 v16, s[12:15], s39 offen offset:2048 sc1 nt lds
    buffer_load_dwordx4 v16, s[12:15], s39 offen offset:3072 sc1 nt lds
    s_waitcnt vmcnt(41)
    s_cmp_ge_u32 s95, 4
    s_cbranch_scc1 L_deep60_4
    s_waitcnt vmcnt(18)
L_deep60_4:
    s_mov_b32 m0, 69632
    s_add_u32 s39, s38, 33558528
    buffer_load_dwordx4 v16, s[12:15], s39 offen offset:0 sc1 nt lds
    buffer_load_dwordx4 v16, s[12:15], s39 offen offset:1024 sc1 nt lds
    buffer_load_dwordx4 v16, s[12:15], s39 offen offset:2048 sc1 nt lds
    buffer_load_dwordx4 v16, s[12:15], s39 offen offset:3072 sc1 nt lds
    s_waitcnt vmcnt(41)
    s_cmp_ge_u32 s95, 4
    s_cbranch_scc1 L_deep60_8
    s_waitcnt vmcnt(18)
L_deep60_8:
    s_mov_b32 m0, 73728
    s_add_u32 s39, s38, 33562624
    buffer_load_dwordx4 v16, s[12:15], s39 offen offset:0 sc1 nt lds
    buffer_load_dwordx4 v16, s[12:15], s39 offen offset:1024 sc1 nt lds
    buffer_load_dwordx4 v16, s[12:15], s39 offen offset:2048 sc1 nt lds
    buffer_load_dwordx4 v16, s[12:15], s39 offen offset:3072 sc1 nt lds
    s_waitcnt vmcnt(41)
    s_cmp_ge_u32 s95, 4
    s_cbranch_scc1 L_deep60_12
    s_waitcnt vmcnt(18)
L_deep60_12:
    s_mov_b32 m0, 77824
    s_add_u32 s39, s38, 33566720
    buffer_load_dwordx4 v16, s[12:15], s39 offen offset:0 sc1 nt lds
    buffer_load_dwordx4 v16, s[12:15], s39 offen offset:1024 sc1 nt lds
    buffer_load_dwordx4 v16, s[12:15], s39 offen offset:2048 sc1 nt lds
    buffer_load_dwordx4 v16, s[12:15], s39 offen offset:3072 sc1 nt lds
    s_waitcnt vmcnt(41)
    s_cmp_ge_u32 s95, 4
    s_cbranch_scc1 L_deep60
    s_waitcnt vmcnt(18)
L_deep60:
    s_barrier
    s_add_u32 s38, s96, 112
    v_mov_b32 v35, s38
    s_mov_b64 exec, 1
    buffer_store_dword v35, v32, s[28:31], 0 offen
    s_mov_b64 exec, -1
    buffer_load_dword v23, v18, s[28:31], 0 offen sc1
    s_add_u32 s38, s97, 245760
    s_and_b32 s38, s38, 262143
    s_add_u32 s38, s38, s45
    s_mov_b32 m0, 81920
    s_add_u32 s39, s38, 33554432
    buffer_load_dwordx4 v24, s[8:11], s39 offen offset:0 sc1 nt lds
    buffer_load_dwordx4 v25, s[8:11], s39 offen offset:1024 sc1 nt lds
    buffer_load_dwordx4 v26, s[8:11], s39 offen offset:2048 sc1 nt lds
    buffer_load_dwordx4 v27, s[8:11], s39 offen offset:3072 sc1 nt lds
    s_mov_b32 m0, 86016
    s_add_u32 s39, s38, 33558528
    buffer_load_dwordx4 v24, s[8:11], s39 offen offset:0 sc1 nt lds
    buffer_load_dwordx4 v25, s[8:11], s39 offen offset:1024 sc1 nt lds
    buffer_load_dwordx4 v26, s[8:11], s39 offen offset:2048 sc1 nt lds
    buffer_load_dwordx4 v27, s[8:11], s39 offen offset:3072 sc1 nt lds
    s_mov_b32 m0, 90112
    s_add_u32 s39, s38, 33562624
    buffer_load_dwordx4 v24, s[8:11], s39 offen offset:0 sc1 nt lds
    buffer_load_dwordx4 v25, s[8:11], s39 offen offset:1024 sc1 nt lds
    buffer_load_dwordx4 v26, s[8:11], s39 offen offset:2048 sc1 nt lds
    buffer_load_dwordx4 v27, s[8:11], s39 offen offset:3072 sc1 nt lds
    s_mov_b32 m0, 94208
    s_add_u32 s39, s38, 33566720
    buffer_load_dwordx4 v24, s[8:11], s39 offen offset:0 sc1 nt lds
    buffer_load_dwordx4 v25, s[8:11], s39 offen offset:1024 sc1 nt lds
    buffer_load_dwordx4 v26, s[8:11], s39 offen offset:2048 sc1 nt lds
    buffer_load_dwordx4 v27, s[8:11], s39 offen offset:3072 sc1 nt lds
    s_waitcnt vmcnt(51)
    s_waitcnt vmcnt(50)
    s_waitcnt vmcnt(46)
    s_waitcnt vmcnt(42)
    s_add_u32 s38, s97, 229376
    s_and_b32 s38, s38, 262143
    s_add_u32 s38, s38, s45
    s_mov_b32 m0, 98304
    s_add_u32 s39, s38, 33554432
    buffer_load_dwordx4 v16, s[12:15], s39 offen offset:0 sc1 nt lds
    buffer_load_dwordx4 v16, s[12:15], s39 offen offset:1024 sc1 nt lds
    buffer_load_dwordx4 v16, s[12:15], s39 offen offset:2048 sc1 nt lds
    buffer_load_dwordx4 v16, s[12:15], s39 offen offset:3072 sc1 nt lds
    s_mov_b32 m0, 102400
    s_add_u32 s39, s38, 33558528
    buffer_load_dwordx4 v16, s[12:15], s39 offen offset:0 sc1 nt lds
    buffer_load_dwordx4 v16, s[12:15], s39 offen offset:1024 sc1 nt lds
    buffer_load_dwordx4 v16, s[12:15], s39 offen offset:2048 sc1 nt lds
    buffer_load_dwordx4 v16, s[12:15], s39 offen offset:3072 sc1 nt lds
    s_mov_b32 m0, 106496
    s_add_u32 s39, s38, 33562624
    buffer_load_dwordx4 v16, s[12:15], s39 offen offset:0 sc1 nt lds
    buffer_load_dwordx4 v16, s[12:15], s39 offen offset:1024 sc1 nt lds
    buffer_load_dwordx4 v16, s[12:15], s39 offen offset:2048 sc1 nt lds
    buffer_load_dwordx4 v16, s[12:15], s39 offen offset:3072 sc1 nt lds
    s_mov_b32 m0, 110592
    s_add_u32 s39, s38, 33566720
    buffer_load_dwordx4 v16, s[12:15], s39 offen offset:0 sc1 nt lds
    buffer_load_dwordx4 v16, s[12:15], s39 offen offset:1024 sc1 nt lds
    buffer_load_dwordx4 v16, s[12:15], s39 offen offset:2048 sc1 nt lds
    buffer_load_dwordx4 v16, s[12:15], s39 offen offset:3072 sc1 nt lds
    s_waitcnt vmcnt(32)
    s_add_u32 s41, s96, 1
    v_and_b32 v23, -3, v23
    v_cmp_eq_u32 vcc, s41, v23
    s_cmp_eq_u64 vcc, -1
    s_cbranch_scc1 L_polled_r1
    s_mov_b32 s93, 0x20000
L_poll_r1:
    s_sleep 4
    buffer_load_dword v23, v18, s[28:31], 0 offen sc1
    s_waitcnt vmcnt(0)
    v_and_b32 v23, -3, v23
    v_cmp_eq_u32 vcc, s41, v23
    s_cmp_eq_u64 vcc, -1
    s_cbranch_scc1 L_polled_r1
    s_sub_u32 s93, s93, 1
    s_cmp_lg_u32 s93, 0
    s_cbranch_scc1 L_poll_r1
L_polled_r1:
    s_barrier
    s_add_u32 s38, s97, 245760
    s_and_b32 s38, s38, 262143
    s_add_u32 s38, s38, s45
    s_mov_b32 m0, 131072
    s_add_u32 s39, s38, 33554432
    buffer_load_dwordx4 v16, s[12:15], s39 offen offset:0 sc1 nt lds
    buffer_load_dwordx4 v16, s[12:15], s39 offen offset:1024 sc1 nt lds
    buffer_load_dwordx4 v16, s[12:15], s39 offen offset:2048 sc1 nt lds
    buffer_load_dwordx4 v16, s[12:15], s39 offen offset:3072 sc1 nt lds
    s_mov_b32 m0, 135168
    s_add_u32 s39, s38, 33558528
    buffer_load_dwordx4 v16, s[12:15], s39 offen offset:0 sc1 nt lds
    buffer_load_dwordx4 v16, s[12:15], s39 offen offset:1024 sc1 nt lds
    buffer_load_dwordx4 v16, s[12:15], s39 offen offset:2048 sc1 nt lds
    buffer_load_dwordx4 v16, s[12:15], s39 offen offset:3072 sc1 nt lds
    s_mov_b32 m0, 139264
    s_add_u32 s39, s38, 33562624
    buffer_load_dwordx4 v16, s[12:15], s39 offen offset:0 sc1 nt lds
    buffer_load_dwordx4 v16, s[12:15], s39 offen offset:1024 sc1 nt lds
    buffer_load_dwordx4 v16, s[12:15], s39 offen offset:2048 sc1 nt lds
    buffer_load_dwordx4 v16, s[12:15], s39 offen offset:3072 sc1 nt lds
    s_mov_b32 m0, 143360
    s_add_u32 s39, s38, 33566720
    buffer_load_dwordx4 v16, s[12:15], s39 offen offset:0 sc1 nt lds
    buffer_load_dwordx4 v16, s[12:15], s39 offen offset:1024 sc1 nt lds
    buffer_load_dwordx4 v16, s[12:15], s39 offen offset:2048 sc1 nt lds
    buffer_load_dwordx4 v16, s[12:15], s39 offen offset:3072 sc1 nt lds
    s_waitcnt vmcnt(32)
    s_add_u32 s40, s90, 0
    s_add_u32 s38, s94, 9
    s_and_b32 s38, s38, 15
    s_mul_i32 s38, s38, 81920
    s_add_u32 s38, s38, s40
    s_mov_b32 m0, 32768
    s_add_u32 s39, s38, 0
    buffer_load_dwordx4 v12, s[20:23], s39 offen offset:0 sc1 lds
    buffer_load_dwordx4 v13, s[20:23], s39 offen offset:1024 sc1 lds
    buffer_load_dwordx4 v14, s[20:23], s39 offen offset:2048 sc1 lds
    buffer_load_dwordx4 v15, s[20:23], s39 offen offset:3072 sc1 lds
    s_mov_b32 m0, 36864
    s_add_u32 s39, s38, 40960
    buffer_load_dwordx4 v12, s[20:23], s39 offen offset:0 sc1 lds
    buffer_load_dwordx4 v13, s[20:23], s39 offen offset:1024 sc1 lds
    buffer_load_dwordx4 v14, s[20:23], s39 offen offset:2048 sc1 lds
    buffer_load_dwordx4 v15, s[20:23], s39 offen offset:3072 sc1 lds
    s_add_u32 s40, s90, 1310720
    s_add_u32 s38, s94, 9
    s_and_b32 s38, s38, 15
    s_mul_i32 s38, s38, 81920
    s_add_u32 s38, s38, s40
    s_mov_b32 m0, 40960
    s_add_u32 s39, s38, 0
    buffer_load_dwordx4 v12, s[20:23], s39 offen offset:0 sc1 lds
    buffer_load_dwordx4 v13, s[20:23], s39 offen offset:1024 sc1 lds
    buffer_load_dwordx4 v14, s[20:23], s39 offen offset:2048 sc1 lds
    buffer_load_dwordx4 v15, s[20:23], s39 offen offset:3072 sc1 lds
    s_mov_b32 m0, 45056
    s_add_u32 s39, s38, 40960
    buffer_load_dwordx4 v12, s[20:23], s39 offen offset:0 sc1 lds
    buffer_load_dwordx4 v13, s[20:23], s39 offen offset:1024 sc1 lds
    buffer_load_dwordx4 v14, s[20:23], s39 offen offset:2048 sc1 lds
    buffer_load_dwordx4 v15, s[20:23], s39 offen offset:3072 sc1 lds
    s_waitcnt vmcnt(32)
    s_barrier
    s_mul_i32 s91, s35, 24
    s_add_u32 s91, s91, s57
    s_lshl_b32 s91, s91, 2
    s_add_u32 s91, s91, s34
    s_lshl_b32 s91, s91, 16
    s_add_u32 s40, s90, 2621440
    s_add_u32 s38, s94, 9
    s_and_b32 s38, s38, 15
    s_mul_i32 s38, s38, 81920
    s_add_u32 s38, s38, s40
    s_mov_b32 m0, 49152
    s_add_u32 s39, s38, 0
    buffer_load_dwordx4 v12, s[20:23], s39 offen offset:0 sc1 lds
    buffer_load_dwordx4 v13, s[20:23], s39 offen offset:1024 sc1 lds
    buffer_load_dwordx4 v14, s[20:23], s39 offen offset:2048 sc1 lds
    buffer_load_dwordx4 v15, s[20:23], s39 offen offset:3072 sc1 lds
    s_mov_b32 m0, 53248
    s_add_u32 s39, s38, 40960
    buffer_load_dwordx4 v12, s[20:23], s39 offen offset:0 sc1 lds
    buffer_load_dwordx4 v13, s[20:23], s39 offen offset:1024 sc1 lds
    buffer_load_dwordx4 v14, s[20:23], s39 offen offset:2048 sc1 lds
    buffer_load_dwordx4 v15, s[20:23], s39 offen offset:3072 sc1 lds
    s_add_u32 s40, s90, 3932160
    s_add_u32 s38, s94, 9
    s_and_b32 s38, s38, 15
    s_mul_i32 s38, s38, 81920
    s_add_u32 s38, s38, s40
    s_mov_b32 m0, 57344
    s_add_u32 s39, s38, 0
    buffer_load_dwordx4 v12, s[20:23], s39 offen offset:0 sc1 lds
    buffer_load_dwordx4 v13, s[20:23], s39 offen offset:1024 sc1 lds
    buffer_load_dwordx4 v14, s[20:23], s39 offen offset:2048 sc1 lds
    buffer_load_dwordx4 v15, s[20:23], s39 offen offset:3072 sc1 lds
    s_mov_b32 m0, 61440
    s_add_u32 s39, s38, 40960
    buffer_load_dwordx4 v12, s[20:23], s39 offen offset:0 sc1 lds
    buffer_load_dwordx4 v13, s[20:23], s39 offen offset:1024 sc1 lds
    buffer_load_dwordx4 v14, s[20:23], s39 offen offset:2048 sc1 lds
    buffer_load_dwordx4 v15, s[20:23], s39 offen offset:3072 sc1 lds
    s_waitcnt vmcnt(32)
    s_barrier
    s_add_u32 s40, s90, 0
    s_add_u32 s38, s94, 10
    s_and_b32 s38, s38, 15
    s_mul_i32 s38, s38, 81920
    s_add_u32 s38, s38, s40
    s_mov_b32 m0, 65536
    s_add_u32 s39, s38, 0
    buffer_load_dwordx4 v12, s[20:23], s39 offen offset:0 sc1 lds
    buffer_load_dwordx4 v13, s[20:23], s39 offen offset:1024 sc1 lds
    buffer_load_dwordx4 v14, s[20:23], s39 offen offset:2048 sc1 lds
    buffer_load_dwordx4 v15, s[20:23], s39 offen offset:3072 sc1 lds
    s_mov_b32 m0, 69632
    s_add_u32 s39, s38, 40960
    buffer_load_dwordx4 v12, s[20:23], s39 offen offset:0 sc1 lds
    buffer_load_dwordx4 v13, s[20:23], s39 offen offset:1024 sc1 lds
    buffer_load_dwordx4 v14, s[20:23], s39 offen offset:2048 sc1 lds
    buffer_load_dwordx4 v15, s[20:23], s39 offen offset:3072 sc1 lds
    s_add_u32 s40, s90, 1310720
    s_add_u32 s38, s94, 10
    s_and_b32 s38, s38, 15
    s_mul_i32 s38, s38, 81920
    s_add_u32 s38, s38, s40
    s_mov_b32 m0, 73728
    s_add_u32 s39, s38, 0
    buffer_load_dwordx4 v12, s[20:23], s39 offen offset:0 sc1 lds
    buffer_load_dwordx4 v13, s[20:23], s39 offen offset:1024 sc1 lds
    buffer_load_dwordx4 v14, s[20:23], s39 offen offset:2048 sc1 lds
    buffer_load_dwordx4 v15, s[20:23], s39 offen offset:3072 sc1 lds
    s_mov_b32 m0, 77824
    s_add_u32 s39, s38, 40960
    buffer_load_dwordx4 v12, s[20:23], s39 offen offset:0 sc1 lds
    buffer_load_dwordx4 v13, s[20:23], s39 offen offset:1024 sc1 lds
    buffer_load_dwordx4 v14, s[20:23], s39 offen offset:2048 sc1 lds
    buffer_load_dwordx4 v15, s[20:23], s39 offen offset:3072 sc1 lds
    s_waitcnt vmcnt(32)
    s_add_u32 s40, s90, 2621440
    s_add_u32 s38, s94, 10
    s_and_b32 s38, s38, 15
    s_mul_i32 s38, s38, 81920
    s_add_u32 s38, s38, s40
    s_mov_b32 m0, 81920
    s_add_u32 s39, s38, 0
    buffer_load_dwordx4 v12, s[20:23], s39 offen offset:0 sc1 lds
    buffer_load_dwordx4 v13, s[20:23], s39 offen offset:1024 sc1 lds
    buffer_load_dwordx4 v14, s[20:23], s39 offen offset:2048 sc1 lds
    buffer_load_dwordx4 v15, s[20:23], s39 offen offset:3072 sc1 lds
    s_mov_b32 m0, 86016
    s_add_u32 s39, s38, 40960
    buffer_load_dwordx4 v12, s[20:23], s39 offen offset:0 sc1 lds
    buffer_load_dwordx4 v13, s[20:23], s39 offen offset:1024 sc1 lds
    buffer_load_dwordx4 v14, s[20:23], s39 offen offset:2048 sc1 lds
    buffer_load_dwordx4 v15, s[20:23], s39 offen offset:3072 sc1 lds
    s_add_u32 s40, s90, 3932160
    s_add_u32 s38, s94, 10
    s_and_b32 s38, s38, 15
    s_mul_i32 s38, s38, 81920
    s_add_u32 s38, s38, s40
    s_mov_b32 m0, 90112
    s_add_u32 s39, s38, 0
    buffer_load_dwordx4 v12, s[20:23], s39 offen offset:0 sc1 lds
    buffer_load_dwordx4 v13, s[20:23], s39 offen offset:1024 sc1 lds
    buffer_load_dwordx4 v14, s[20:23], s39 offen offset:2048 sc1 lds
    buffer_load_dwordx4 v15, s[20:23], s39 offen offset:3072 sc1 lds
    s_mov_b32 m0, 94208
    s_add_u32 s39, s38, 40960
    buffer_load_dwordx4 v12, s[20:23], s39 offen offset:0 sc1 lds
    buffer_load_dwordx4 v13, s[20:23], s39 offen offset:1024 sc1 lds
    buffer_load_dwordx4 v14, s[20:23], s39 offen offset:2048 sc1 lds
    buffer_load_dwordx4 v15, s[20:23], s39 offen offset:3072 sc1 lds
    s_waitcnt vmcnt(48)
    s_waitcnt vmcnt(32)
    s_add_u32 s40, s90, 0
    s_add_u32 s38, s94, 11
    s_and_b32 s38, s38, 15
    s_mul_i32 s38, s38, 81920
    s_add_u32 s38, s38, s40
    s_mov_b32 m0, 98304
    s_add_u32 s39, s38, 0
    buffer_load_dwordx4 v12, s[20:23], s39 offen offset:0 sc1 lds
    buffer_load_dwordx4 v13, s[20:23], s39 offen offset:1024 sc1 lds
    buffer_load_dwordx4 v14, s[20:23], s39 offen offset:2048 sc1 lds
    buffer_load_dwordx4 v15, s[20:23], s39 offen offset:3072 sc1 lds
    s_mov_b32 m0, 102400
    s_add_u32 s39, s38, 40960
    buffer_load_dwordx4 v12, s[20:23], s39 offen offset:0 sc1 lds
    buffer_load_dwordx4 v13, s[20:23], s39 offen offset:1024 sc1 lds
    buffer_load_dwordx4 v14, s[20:23], s39 offen offset:2048 sc1 lds
    buffer_load_dwordx4 v15, s[20:23], s39 offen offset:3072 sc1 lds
    s_add_u32 s40, s90, 1310720
    s_add_u32 s38, s94, 11
    s_and_b32 s38, s38, 15
    s_mul_i32 s38, s38, 81920
    s_add_u32 s38, s38, s40
    s_mov_b32 m0, 106496
    s_add_u32 s39, s38, 0
    buffer_load_dwordx4 v12, s[20:23], s39 offen offset:0 sc1 lds
    buffer_load_dwordx4 v13, s[20:23], s39 offen offset:1024 sc1 lds
    buffer_load_dwordx4 v14, s[20:23], s39 offen offset:2048 sc1 lds
    buffer_load_dwordx4 v15, s[20:23], s39 offen offset:3072 sc1 lds
    s_mov_b32 m0, 110592
    s_add_u32 s39, s38, 40960
    buffer_load_dwordx4 v12, s[20:23], s39 offen offset:0 sc1 lds
    buffer_load_dwordx4 v13, s[20:23], s39 offen offset:1024 sc1 lds
    buffer_load_dwordx4 v14, s[20:23], s39 offen offset:2048 sc1 lds
    buffer_load_dwordx4 v15, s[20:23], s39 offen offset:3072 sc1 lds
    s_waitcnt vmcnt(32)
    s_add_u32 s40, s90, 2621440
    s_add_u32 s38, s94, 11
    s_and_b32 s38, s38, 15
    s_mul_i32 s38, s38, 81920
    s_add_u32 s38, s38, s40
    s_mov_b32 m0, 114688
    s_add_u32 s39, s38, 0
    buffer_load_dwordx4 v12, s[20:23], s39 offen offset:0 sc1 lds
    buffer_load_dwordx4 v13, s[20:23], s39 offen offset:1024 sc1 lds
    buffer_load_dwordx4 v14, s[20:23], s39 offen offset:2048 sc1 lds
    buffer_load_dwordx4 v15, s[20:23], s39 offen offset:3072 sc1 lds
    s_mov_b32 m0, 118784
    s_add_u32 s39, s38, 40960
    buffer_load_dwordx4 v12, s[20:23], s39 offen offset:0 sc1 lds
    buffer_load_dwordx4 v13, s[20:23], s39 offen offset:1024 sc1 lds
    buffer_load_dwordx4 v14, s[20:23], s39 offen offset:2048 sc1 lds
    buffer_load_dwordx4 v15, s[20:23], s39 offen offset:3072 sc1 lds
    s_add_u32 s40, s90, 3932160
    s_add_u32 s38, s94, 11
    s_and_b32 s38, s38, 15
    s_mul_i32 s38, s38, 81920
    s_add_u32 s38, s38, s40
    s_mov_b32 m0, 122880
    s_add_u32 s39, s38, 0
    buffer_load_dwordx4 v12, s[20:23], s39 offen offset:0 sc1 lds
    buffer_load_dwordx4 v13, s[20:23], s39 offen offset:1024 sc1 lds
    buffer_load_dwordx4 v14, s[20:23], s39 offen offset:2048 sc1 lds
    buffer_load_dwordx4 v15, s[20:23], s39 offen offset:3072 sc1 lds
    s_mov_b32 m0, 126976
    s_add_u32 s39, s38, 40960
    buffer_load_dwordx4 v12, s[20:23], s39 offen offset:0 sc1 lds
    buffer_load_dwordx4 v13, s[20:23], s39 offen offset:1024 sc1 lds
    buffer_load_dwordx4 v14, s[20:23], s39 offen offset:2048 sc1 lds
    buffer_load_dwordx4 v15, s[20:23], s39 offen offset:3072 sc1 lds
    s_barrier
    s_add_u32 s38, s96, 3
    v_mov_b32 v4, s38
    s_mov_b64 exec, 1
    buffer_store_dword v4, v19, s[28:31], s63 offen sc1
    s_mov_b64 exec, -1
    s_add_u32 s39, s94, 0
    s_and_b32 s39, s39, 15
    s_lshl_b32 s39, s39, 12
    s_add_u32 s39, s39, s91
    buffer_load_dwordx4 v[96:99], v28, s[28:31], s39 offen offset:0 sc1
    buffer_load_dwordx4 v[100:103], v28, s[28:31], s39 offen offset:1024 sc1
    buffer_load_dwordx4 v[104:107], v28, s[28:31], s39 offen offset:2048 sc1
    buffer_load_dwordx4 v[108:111], v28, s[28:31], s39 offen offset:3072 sc1
    s_add_u32 s39, s94, 1
    s_and_b32 s39, s39, 15
    s_lshl_b32 s39, s39, 12
    s_add_u32 s39, s39, s91
    buffer_load_dwordx4 v[112:115], v28, s[28:31], s39 offen offset:0 sc1
    buffer_load_dwordx4 v[116:119], v28, s[28:31], s39 offen offset:1024 sc1
    buffer_load_dwordx4 v[120:123], v28, s[28:31], s39 offen offset:2048 sc1
    buffer_load_dwordx4 v[124:127], v28, s[28:31], s39 offen offset:3072 sc1
    s_add_u32 s39, s94, 2
    s_and_b32 s39, s39, 15
    s_lshl_b32 s39, s39, 12
    s_add_u32 s39, s39, s91
    buffer_load_dwordx4 v[128:131], v28, s[28:31], s39 offen offset:0 sc1
    buffer_load_dwordx4 v[132:135], v28, s[28:31], s39 offen offset:1024 sc1
    buffer_load_dwordx4 v[136:139], v28, s[28:31], s39 offen offset:2048 sc1
    buffer_load_dwordx4 v[140:143], v28, s[28:31], s39 offen offset:3072 sc1
    s_waitcnt vmcnt(12)
L_join:
    s_cmp_eq_u32 s58, 15
    s_cbranch_scc1 L_exit
    s_mul_i32 s53, s34, 1310720
    s_add_u32 s53, s53, s90
    s_add_u32 s39, s94, 8
    s_and_b32 s39, s39, 15
    s_lshl_b32 s39, s39, 12
    s_add_u32 s39, s39, s91
    buffer_load_dwordx4 v[144:147], v28, s[28:31], s39 offen offset:0 sc1
    buffer_load_dwordx4 v[148:151], v28, s[28:31], s39 offen offset:1024 sc1
    buffer_load_dwordx4 v[152:155], v28, s[28:31], s39 offen offset:2048 sc1
    buffer_load_dwordx4 v[156:159], v28, s[28:31], s39 offen offset:3072 sc1
    s_add_u32 s39, s94, 3
    s_and_b32 s39, s39, 15
    s_lshl_b32 s39, s39, 12
    s_add_u32 s39, s39, s91
    buffer_load_dwordx4 v[32:35], v28, s[28:31], s39 offen offset:0 sc1
    buffer_load_dwordx4 v[36:39], v28, s[28:31], s39 offen offset:1024 sc1
    buffer_load_dwordx4 v[40:43], v28, s[28:31], s39 offen offset:2048 sc1
    buffer_load_dwordx4 v[44:47], v28, s[28:31], s39 offen offset:3072 sc1
    s_add_u32 s39, s94, 9
    s_and_b32 s39, s39, 15
    s_lshl_b32 s39, s39, 12
    s_add_u32 s39, s39, s91
    buffer_load_dwordx4 v[16:19], v28, s[28:31], s39 offen offset:0 sc1
    buffer_load_dwordx4 v[20:23], v28, s[28:31], s39 offen offset:1024 sc1
    buffer_load_dwordx4 v[24:27], v28, s[28:31], s39 offen offset:2048 sc1
    buffer_load_dwordx4 v[80:83], v28, s[28:31], s39 offen offset:3072 sc1
    s_add_u32 s39, s94, 4
    s_and_b32 s39, s39, 15
    s_lshl_b32 s39, s39, 12
    s_add_u32 s39, s39, s91
    buffer_load_dwordx4 v[84:87], v28, s[28:31], s39 offen offset:0 sc1
    buffer_load_dwordx4 v[160:163], v28, s[28:31], s39 offen offset:1024 sc1
    buffer_load_dwordx4 v[164:167], v28, s[28:31], s39 offen offset:2048 sc1
    buffer_load_dwordx4 v[168:171], v28, s[28:31], s39 offen offset:3072 sc1
    s_add_u32 s39, s94, 10
    s_and_b32 s39, s39, 15
    s_lshl_b32 s39, s39, 12
    s_add_u32 s39, s39, s91
    buffer_load_dwordx4 v[172:175], v28, s[28:31], s39 offen offset:0 sc1
    buffer_load_dwordx4 v[176:179], v28, s[28:31], s39 offen offset:1024 sc1
    buffer_load_dwordx4 v[180:183], v28, s[28:31], s39 offen offset:2048 sc1
    buffer_load_dwordx4 v[184:187], v28, s[28:31], s39 offen offset:3072 sc1
    s_add_u32 s38, s94, 12
    s_and_b32 s38, s38, 15
    s_mul_i32 s38, s38, 81920
    s_add_u32 s38, s38, s53
    s_add_u32 m0, s44, 131072
    s_add_u32 s39, s38, 0
    buffer_load_dwordx4 v12, s[20:23], s39 offen offset:0 sc1 lds
    buffer_load_dwordx4 v13, s[20:23], s39 offen offset:1024 sc1 lds
    buffer_load_dwordx4 v14, s[20:23], s39 offen offset:2048 sc1 lds
    buffer_load_dwordx4 v15, s[20:23], s39 offen offset:3072 sc1 lds
    s_add_u32 m0, s44, 135168
    s_add_u32 s39, s38, 40960
    buffer_load_dwordx4 v12, s[20:23], s39 offen offset:0 sc1 lds
    buffer_load_dwordx4 v13, s[20:23], s39 offen offset:1024 sc1 lds
    buffer_load_dwordx4 v14, s[20:23], s39 offen offset:2048 sc1 lds
    buffer_load_dwordx4 v15, s[20:23], s39 offen offset:3072 sc1 lds
    v_add_u32 v6, 0, v29
    v_add_u32 v7, 0, v30
    v_add_u32 v8, 65536, v29
    v_add_u32 v9, 65536, v30
    v_add_u32 v10, 131072, v29
    v_add_u32 v11, 131072, v30
    s_lshl_b32 s38, s35, 2
    s_add_u32 s38, s38, s92
    s_lshl_b32 s38, s38, 2
    s_add_u32 s38, s38, s34
    s_lshl_b32 s38, s38, 10
    s_add_u32 s38, s38, 12582912
    v_and_b32 v31, 7, v1
    v_lshlrev_b32 v31, 7, v31
    v_add_u32 v31, s38, v31
    v_mov_b32 v0, 0
    s_waitcnt vmcnt(36)
    v_mfma_f32_32x32x16_bf16 a[0:15], a[64:67], v[96:99], 0
    v_mfma_f32_32x32x16_bf16 a[16:31], a[68:71], v[96:99], 0
    v_mfma_f32_32x32x16_bf16 a[0:15], a[72:75], v[100:103], a[0:15]
    v_mfma_f32_32x32x16_bf16 a[16:31], a[76:79], v[100:103], a[16:31]
    v_mfma_f32_32x32x16_bf16 a[0:15], a[80:83], v[104:107], a[0:15]
    v_mfma_f32_32x32x16_bf16 a[16:31], a[84:87], v[104:107], a[16:31]
    v_mfma_f32_32x32x16_bf16 a[0:15], a[88:91], v[108:111], a[0:15]
    v_mfma_f32_32x32x16_bf16 a[16:31], a[92:95], v[108:111], a[16:31]
    s_waitcnt vmcnt(32)
    v_mfma_f32_32x32x16_bf16 a[0:15], a[96:99], v[112:115], a[0:15]
    s_add_u32 s39, s94, 5
    v_mfma_f32_32x32x16_bf16 a[16:31], a[100:103], v[112:115], a[16:31]
    s_and_b32 s39, s39, 15
    v_mfma_f32_32x32x16_bf16 a[0:15], a[104:107], v[116:119], a[0:15]
    s_lshl_b32 s39, s39, 12
    v_mfma_f32_32x32x16_bf16 a[16:31], a[108:111], v[116:119], a[16:31]
    s_add_u32 s39, s39, s91
    v_mfma_f32_32x32x16_bf16 a[0:15], a[112:115], v[120:123], a[0:15]
    buffer_load_dwordx4 v[188:191], v28, s[28:31], s39 offen offset:0 sc1
    v_mfma_f32_32x32x16_bf16 a[16:31], a[116:119], v[120:123], a[16:31]
    buffer_load_dwordx4 v[88:91], v28, s[28:31], s39 offen offset:1024 sc1
    v_mfma_f32_32x32x16_bf16 a[0:15], a[120:123], v[124:127], a[0:15]
    buffer_load_dwordx4 v[92:95], v28, s[28:31], s39 offen offset:2048 sc1
    v_mfma_f32_32x32x16_bf16 a[16:31], a[124:127], v[124:127], a[16:31]
    buffer_load_dwordx4 v[96:99], v28, s[28:31], s39 offen offset:3072 sc1
    s_waitcnt vmcnt(32)
    v_mfma_f32_32x32x16_bf16 a[0:15], a[128:131], v[128:131], a[0:15]
    ds_read_b64_tr_b16 v[48:49], v6 offset:0
    ds_read_b64_tr_b16 v[50:51], v6 offset:1024
    ds_read_b64_tr_b16 v[52:53], v7 offset:0
    v_mfma_f32_32x32x16_bf16 a[16:31], a[132:135], v[128:131], a[16:31]
    ds_read_b64_tr_b16 v[54:55], v7 offset:1024
    ds_read_b64_tr_b16 v[56:57], v6 offset:2048
    ds_read_b64_tr_b16 v[58:59], v6 offset:3072
    v_mfma_f32_32x32x16_bf16 a[0:15], a[136:139], v[132:135], a[0:15]
    ds_read_b64_tr_b16 v[60:61], v7 offset:2048
    ds_read_b64_tr_b16 v[62:63], v7 offset:3072
    ds_read_b64_tr_b16 v[64:65], v6 offset:4096
    s_add_u32 s39, s94, 11
    s_and_b32 s39, s39, 15
    v_mfma_f32_32x32x16_bf16 a[16:31], a[140:143], v[132:135], a[16:31]
    ds_read_b64_tr_b16 v[66:67], v6 offset:5120
    ds_read_b64_tr_b16 v[68:69], v7 offset:4096
    ds_read_b64_tr_b16 v[70:71], v7 offset:5120
    s_lshl_b32 s39, s39, 12
    v_mfma_f32_32x32x16_bf16 a[0:15], a[144:147], v[136:139], a[0:15]
    ds_read_b64_tr_b16 v[72:73], v6 offset:6144
    ds_read_b64_tr_b16 v[74:75], v6 offset:7168
    ds_read_b64_tr_b16 v[76:77], v7 offset:6144
    s_add_u32 s39, s39, s91
    v_mfma_f32_32x32x16_bf16 a[16:31], a[148:151], v[136:139], a[16:31]
    ds_read_b64_tr_b16 v[78:79], v7 offset:7168
    buffer_load_dwordx4 v[100:103], v28, s[28:31], s39 offen offset:0 sc1
    buffer_load_dwordx4 v[104:107], v28, s[28:31], s39 offen offset:1024 sc1
    v_mfma_f32_32x32x16_bf16 a[0:15], a[152:155], v[140:143], a[0:15]
    buffer_load_dwordx4 v[108:111], v28, s[28:31], s39 offen offset:2048 sc1
    v_mfma_f32_32x32x16_bf16 a[16:31], a[156:159], v[140:143], a[16:31]
    buffer_load_dwordx4 v[112:115], v28, s[28:31], s39 offen offset:3072 sc1
    s_waitcnt lgkmcnt(0)
    s_waitcnt vmcnt(32)
    v_mfma_f32_32x32x16_bf16 a[0:15], v[48:51], v[144:147], a[0:15]
    s_add_u32 s39, s94, 6
    v_mfma_f32_32x32x16_bf16 a[16:31], v[52:55], v[144:147], a[16:31]
    s_and_b32 s39, s39, 15
    v_mfma_f32_32x32x16_bf16 a[0:15], v[56:59], v[148:151], a[0:15]
    s_lshl_b32 s39, s39, 12
    v_mfma_f32_32x32x16_bf16 a[16:31], v[60:63], v[148:151], a[16:31]
    s_add_u32 s39, s39, s91
    v_mfma_f32_32x32x16_bf16 a[0:15], v[64:67], v[152:155], a[0:15]
    buffer_load_dwordx4 v[116:119], v28, s[28:31], s39 offen offset:0 sc1
    v_mfma_f32_32x32x16_bf16 a[16:31], v[68:71], v[152:155], a[16:31]
    buffer_load_dwordx4 v[120:123], v28, s[28:31], s39 offen offset:1024 sc1
    v_mfma_f32_32x32x16_bf16 a[0:15], v[72:75], v[156:159], a[0:15]
    buffer_load_dwordx4 v[124:127], v28, s[28:31], s39 offen offset:2048 sc1
    v_mfma_f32_32x32x16_bf16 a[16:31], v[76:79], v[156:159], a[16:31]
    buffer_load_dwordx4 v[128:131], v28, s[28:31], s39 offen offset:3072 sc1
    global_load_dword v30, v0, s[32:33] sc1
    buffer_load_dword v4, v31, s[28:31], 0 offen sc1
    s_waitcnt vmcnt(34)
    s_barrier
    v_mfma_f32_32x32x16_bf16 a[0:15], a[160:163], v[32:35], a[0:15]
    ds_read_b64_tr_b16 v[48:49], v6 offset:32768
    ds_read_b64_tr_b16 v[50:51], v6 offset:33792
    ds_read_b64_tr_b16 v[52:53], v7 offset:32768
    v_mfma_f32_32x32x16_bf16 a[16:31], a[164:167], v[32:35], a[16:31]
    ds_read_b64_tr_b16 v[54:55], v7 offset:33792
    ds_read_b64_tr_b16 v[56:57], v6 offset:34816
    ds_read_b64_tr_b16 v[58:59], v6 offset:35840
    v_mfma_f32_32x32x16_bf16 a[0:15], a[168:171], v[36:39], a[0:15]
    ds_read_b64_tr_b16 v[60:61], v7 offset:34816
    ds_read_b64_tr_b16 v[62:63], v7 offset:35840
    ds_read_b64_tr_b16 v[64:65], v6 offset:36864
    s_add_u32 s39, s94, 12
    s_and_b32 s39, s39, 15
    v_mfma_f32_32x32x16_bf16 a[16:31], a[172:175], v[36:39], a[16:31]
    ds_read_b64_tr_b16 v[66:67], v6 offset:37888
    ds_read_b64_tr_b16 v[68:69], v7 offset:36864
    ds_read_b64_tr_b16 v[70:71], v7 offset:37888
    s_lshl_b32 s39, s39, 12
    v_mfma_f32_32x32x16_bf16 a[0:15], a[176:179], v[40:43], a[0:15]
    ds_read_b64_tr_b16 v[72:73], v6 offset:38912
    ds_read_b64_tr_b16 v[74:75], v6 offset:39936
    ds_read_b64_tr_b16 v[76:77], v7 offset:38912
    s_add_u32 s39, s39, s91
    v_mfma_f32_32x32x16_bf16 a[16:31], a[180:183], v[40:43], a[16:31]
    ds_read_b64_tr_b16 v[78:79], v7 offset:39936
    buffer_load_dwordx4 v[132:135], v28, s[28:31], s39 offen offset:0 sc1
    buffer_load_dwordx4 v[136:139], v28, s[28:31], s39 offen offset:1024 sc1
    v_mfma_f32_32x32x16_bf16 a[0:15], a[184:187], v[44:47], a[0:15]
    buffer_load_dwordx4 v[140:143], v28, s[28:31], s39 offen offset:2048 sc1
    v_mfma_f32_32x32x16_bf16 a[16:31], a[188:191], v[44:47], a[16:31]
    buffer_load_dwordx4 v[144:147], v28, s[28:31], s39 offen offset:3072 sc1
    s_waitcnt lgkmcnt(0)
    s_waitcnt vmcnt(34)
    v_mfma_f32_32x32x16_bf16 a[0:15], v[48:51], v[16:19], a[0:15]
    s_add_u32 s39, s94, 7
    v_mfma_f32_32x32x16_bf16 a[16:31], v[52:55], v[16:19], a[16:31]
    s_and_b32 s39, s39, 15
    v_mfma_f32_32x32x16_bf16 a[0:15], v[56:59], v[20:23], a[0:15]
    s_lshl_b32 s39, s39, 12
    v_mfma_f32_32x32x16_bf16 a[16:31], v[60:63], v[20:23], a[16:31]
    s_add_u32 s39, s39, s91
    v_mfma_f32_32x32x16_bf16 a[0:15], v[64:67], v[24:27], a[0:15]
    buffer_load_dwordx4 v[148:151], v28, s[28:31], s39 offen offset:0 sc1
    v_mfma_f32_32x32x16_bf16 a[16:31], v[68:71], v[24:27], a[16:31]
    buffer_load_dwordx4 v[152:155], v28, s[28:31], s39 offen offset:1024 sc1
    v_mfma_f32_32x32x16_bf16 a[0:15], v[72:75], v[80:83], a[0:15]
    buffer_load_dwordx4 v[156:159], v28, s[28:31], s39 offen offset:2048 sc1
    v_mfma_f32_32x32x16_bf16 a[16:31], v[76:79], v[80:83], a[16:31]
    buffer_load_dwordx4 v[32:35], v28, s[28:31], s39 offen offset:3072 sc1
    s_waitcnt vmcnt(34)
    v_mfma_f32_32x32x16_bf16 a[0:15], a[192:195], v[84:87], a[0:15]
    ds_read_b64_tr_b16 v[48:49], v8 offset:0
    ds_read_b64_tr_b16 v[50:51], v8 offset:1024
    ds_read_b64_tr_b16 v[52:53], v9 offset:0
    v_mfma_f32_32x32x16_bf16 a[16:31], a[196:199], v[84:87], a[16:31]
    ds_read_b64_tr_b16 v[54:55], v9 offset:1024
    ds_read_b64_tr_b16 v[56:57], v8 offset:2048
    ds_read_b64_tr_b16 v[58:59], v8 offset:3072
    v_mfma_f32_32x32x16_bf16 a[0:15], a[200:203], v[160:163], a[0:15]
    ds_read_b64_tr_b16 v[60:61], v9 offset:2048
    ds_read_b64_tr_b16 v[62:63], v9 offset:3072
    ds_read_b64_tr_b16 v[64:65], v8 offset:4096
    s_add_u32 s39, s94, 13
    s_and_b32 s39, s39, 15
    v_mfma_f32_32x32x16_bf16 a[16:31], a[204:207], v[160:163], a[16:31]
    ds_read_b64_tr_b16 v[66:67], v8 offset:5120
    ds_read_b64_tr_b16 v[68:69], v9 offset:4096
    ds_read_b64_tr_b16 v[70:71], v9 offset:5120
    s_lshl_b32 s39, s39, 12
    v_mfma_f32_32x32x16_bf16 a[0:15], a[208:211], v[164:167], a[0:15]
    ds_read_b64_tr_b16 v[72:73], v8 offset:6144
    ds_read_b64_tr_b16 v[74:75], v8 offset:7168
    ds_read_b64_tr_b16 v[76:77], v9 offset:6144
    s_add_u32 s39, s39, s91
    v_mfma_f32_32x32x16_bf16 a[16:31], a[212:215], v[164:167], a[16:31]
    ds_read_b64_tr_b16 v[78:79], v9 offset:7168
    buffer_load_dwordx4 v[36:39], v28, s[28:31], s39 offen offset:0 sc1
    buffer_load_dwordx4 v[40:43], v28, s[28:31], s39 offen offset:1024 sc1
    v_mfma_f32_32x32x16_bf16 a[0:15], a[216:219], v[168:171], a[0:15]
    buffer_load_dwordx4 v[44:47], v28, s[28:31], s39 offen offset:2048 sc1
    v_mfma_f32_32x32x16_bf16 a[16:31], a[220:223], v[168:171], a[16:31]
    buffer_load_dwordx4 v[16:19], v28, s[28:31], s39 offen offset:3072 sc1
    s_waitcnt lgkmcnt(0)
    s_waitcnt vmcnt(34)
    v_mfma_f32_32x32x16_bf16 a[0:15], v[48:51], v[172:175], a[0:15]
    s_add_u32 s39, s94, 14
    v_mfma_f32_32x32x16_bf16 a[16:31], v[52:55], v[172:175], a[16:31]
    s_and_b32 s39, s39, 15
    v_mfma_f32_32x32x16_bf16 a[0:15], v[56:59], v[176:179], a[0:15]
    s_lshl_b32 s39, s39, 12
    v_mfma_f32_32x32x16_bf16 a[16:31], v[60:63], v[176:179], a[16:31]
    s_add_u32 s39, s39, s91
    v_mfma_f32_32x32x16_bf16 a[0:15], v[64:67], v[180:183], a[0:15]
    buffer_load_dwordx4 v[20:23], v28, s[28:31], s39 offen offset:0 sc1
    v_mfma_f32_32x32x16_bf16 a[16:31], v[68:71], v[180:183], a[16:31]
    buffer_load_dwordx4 v[24:27], v28, s[28:31], s39 offen offset:1024 sc1
    v_mfma_f32_32x32x16_bf16 a[0:15], v[72:75], v[184:187], a[0:15]
    buffer_load_dwordx4 v[80:83], v28, s[28:31], s39 offen offset:2048 sc1
    v_mfma_f32_32x32x16_bf16 a[16:31], v[76:79], v[184:187], a[16:31]
    buffer_load_dwordx4 v[84:87], v28, s[28:31], s39 offen offset:3072 sc1
    s_waitcnt vmcnt(26)
    v_mfma_f32_32x32x16_bf16 a[0:15], a[224:227], v[188:191], a[0:15]
    ds_read_b64_tr_b16 v[48:49], v8 offset:32768
    ds_read_b64_tr_b16 v[50:51], v8 offset:33792
    ds_read_b64_tr_b16 v[52:53], v9 offset:32768
    v_mfma_f32_32x32x16_bf16 a[16:31], a[228:231], v[188:191], a[16:31]
    ds_read_b64_tr_b16 v[54:55], v9 offset:33792
    ds_read_b64_tr_b16 v[56:57], v8 offset:34816
    ds_read_b64_tr_b16 v[58:59], v8 offset:35840
    v_mfma_f32_32x32x16_bf16 a[0:15], a[232:235], v[88:91], a[0:15]
    ds_read_b64_tr_b16 v[60:61], v9 offset:34816
    ds_read_b64_tr_b16 v[62:63], v9 offset:35840
    ds_read_b64_tr_b16 v[64:65], v8 offset:36864
    s_add_u32 s39, s94, 15
    s_and_b32 s39, s39, 15
    v_mfma_f32_32x32x16_bf16 a[16:31], a[236:239], v[88:91], a[16:31]
    ds_read_b64_tr_b16 v[66:67], v8 offset:37888
    ds_read_b64_tr_b16 v[68:69], v9 offset:36864
    ds_read_b64_tr_b16 v[70:71], v9 offset:37888
    s_lshl_b32 s39, s39, 12
    v_mfma_f32_32x32x16_bf16 a[0:15], a[240:243], v[92:95], a[0:15]
    ds_read_b64_tr_b16 v[72:73], v8 offset:38912
    ds_read_b64_tr_b16 v[74:75], v8 offset:39936
    ds_read_b64_tr_b16 v[76:77], v9 offset:38912
    s_add_u32 s39, s39, s91
    v_mfma_f32_32x32x16_bf16 a[16:31], a[244:247], v[92:95], a[16:31]
    ds_read_b64_tr_b16 v[78:79], v9 offset:39936
    buffer_load_dwordx4 v[160:163], v28, s[28:31], s39 offen offset:0 sc1
    buffer_load_dwordx4 v[164:167], v28, s[28:31], s39 offen offset:1024 sc1
    v_mfma_f32_32x32x16_bf16 a[0:15], a[248:251], v[96:99], a[0:15]
    buffer_load_dwordx4 v[168:171], v28, s[28:31], s39 offen offset:2048 sc1
    v_mfma_f32_32x32x16_bf16 a[16:31], a[252:255], v[96:99], a[16:31]
    buffer_load_dwordx4 v[172:175], v28, s[28:31], s39 offen offset:3072 sc1
    s_waitcnt vmcnt(20)
    v_add_u32 v30, 3, v30
    v_cmp_eq_u32 vcc, v30, v4
    s_cmp_eq_u64 vcc, -1
    s_cbranch_scc1 L_polled_r2
    s_mov_b32 s93, 0x20000
L_poll_r2:
    s_sleep 4
    buffer_load_dword v4, v31, s[28:31], 0 offen sc1
    s_waitcnt vmcnt(0)
    v_cmp_eq_u32 vcc, v30, v4
    s_cmp_eq_u64 vcc, -1
    s_cbranch_scc1 L_polled_r2
    s_sub_u32 s93, s93, 1
    s_cmp_lg_u32 s93, 0
    s_cbranch_scc1 L_poll_r2
L_polled_r2:
    s_add_u32 s39, s94, 8
    s_and_b32 s39, s39, 15
    s_lshl_b32 s39, s39, 12
    s_add_u32 s39, s39, s91
    s_add_u32 s39, s39, 3145728
    buffer_load_dwordx4 v[176:179], v28, s[28:31], s39 offen offset:0 sc1
    buffer_load_dwordx4 v[180:183], v28, s[28:31], s39 offen offset:1024 sc1
    buffer_load_dwordx4 v[184:187], v28, s[28:31], s39 offen offset:2048 sc1
    buffer_load_dwordx4 v[188:191], v28, s[28:31], s39 offen offset:3072 sc1
    s_waitcnt lgkmcnt(0)
    v_mfma_f32_32x32x16_bf16 a[0:15], v[48:51], v[100:103], a[0:15]
    v_mfma_f32_32x32x16_bf16 a[16:31], v[52:55], v[100:103], a[16:31]
    v_mfma_f32_32x32x16_bf16 a[0:15], v[56:59], v[104:107], a[0:15]
    v_mfma_f32_32x32x16_bf16 a[16:31], v[60:63], v[104:107], a[16:31]
    v_mfma_f32_32x32x16_bf16 a[0:15], v[64:67], v[108:111], a[0:15]
    v_mfma_f32_32x32x16_bf16 a[16:31], v[68:71], v[108:111], a[16:31]
    v_mfma_f32_32x32x16_bf16 a[0:15], v[72:75], v[112:115], a[0:15]
    v_mfma_f32_32x32x16_bf16 a[16:31], v[76:79], v[112:115], a[16:31]
    v_mfma_f32_32x32x16_bf16 a[0:15], v[192:195], v[116:119], a[0:15]
    ds_read_b64_tr_b16 v[48:49], v10 offset:0
    ds_read_b64_tr_b16 v[50:51], v10 offset:1024
    ds_read_b64_tr_b16 v[52:53], v11 offset:0
    v_mfma_f32_32x32x16_bf16 a[16:31], v[196:199], v[116:119], a[16:31]
    ds_read_b64_tr_b16 v[54:55], v11 offset:1024
    ds_read_b64_tr_b16 v[56:57], v10 offset:2048
    ds_read_b64_tr_b16 v[58:59], v10 offset:3072
    v_mfma_f32_32x32x16_bf16 a[0:15], v[200:203], v[120:123], a[0:15]
    ds_read_b64_tr_b16 v[60:61], v11 offset:2048
    ds_read_b64_tr_b16 v[62:63], v11 offset:3072
    ds_read_b64_tr_b16 v[64:65], v10 offset:4096
    s_add_u32 s39, s94, 0
    s_and_b32 s39, s39, 15
    v_mfma_f32_32x32x16_bf16 a[16:31], v[204:207], v[120:123], a[16:31]
    ds_read_b64_tr_b16 v[66:67], v10 offset:5120
    ds_read_b64_tr_b16 v[68:69], v11 offset:4096
    ds_read_b64_tr_b16 v[70:71], v11 offset:5120
    s_lshl_b32 s39, s39, 12
    v_mfma_f32_32x32x16_bf16 a[0:15], v[208:211], v[124:127], a[0:15]
    ds_read_b64_tr_b16 v[72:73], v10 offset:6144
    ds_read_b64_tr_b16 v[74:75], v10 offset:7168
    ds_read_b64_tr_b16 v[76:77], v11 offset:6144
    s_add_u32 s39, s39, s91
    s_add_u32 s39, s39, 3145728
    v_mfma_f32_32x32x16_bf16 a[16:31], v[212:215], v[124:127], a[16:31]
    ds_read_b64_tr_b16 v[78:79], v11 offset:7168
    buffer_load_dwordx4 v[88:91], v28, s[28:31], s39 offen offset:0 sc1
    v_mfma_f32_32x32x16_bf16 a[0:15], v[216:219], v[128:131], a[0:15]
    buffer_load_dwordx4 v[92:95], v28, s[28:31], s39 offen offset:1024 sc1
    buffer_load_dwordx4 v[96:99], v28, s[28:31], s39 offen offset:2048 sc1
    v_mfma_f32_32x32x16_bf16 a[16:31], v[220:223], v[128:131], a[16:31]
    buffer_load_dwordx4 v[100:103], v28, s[28:31], s39 offen offset:3072 sc1
    s_waitcnt lgkmcnt(0)
    s_waitcnt vmcnt(24)
    v_mfma_f32_32x32x16_bf16 a[0:15], v[48:51], v[132:135], a[0:15]
    s_add_u32 s39, s94, 9
    s_and_b32 s39, s39, 15
    v_mfma_f32_32x32x16_bf16 a[16:31], v[52:55], v[132:135], a[16:31]
    s_lshl_b32 s39, s39, 12
    v_mfma_f32_32x32x16_bf16 a[0:15], v[56:59], v[136:139], a[0:15]
    s_add_u32 s39, s39, s91
    v_mfma_f32_32x32x16_bf16 a[16:31], v[60:63], v[136:139], a[16:31]
    s_add_u32 s39, s39, 3145728
    v_mfma_f32_32x32x16_bf16 a[0:15], v[64:67], v[140:143], a[0:15]
    buffer_load_dwordx4 v[104:107], v28, s[28:31], s39 offen offset:0 sc1
    v_mfma_f32_32x32x16_bf16 a[16:31], v[68:71], v[140:143], a[16:31]
    buffer_load_dwordx4 v[108:111], v28, s[28:31], s39 offen offset:1024 sc1
    v_mfma_f32_32x32x16_bf16 a[0:15], v[72:75], v[144:147], a[0:15]
    buffer_load_dwordx4 v[112:115], v28, s[28:31], s39 offen offset:2048 sc1
    v_mfma_f32_32x32x16_bf16 a[16:31], v[76:79], v[144:147], a[16:31]
    buffer_load_dwordx4 v[116:119], v28, s[28:31], s39 offen offset:3072 sc1
    s_waitcnt vmcnt(24)
    v_mfma_f32_32x32x16_bf16 a[0:15], v[224:227], v[148:151], a[0:15]
    ds_read_b64_tr_b16 v[48:49], v6 offset:0
    ds_read_b64_tr_b16 v[50:51], v6 offset:1024
    ds_read_b64_tr_b16 v[52:53], v7 offset:0
    v_mfma_f32_32x32x16_bf16 a[16:31], v[228:231], v[148:151], a[16:31]
    ds_read_b64_tr_b16 v[54:55], v7 offset:1024
    ds_read_b64_tr_b16 v[56:57], v6 offset:2048
    ds_read_b64_tr_b16 v[58:59], v6 offset:3072
    v_mfma_f32_32x32x16_bf16 a[0:15], v[232:235], v[152:155], a[0:15]
    ds_read_b64_tr_b16 v[60:61], v7 offset:2048
    ds_read_b64_tr_b16 v[62:63], v7 offset:3072
    ds_read_b64_tr_b16 v[64:65], v6 offset:4096
    s_add_u32 s39, s94, 1
    s_and_b32 s39, s39, 15
    v_mfma_f32_32x32x16_bf16 a[16:31], v[236:239], v[152:155], a[16:31]
    ds_read_b64_tr_b16 v[66:67], v6 offset:5120
    ds_read_b64_tr_b16 v[68:69], v7 offset:4096
    ds_read_b64_tr_b16 v[70:71], v7 offset:5120
    s_lshl_b32 s39, s39, 12
    v_mfma_f32_32x32x16_bf16 a[0:15], v[240:243], v[156:159], a[0:15]
    ds_read_b64_tr_b16 v[72:73], v6 offset:6144
    ds_read_b64_tr_b16 v[74:75], v6 offset:7168
    ds_read_b64_tr_b16 v[76:77], v7 offset:6144
    s_add_u32 s39, s39, s91
    s_add_u32 s39, s39, 3145728
    v_mfma_f32_32x32x16_bf16 a[16:31], v[244:247], v[156:159], a[16:31]
    ds_read_b64_tr_b16 v[78:79], v7 offset:7168
    buffer_load_dwordx4 v[120:123], v28, s[28:31], s39 offen offset:0 sc1
    v_mfma_f32_32x32x16_bf16 a[0:15], v[248:251], v[32:35], a[0:15]
    buffer_load_dwordx4 v[124:127], v28, s[28:31], s39 offen offset:1024 sc1
    buffer_load_dwordx4 v[128:131], v28, s[28:31], s39 offen offset:2048 sc1
    v_mfma_f32_32x32x16_bf16 a[16:31], v[252:255], v[32:35], a[16:31]
    buffer_load_dwordx4 v[132:135], v28, s[28:31], s39 offen offset:3072 sc1
    s_waitcnt lgkmcnt(0)
    s_waitcnt vmcnt(12)
    v_mfma_f32_32x32x16_bf16 a[32:47], v[48:51], v[176:179], 0
    s_add_u32 s38, s94, 13
    s_and_b32 s38, s38, 15
    s_mul_i32 s38, s38, 81920
    s_add_u32 s38, s38, s53
    v_mfma_f32_32x32x16_bf16 a[48:63], v[52:55], v[176:179], 0
    s_add_u32 m0, s44, 0
    s_add_u32 s39, s38, 0
    buffer_load_dwordx4 v12, s[20:23], s39 offen offset:0 sc1 lds
    v_mfma_f32_32x32x16_bf16 a[32:47], v[56:59], v[180:183], a[32:47]
    buffer_load_dwordx4 v13, s[20:23], s39 offen offset:1024 sc1 lds
    buffer_load_dwordx4 v14, s[20:23], s39 offen offset:2048 sc1 lds
    buffer_load_dwordx4 v15, s[20:23], s39 offen offset:3072 sc1 lds
    v_mfma_f32_32x32x16_bf16 a[48:63], v[60:63], v[180:183], a[48:63]
    s_add_u32 m0, s44, 4096
    s_add_u32 s39, s38, 40960
    buffer_load_dwordx4 v12, s[20:23], s39 offen offset:0 sc1 lds
    v_mfma_f32_32x32x16_bf16 a[32:47], v[64:67], v[184:187], a[32:47]
    buffer_load_dwordx4 v13, s[20:23], s39 offen offset:1024 sc1 lds
    buffer_load_dwordx4 v14, s[20:23], s39 offen offset:2048 sc1 lds
    buffer_load_dwordx4 v15, s[20:23], s39 offen offset:3072 sc1 lds
    v_mfma_f32_32x32x16_bf16 a[48:63], v[68:71], v[184:187], a[48:63]
    s_add_u32 s39, s94, 10
    s_and_b32 s39, s39, 15
    s_lshl_b32 s39, s39, 12
    v_mfma_f32_32x32x16_bf16 a[32:47], v[72:75], v[188:191], a[32:47]
    s_add_u32 s39, s39, s91
    s_add_u32 s39, s39, 3145728
    buffer_load_dwordx4 v[136:139], v28, s[28:31], s39 offen offset:0 sc1
    v_mfma_f32_32x32x16_bf16 a[48:63], v[76:79], v[188:191], a[48:63]
    buffer_load_dwordx4 v[140:143], v28, s[28:31], s39 offen offset:1024 sc1
    buffer_load_dwordx4 v[144:147], v28, s[28:31], s39 offen offset:2048 sc1
    buffer_load_dwordx4 v[148:151], v28, s[28:31], s39 offen offset:3072 sc1
    s_waitcnt vmcnt(20)
    v_mfma_f32_32x32x16_bf16 a[32:47], a[64:67], v[88:91], a[32:47]
    ds_read_b64_tr_b16 v[48:49], v6 offset:32768
    ds_read_b64_tr_b16 v[50:51], v6 offset:33792
    ds_read_b64_tr_b16 v[52:53], v7 offset:32768
    v_mfma_f32_32x32x16_bf16 a[48:63], a[68:71], v[88:91], a[48:63]
    ds_read_b64_tr_b16 v[54:55], v7 offset:33792
    ds_read_b64_tr_b16 v[56:57], v6 offset:34816
    ds_read_b64_tr_b16 v[58:59], v6 offset:35840
    v_mfma_f32_32x32x16_bf16 a[32:47], a[72:75], v[92:95], a[32:47]
    ds_read_b64_tr_b16 v[60:61], v7 offset:34816
    ds_read_b64_tr_b16 v[62:63], v7 offset:35840
    ds_read_b64_tr_b16 v[64:65], v6 offset:36864
    s_add_u32 s39, s94, 2
    s_and_b32 s39, s39, 15
    v_mfma_f32_32x32x16_bf16 a[48:63], a[76:79], v[92:95], a[48:63]
    ds_read_b64_tr_b16 v[66:67], v6 offset:37888
    ds_read_b64_tr_b16 v[68:69], v7 offset:36864
    ds_read_b64_tr_b16 v[70:71], v7 offset:37888
    s_lshl_b32 s39, s39, 12
    v_mfma_f32_32x32x16_bf16 a[32:47], a[80:83], v[96:99], a[32:47]
    ds_read_b64_tr_b16 v[72:73], v6 offset:38912
    ds_read_b64_tr_b16 v[74:75], v6 offset:39936
    ds_read_b64_tr_b16 v[76:77], v7 offset:38912
    s_add_u32 s39, s39, s91
    s_add_u32 s39, s39, 3145728
    v_mfma_f32_32x32x16_bf16 a[48:63], a[84:87], v[96:99], a[48:63]
    ds_read_b64_tr_b16 v[78:79], v7 offset:39936
    buffer_load_dwordx4 v[152:155], v28, s[28:31], s39 offen offset:0 sc1
    v_mfma_f32_32x32x16_bf16 a[32:47], a[88:91], v[100:103], a[32:47]
    buffer_load_dwordx4 v[156:159], v28, s[28:31], s39 offen offset:1024 sc1
    buffer_load_dwordx4 v[32:35], v28, s[28:31], s39 offen offset:2048 sc1
    v_mfma_f32_32x32x16_bf16 a[48:63], a[92:95], v[100:103], a[48:63]
    buffer_load_dwordx4 v[176:179], v28, s[28:31], s39 offen offset:3072 sc1
    s_waitcnt lgkmcnt(0)
    s_waitcnt vmcnt(20)
    v_mfma_f32_32x32x16_bf16 a[32:47], v[48:51], v[104:107], a[32:47]
    s_add_u32 s38, s94, 14
    s_and_b32 s38, s38, 15
    s_mul_i32 s38, s38, 81920
    s_add_u32 s38, s38, s53
    v_mfma_f32_32x32x16_bf16 a[48:63], v[52:55], v[104:107], a[48:63]
    s_add_u32 m0, s44, 32768
    s_add_u32 s39, s38, 0
    buffer_load_dwordx4 v12, s[20:23], s39 offen offset:0 sc1 lds
    v_mfma_f32_32x32x16_bf16 a[32:47], v[56:59], v[108:111], a[32:47]
    buffer_load_dwordx4 v13, s[20:23], s39 offen offset:1024 sc1 lds
    buffer_load_dwordx4 v14, s[20:23], s39 offen offset:2048 sc1 lds
    buffer_load_dwordx4 v15, s[20:23], s39 offen offset:3072 sc1 lds
    v_mfma_f32_32x32x16_bf16 a[48:63], v[60:63], v[108:111], a[48:63]
    s_add_u32 m0, s44, 36864
    s_add_u32 s39, s38, 40960
    buffer_load_dwordx4 v12, s[20:23], s39 offen offset:0 sc1 lds
    v_mfma_f32_32x32x16_bf16 a[32:47], v[64:67], v[112:115], a[32:47]
    buffer_load_dwordx4 v13, s[20:23], s39 offen offset:1024 sc1 lds
    buffer_load_dwordx4 v14, s[20:23], s39 offen offset:2048 sc1 lds
    buffer_load_dwordx4 v15, s[20:23], s39 offen offset:3072 sc1 lds
    v_mfma_f32_32x32x16_bf16 a[48:63], v[68:71], v[112:115], a[48:63]
    s_add_u32 s39, s94, 11
    s_and_b32 s39, s39, 15
    s_lshl_b32 s39, s39, 12
    v_mfma_f32_32x32x16_bf16 a[32:47], v[72:75], v[116:119], a[32:47]
    s_add_u32 s39, s39, s91
    s_add_u32 s39, s39, 3145728
    buffer_load_dwordx4 v[180:183], v28, s[28:31], s39 offen offset:0 sc1
    v_mfma_f32_32x32x16_bf16 a[48:63], v[76:79], v[116:119], a[48:63]
    buffer_load_dwordx4 v[184:187], v28, s[28:31], s39 offen offset:1024 sc1
    buffer_load_dwordx4 v[188:191], v28, s[28:31], s39 offen offset:2048 sc1
    buffer_load_dwordx4 v[88:91], v28, s[28:31], s39 offen offset:3072 sc1
    s_waitcnt vmcnt(28)
    v_mfma_f32_32x32x16_bf16 a[32:47], a[96:99], v[120:123], a[32:47]
    ds_read_b64_tr_b16 v[48:49], v8 offset:0
    ds_read_b64_tr_b16 v[50:51], v8 offset:1024
    ds_read_b64_tr_b16 v[52:53], v9 offset:0
    v_mfma_f32_32x32x16_bf16 a[48:63], a[100:103], v[120:123], a[48:63]
    ds_read_b64_tr_b16 v[54:55], v9 offset:1024
    ds_read_b64_tr_b16 v[56:57], v8 offset:2048
    ds_read_b64_tr_b16 v[58:59], v8 offset:3072
    v_mfma_f32_32x32x16_bf16 a[32:47], a[104:107], v[124:127], a[32:47]
    ds_read_b64_tr_b16 v[60:61], v9 offset:2048
    ds_read_b64_tr_b16 v[62:63], v9 offset:3072
    ds_read_b64_tr_b16 v[64:65], v8 offset:4096
    s_add_u32 s39, s94, 3
    s_and_b32 s39, s39, 15
    v_mfma_f32_32x32x16_bf16 a[48:63], a[108:111], v[124:127], a[48:63]
    ds_read_b64_tr_b16 v[66:67], v8 offset:5120
    ds_read_b64_tr_b16 v[68:69], v9 offset:4096
    ds_read_b64_tr_b16 v[70:71], v9 offset:5120
    s_lshl_b32 s39, s39, 12
    v_mfma_f32_32x32x16_bf16 a[32:47], a[112:115], v[128:131], a[32:47]
    ds_read_b64_tr_b16 v[72:73], v8 offset:6144
    ds_read_b64_tr_b16 v[74:75], v8 offset:7168
    ds_read_b64_tr_b16 v[76:77], v9 offset:6144
    s_add_u32 s39, s39, s91
    s_add_u32 s39, s39, 3145728
    v_mfma_f32_32x32x16_bf16 a[48:63], a[116:119], v[128:131], a[48:63]
    ds_read_b64_tr_b16 v[78:79], v9 offset:7168
    buffer_load_dwordx4 v[92:95], v28, s[28:31], s39 offen offset:0 sc1
    v_mfma_f32_32x32x16_bf16 a[32:47], a[120:123], v[132:135], a[32:47]
    buffer_load_dwordx4 v[96:99], v28, s[28:31], s39 offen offset:1024 sc1
    buffer_load_dwordx4 v[100:103], v28, s[28:31], s39 offen offset:2048 sc1
    v_mfma_f32_32x32x16_bf16 a[48:63], a[124:127], v[132:135], a[48:63]
    buffer_load_dwordx4 v[104:107], v28, s[28:31], s39 offen offset:3072 sc1
    s_waitcnt lgkmcnt(0)
    s_waitcnt vmcnt(20)
    v_mfma_f32_32x32x16_bf16 a[32:47], v[48:51], v[136:139], a[32:47]
    s_add_u32 s38, s94, 15
    s_and_b32 s38, s38, 15
    s_mul_i32 s38, s38, 81920
    s_add_u32 s38, s38, s53
    v_mfma_f32_32x32x16_bf16 a[48:63], v[52:55], v[136:139], a[48:63]
    s_add_u32 m0, s44, 65536
    s_add_u32 s39, s38, 0
    buffer_load_dwordx4 v12, s[20:23], s39 offen offset:0 sc1 lds
    v_mfma_f32_32x32x16_bf16 a[32:47], v[56:59], v[140:143], a[32:47]
    buffer_load_dwordx4 v13, s[20:23], s39 offen offset:1024 sc1 lds
    buffer_load_dwordx4 v14, s[20:23], s39 offen offset:2048 sc1 lds
    buffer_load_dwordx4 v15, s[20:23], s39 offen offset:3072 sc1 lds
    v_mfma_f32_32x32x16_bf16 a[48:63], v[60:63], v[140:143], a[48:63]
    s_add_u32 m0, s44, 69632
    s_add_u32 s39, s38, 40960
    buffer_load_dwordx4 v12, s[20:23], s39 offen offset:0 sc1 lds
    v_mfma_f32_32x32x16_bf16 a[32:47], v[64:67], v[144:147], a[32:47]
    buffer_load_dwordx4 v13, s[20:23], s39 offen offset:1024 sc1 lds
    buffer_load_dwordx4 v14, s[20:23], s39 offen offset:2048 sc1 lds
    buffer_load_dwordx4 v15, s[20:23], s39 offen offset:3072 sc1 lds
    v_mfma_f32_32x32x16_bf16 a[48:63], v[68:71], v[144:147], a[48:63]
    s_add_u32 s39, s94, 12
    s_and_b32 s39, s39, 15
    s_lshl_b32 s39, s39, 12
    v_mfma_f32_32x32x16_bf16 a[32:47], v[72:75], v[148:151], a[32:47]
    s_add_u32 s39, s39, s91
    s_add_u32 s39, s39, 3145728
    buffer_load_dwordx4 v[108:111], v28, s[28:31], s39 offen offset:0 sc1
    v_mfma_f32_32x32x16_bf16 a[48:63], v[76:79], v[148:151], a[48:63]
    buffer_load_dwordx4 v[112:115], v28, s[28:31], s39 offen offset:1024 sc1
    buffer_load_dwordx4 v[116:119], v28, s[28:31], s39 offen offset:2048 sc1
    buffer_load_dwordx4 v[120:123], v28, s[28:31], s39 offen offset:3072 sc1
    s_waitcnt vmcnt(28)
    v_mfma_f32_32x32x16_bf16 a[32:47], a[128:131], v[152:155], a[32:47]
    ds_read_b64_tr_b16 v[48:49], v8 offset:32768
    ds_read_b64_tr_b16 v[50:51], v8 offset:33792
    ds_read_b64_tr_b16 v[52:53], v9 offset:32768
    v_mfma_f32_32x32x16_bf16 a[48:63], a[132:135], v[152:155], a[48:63]
    ds_read_b64_tr_b16 v[54:55], v9 offset:33792
    ds_read_b64_tr_b16 v[56:57], v8 offset:34816
    ds_read_b64_tr_b16 v[58:59], v8 offset:35840
    v_mfma_f32_32x32x16_bf16 a[32:47], a[136:139], v[156:159], a[32:47]
    ds_read_b64_tr_b16 v[60:61], v9 offset:34816
    ds_read_b64_tr_b16 v[62:63], v9 offset:35840
    ds_read_b64_tr_b16 v[64:65], v8 offset:36864
    s_add_u32 s39, s94, 4
    s_and_b32 s39, s39, 15
    v_mfma_f32_32x32x16_bf16 a[48:63], a[140:143], v[156:159], a[48:63]
    ds_read_b64_tr_b16 v[66:67], v8 offset:37888
    ds_read_b64_tr_b16 v[68:69], v9 offset:36864
    ds_read_b64_tr_b16 v[70:71], v9 offset:37888
    s_lshl_b32 s39, s39, 12
    v_mfma_f32_32x32x16_bf16 a[32:47], a[144:147], v[32:35], a[32:47]
    ds_read_b64_tr_b16 v[72:73], v8 offset:38912
    ds_read_b64_tr_b16 v[74:75], v8 offset:39936
    ds_read_b64_tr_b16 v[76:77], v9 offset:38912
    s_add_u32 s39, s39, s91
    s_add_u32 s39, s39, 3145728
    v_mfma_f32_32x32x16_bf16 a[48:63], a[148:151], v[32:35], a[48:63]
    ds_read_b64_tr_b16 v[78:79], v9 offset:39936
    buffer_load_dwordx4 v[124:127], v28, s[28:31], s39 offen offset:0 sc1
    v_mfma_f32_32x32x16_bf16 a[32:47], a[152:155], v[176:179], a[32:47]
    buffer_load_dwordx4 v[128:131], v28, s[28:31], s39 offen offset:1024 sc1
    buffer_load_dwordx4 v[132:135], v28, s[28:31], s39 offen offset:2048 sc1
    v_mfma_f32_32x32x16_bf16 a[48:63], a[156:159], v[176:179], a[48:63]
    buffer_load_dwordx4 v[136:139], v28, s[28:31], s39 offen offset:3072 sc1
    s_waitcnt lgkmcnt(0)
    s_waitcnt vmcnt(20)
    v_mfma_f32_32x32x16_bf16 a[32:47], v[48:51], v[180:183], a[32:47]
    s_add_u32 s39, s94, 13
    s_and_b32 s39, s39, 15
    v_mfma_f32_32x32x16_bf16 a[48:63], v[52:55], v[180:183], a[48:63]
    s_lshl_b32 s39, s39, 12
    v_mfma_f32_32x32x16_bf16 a[32:47], v[56:59], v[184:187], a[32:47]
    s_add_u32 s39, s39, s91
    v_mfma_f32_32x32x16_bf16 a[48:63], v[60:63], v[184:187], a[48:63]
    s_add_u32 s39, s39, 3145728
    v_mfma_f32_32x32x16_bf16 a[32:47], v[64:67], v[188:191], a[32:47]
    buffer_load_dwordx4 v[140:143], v28, s[28:31], s39 offen offset:0 sc1
    v_mfma_f32_32x32x16_bf16 a[48:63], v[68:71], v[188:191], a[48:63]
    buffer_load_dwordx4 v[144:147], v28, s[28:31], s39 offen offset:1024 sc1
    v_mfma_f32_32x32x16_bf16 a[32:47], v[72:75], v[88:91], a[32:47]
    buffer_load_dwordx4 v[148:151], v28, s[28:31], s39 offen offset:2048 sc1
    v_mfma_f32_32x32x16_bf16 a[48:63], v[76:79], v[88:91], a[48:63]
    buffer_load_dwordx4 v[152:155], v28, s[28:31], s39 offen offset:3072 sc1
    s_waitcnt vmcnt(20)
    v_mfma_f32_32x32x16_bf16 a[32:47], a[160:163], v[92:95], a[32:47]
    ds_read_b64_tr_b16 v[48:49], v10 offset:0
    ds_read_b64_tr_b16 v[50:51], v10 offset:1024
    ds_read_b64_tr_b16 v[52:53], v11 offset:0
    v_mfma_f32_32x32x16_bf16 a[48:63], a[164:167], v[92:95], a[48:63]
    ds_read_b64_tr_b16 v[54:55], v11 offset:1024
    ds_read_b64_tr_b16 v[56:57], v10 offset:2048
    ds_read_b64_tr_b16 v[58:59], v10 offset:3072
    v_mfma_f32_32x32x16_bf16 a[32:47], a[168:171], v[96:99], a[32:47]
    ds_read_b64_tr_b16 v[60:61], v11 offset:2048
    ds_read_b64_tr_b16 v[62:63], v11 offset:3072
    ds_read_b64_tr_b16 v[64:65], v10 offset:4096
    s_add_u32 s39, s94, 14
    s_and_b32 s39, s39, 15
    v_mfma_f32_32x32x16_bf16 a[48:63], a[172:175], v[96:99], a[48:63]
    ds_read_b64_tr_b16 v[66:67], v10 offset:5120
    ds_read_b64_tr_b16 v[68:69], v11 offset:4096
    ds_read_b64_tr_b16 v[70:71], v11 offset:5120
    s_lshl_b32 s39, s39, 12
    v_mfma_f32_32x32x16_bf16 a[32:47], a[176:179], v[100:103], a[32:47]
    ds_read_b64_tr_b16 v[72:73], v10 offset:6144
    ds_read_b64_tr_b16 v[74:75], v10 offset:7168
    ds_read_b64_tr_b16 v[76:77], v11 offset:6144
    s_add_u32 s39, s39, s91
    s_add_u32 s39, s39, 3145728
    v_mfma_f32_32x32x16_bf16 a[48:63], a[180:183], v[100:103], a[48:63]
    ds_read_b64_tr_b16 v[78:79], v11 offset:7168
    buffer_load_dwordx4 v[156:159], v28, s[28:31], s39 offen offset:0 sc1
    v_mfma_f32_32x32x16_bf16 a[32:47], a[184:187], v[104:107], a[32:47]
    buffer_load_dwordx4 v[32:35], v28, s[28:31], s39 offen offset:1024 sc1
    buffer_load_dwordx4 v[176:179], v28, s[28:31], s39 offen offset:2048 sc1
    v_mfma_f32_32x32x16_bf16 a[48:63], a[188:191], v[104:107], a[48:63]
    buffer_load_dwordx4 v[180:183], v28, s[28:31], s39 offen offset:3072 sc1
    s_waitcnt lgkmcnt(0)
    s_waitcnt vmcnt(12)
    v_mfma_f32_32x32x16_bf16 a[32:47], v[48:51], v[108:111], a[32:47]
    s_add_u32 s39, s94, 15
    s_and_b32 s39, s39, 15
    v_mfma_f32_32x32x16_bf16 a[48:63], v[52:55], v[108:111], a[48:63]
    s_lshl_b32 s39, s39, 12
    v_mfma_f32_32x32x16_bf16 a[32:47], v[56:59], v[112:115], a[32:47]
    s_add_u32 s39, s39, s91
    v_mfma_f32_32x32x16_bf16 a[48:63], v[60:63], v[112:115], a[48:63]
    s_add_u32 s39, s39, 3145728
    v_mfma_f32_32x32x16_bf16 a[32:47], v[64:67], v[116:119], a[32:47]
    buffer_load_dwordx4 v[184:187], v28, s[28:31], s39 offen offset:0 sc1
    v_mfma_f32_32x32x16_bf16 a[48:63], v[68:71], v[116:119], a[48:63]
    buffer_load_dwordx4 v[188:191], v28, s[28:31], s39 offen offset:1024 sc1
    v_mfma_f32_32x32x16_bf16 a[32:47], v[72:75], v[120:123], a[32:47]
    buffer_load_dwordx4 v[88:91], v28, s[28:31], s39 offen offset:2048 sc1
    v_mfma_f32_32x32x16_bf16 a[48:63], v[76:79], v[120:123], a[48:63]
    buffer_load_dwordx4 v[92:95], v28, s[28:31], s39 offen offset:3072 sc1
    s_waitcnt vmcnt(12)
    v_mfma_f32_32x32x16_bf16 a[32:47], a[192:195], v[124:127], a[32:47]
    ds_read_b64_tr_b16 a[64:65], v6 offset:0
    ds_read_b64_tr_b16 a[66:67], v6 offset:1024
    ds_read_b64_tr_b16 a[68:69], v7 offset:0
    v_mfma_f32_32x32x16_bf16 a[48:63], a[196:199], v[124:127], a[48:63]
    ds_read_b64_tr_b16 a[70:71], v7 offset:1024
    ds_read_b64_tr_b16 a[72:73], v6 offset:2048
    ds_read_b64_tr_b16 a[74:75], v6 offset:3072
    v_mfma_f32_32x32x16_bf16 a[32:47], a[200:203], v[128:131], a[32:47]
    ds_read_b64_tr_b16 a[76:77], v7 offset:2048
    ds_read_b64_tr_b16 a[78:79], v7 offset:3072
    ds_read_b64_tr_b16 a[80:81], v6 offset:4096
    s_add_u32 s39, s94, 5
    s_and_b32 s39, s39, 15
    v_mfma_f32_32x32x16_bf16 a[48:63], a[204:207], v[128:131], a[48:63]
    ds_read_b64_tr_b16 a[82:83], v6 offset:5120
    ds_read_b64_tr_b16 a[84:85], v7 offset:4096
    ds_read_b64_tr_b16 a[86:87], v7 offset:5120
    s_lshl_b32 s39, s39, 12
    v_mfma_f32_32x32x16_bf16 a[32:47], a[208:211], v[132:135], a[32:47]
    ds_read_b64_tr_b16 a[88:89], v6 offset:6144
    ds_read_b64_tr_b16 a[90:91], v6 offset:7168
    ds_read_b64_tr_b16 a[92:93], v7 offset:6144
    s_add_u32 s39, s39, s91
    s_add_u32 s39, s39, 3145728
    v_mfma_f32_32x32x16_bf16 a[48:63], a[212:215], v[132:135], a[48:63]
    ds_read_b64_tr_b16 a[94:95], v7 offset:7168
    buffer_load_dwordx4 v[96:99], v28, s[28:31], s39 offen offset:0 sc1
    v_mfma_f32_32x32x16_bf16 a[32:47], a[216:219], v[136:139], a[32:47]
    buffer_load_dwordx4 v[100:103], v28, s[28:31], s39 offen offset:1024 sc1
    buffer_load_dwordx4 v[104:107], v28, s[28:31], s39 offen offset:2048 sc1
    v_mfma_f32_32x32x16_bf16 a[48:63], a[220:223], v[136:139], a[48:63]
    buffer_load_dwordx4 v[108:111], v28, s[28:31], s39 offen offset:3072 sc1
    s_waitcnt lgkmcnt(0)
    s_waitcnt vmcnt(12)
    v_mfma_f32_32x32x16_bf16 a[0:15], a[64:67], v[36:39], a[0:15]
    ds_read_b64_tr_b16 a[96:97], v6 offset:32768
    ds_read_b64_tr_b16 a[98:99], v6 offset:33792
    ds_read_b64_tr_b16 a[100:101], v7 offset:32768
    v_mfma_f32_32x32x16_bf16 a[16:31], a[68:71], v[36:39], a[16:31]
    ds_read_b64_tr_b16 a[102:103], v7 offset:33792
    ds_read_b64_tr_b16 a[104:105], v6 offset:34816
    ds_read_b64_tr_b16 a[106:107], v6 offset:35840
    v_mfma_f32_32x32x16_bf16 a[32:47], a[64:67], v[140:143], a[32:47]
    ds_read_b64_tr_b16 a[108:109], v7 offset:34816
    ds_read_b64_tr_b16 a[110:111], v7 offset:35840
    ds_read_b64_tr_b16 a[112:113], v6 offset:36864
    s_add_u32 s39, s94, 6
    v_mfma_f32_32x32x16_bf16 a[48:63], a[68:71], v[140:143], a[48:63]
    ds_read_b64_tr_b16 a[114:115], v6 offset:37888
    ds_read_b64_tr_b16 a[116:117], v7 offset:36864
    ds_read_b64_tr_b16 a[118:119], v7 offset:37888
    s_and_b32 s39, s39, 15
    v_mfma_f32_32x32x16_bf16 a[0:15], a[72:75], v[40:43], a[0:15]
    ds_read_b64_tr_b16 a[120:121], v6 offset:38912
    ds_read_b64_tr_b16 a[122:123], v6 offset:39936
    ds_read_b64_tr_b16 a[124:125], v7 offset:38912
    v_mfma_f32_32x32x16_bf16 a[16:31], a[76:79], v[40:43], a[16:31]
    ds_read_b64_tr_b16 a[126:127], v7 offset:39936
    s_lshl_b32 s39, s39, 12
    v_mfma_f32_32x32x16_bf16 a[32:47], a[72:75], v[144:147], a[32:47]
    s_add_u32 s39, s39, s91
    v_mfma_f32_32x32x16_bf16 a[48:63], a[76:79], v[144:147], a[48:63]
    v_mfma_f32_32x32x16_bf16 a[0:15], a[80:83], v[44:47], a[0:15]
    s_add_u32 s39, s39, 3145728
    v_mfma_f32_32x32x16_bf16 a[16:31], a[84:87], v[44:47], a[16:31]
    buffer_load_dwordx4 v[112:115], v28, s[28:31], s39 offen offset:0 sc1
    v_mfma_f32_32x32x16_bf16 a[32:47], a[80:83], v[148:151], a[32:47]
    v_mfma_f32_32x32x16_bf16 a[48:63], a[84:87], v[148:151], a[48:63]
    buffer_load_dwordx4 v[116:119], v28, s[28:31], s39 offen offset:1024 sc1
    v_mfma_f32_32x32x16_bf16 a[0:15], a[88:91], v[16:19], a[0:15]
    buffer_load_dwordx4 v[120:123], v28, s[28:31], s39 offen offset:2048 sc1
    v_mfma_f32_32x32x16_bf16 a[16:31], a[92:95], v[16:19], a[16:31]
    v_mfma_f32_32x32x16_bf16 a[32:47], a[88:91], v[152:155], a[32:47]
    buffer_load_dwordx4 v[124:127], v28, s[28:31], s39 offen offset:3072 sc1
    v_mfma_f32_32x32x16_bf16 a[48:63], a[92:95], v[152:155], a[48:63]
    s_waitcnt lgkmcnt(0)
    s_waitcnt vmcnt(12)
    v_mfma_f32_32x32x16_bf16 a[0:15], a[96:99], v[20:23], a[0:15]
    ds_read_b64_tr_b16 a[128:129], v8 offset:0
    ds_read_b64_tr_b16 a[130:131], v8 offset:1024
    ds_read_b64_tr_b16 a[132:133], v9 offset:0
    v_mfma_f32_32x32x16_bf16 a[16:31], a[100:103], v[20:23], a[16:31]
    ds_read_b64_tr_b16 a[134:135], v9 offset:1024
    ds_read_b64_tr_b16 a[136:137], v8 offset:2048
    ds_read_b64_tr_b16 a[138:139], v8 offset:3072
    v_mfma_f32_32x32x16_bf16 a[32:47], a[96:99], v[156:159], a[32:47]
    ds_read_b64_tr_b16 a[140:141], v9 offset:2048
    ds_read_b64_tr_b16 a[142:143], v9 offset:3072
    ds_read_b64_tr_b16 a[144:145], v8 offset:4096
    s_add_u32 s39, s94, 7
    v_mfma_f32_32x32x16_bf16 a[48:63], a[100:103], v[156:159], a[48:63]
    ds_read_b64_tr_b16 a[146:147], v8 offset:5120
    ds_read_b64_tr_b16 a[148:149], v9 offset:4096
    ds_read_b64_tr_b16 a[150:151], v9 offset:5120
    s_and_b32 s39, s39, 15
    v_mfma_f32_32x32x16_bf16 a[0:15], a[104:107], v[24:27], a[0:15]
    ds_read_b64_tr_b16 a[152:153], v8 offset:6144
    ds_read_b64_tr_b16 a[154:155], v8 offset:7168
    ds_read_b64_tr_b16 a[156:157], v9 offset:6144
    v_mfma_f32_32x32x16_bf16 a[16:31], a[108:111], v[24:27], a[16:31]
    ds_read_b64_tr_b16 a[158:159], v9 offset:7168
    s_lshl_b32 s39, s39, 12
    v_mfma_f32_32x32x16_bf16 a[32:47], a[104:107], v[32:35], a[32:47]
    s_add_u32 s39, s39, s91
    v_mfma_f32_32x32x16_bf16 a[48:63], a[108:111], v[32:35], a[48:63]
    v_mfma_f32_32x32x16_bf16 a[0:15], a[112:115], v[80:83], a[0:15]
    s_add_u32 s39, s39, 3145728
    v_mfma_f32_32x32x16_bf16 a[16:31], a[116:119], v[80:83], a[16:31]
    buffer_load_dwordx4 v[128:131], v28, s[28:31], s39 offen offset:0 sc1
    v_mfma_f32_32x32x16_bf16 a[32:47], a[112:115], v[176:179], a[32:47]
    v_mfma_f32_32x32x16_bf16 a[48:63], a[116:119], v[176:179], a[48:63]
    buffer_load_dwordx4 v[132:135], v28, s[28:31], s39 offen offset:1024 sc1
    v_mfma_f32_32x32x16_bf16 a[0:15], a[120:123], v[84:87], a[0:15]
    buffer_load_dwordx4 v[136:139], v28, s[28:31], s39 offen offset:2048 sc1
    v_mfma_f32_32x32x16_bf16 a[16:31], a[124:127], v[84:87], a[16:31]
    v_mfma_f32_32x32x16_bf16 a[32:47], a[120:123], v[180:183], a[32:47]
    buffer_load_dwordx4 v[36:39], v28, s[28:31], s39 offen offset:3072 sc1
    v_mfma_f32_32x32x16_bf16 a[48:63], a[124:127], v[180:183], a[48:63]
    s_waitcnt lgkmcnt(0)
    s_waitcnt vmcnt(12)
    v_mfma_f32_32x32x16_bf16 a[0:15], a[128:131], v[160:163], a[0:15]
    v_and_b32 v2, 31, v1
    v_mfma_f32_32x32x16_bf16 a[16:31], a[132:135], v[160:163], a[16:31]
    v_lshrrev_b32 v3, 5, v1
    v_mfma_f32_32x32x16_bf16 a[32:47], a[128:131], v[184:187], a[32:47]
    v_and_b32 v5, 15, v1
    v_mfma_f32_32x32x16_bf16 a[48:63], a[132:135], v[184:187], a[48:63]
    v_xor_b32 v3, v3, v5
    v_mfma_f32_32x32x16_bf16 a[0:15], a[136:139], v[164:167], a[0:15]
    v_lshlrev_b32 v3, 4, v3
    v_mfma_f32_32x32x16_bf16 a[16:31], a[140:143], v[164:167], a[16:31]
    v_lshl_add_u32 v2, v2, 8, v3
    v_mfma_f32_32x32x16_bf16 a[32:47], a[136:139], v[188:191], a[32:47]
    s_add_u32 s41, s44, 98304
    v_mfma_f32_32x32x16_bf16 a[48:63], a[140:143], v[188:191], a[48:63]
    v_add_u32 v2, s41, v2
    v_mfma_f32_32x32x16_bf16 a[0:15], a[144:147], v[168:171], a[0:15]
    v_xor_b32 v48, 0, v2
    v_mfma_f32_32x32x16_bf16 a[16:31], a[148:151], v[168:171], a[16:31]
    v_xor_b32 v49, 32, v2
    v_mfma_f32_32x32x16_bf16 a[32:47], a[144:147], v[88:91], a[32:47]
    v_xor_b32 v50, 64, v2
    v_mfma_f32_32x32x16_bf16 a[48:63], a[148:151], v[88:91], a[48:63]
    v_xor_b32 v51, 96, v2
    v_mfma_f32_32x32x16_bf16 a[0:15], a[152:155], v[172:175], a[0:15]
    v_xor_b32 v52, 128, v2
    v_mfma_f32_32x32x16_bf16 a[16:31], a[156:159], v[172:175], a[16:31]
    v_xor_b32 v53, 160, v2
    v_mfma_f32_32x32x16_bf16 a[32:47], a[152:155], v[92:95], a[32:47]
    v_xor_b32 v54, 192, v2
    v_mfma_f32_32x32x16_bf16 a[48:63], a[156:159], v[92:95], a[48:63]
    v_xor_b32 v55, 224, v2
    s_waitcnt vmcnt(8)
    v_mfma_f32_32x32x16_bf16 a[32:47], a[224:227], v[96:99], a[32:47]
    s_lshr_b32 s48, s34, 1
    s_and_b32 s49, s34, 1
    s_lshl_b32 s40, s48, 15
    s_lshl_b32 s41, s49, 12
    v_mfma_f32_32x32x16_bf16 a[48:63], a[228:231], v[96:99], a[48:63]
    s_add_u32 s40, s40, s41
    s_add_u32 s40, s40, 98304
    v_lshrrev_b32 v3, 3, v1
    v_mfma_f32_32x32x16_bf16 a[32:47], a[232:235], v[100:103], a[32:47]
    v_and_b32 v5, 7, v1
    v_lshlrev_b32 v2, 1, v5
    v_xor_b32 v2, v2, v3
    v_lshlrev_b32 v2, 4, v2
    v_mfma_f32_32x32x16_bf16 a[48:63], a[236:239], v[100:103], a[48:63]
    v_lshl_add_u32 v2, v3, 8, v2
    v_add_u32 v56, s40, v2
    v_xor_b32 v57, 16, v56
    v_mfma_f32_32x32x16_bf16 a[32:47], a[240:243], v[104:107], a[32:47]
    v_xor_b32 v58, 2176, v56
    v_xor_b32 v59, 16, v58
    s_lshl_b32 s47, s57, 5
    v_mfma_f32_32x32x16_bf16 a[48:63], a[244:247], v[104:107], a[48:63]
    s_mul_i32 s48, s48, 384
    s_add_u32 s47, s47, s48
    s_lshl_b32 s49, s49, 4
    s_add_u32 s47, s47, s49
    v_mfma_f32_32x32x16_bf16 a[32:47], a[248:251], v[108:111], a[32:47]
    s_mul_i32 s47, s47, 2560
    s_mul_i32 s41, s35, 1280
    s_add_u32 s47, s47, s41
    v_mfma_f32_32x32x16_bf16 a[48:63], a[252:255], v[108:111], a[48:63]
    s_add_u32 s47, s47, s90
    v_mul_u32_u24 v3, 2560, v3
    v_lshl_add_u32 v60, v5, 4, v3
    s_waitcnt vmcnt(4)
    v_mfma_f32_32x32x16_bf16 a[32:47], v[192:195], v[112:115], a[32:47]
    ds_write_b128 v48, a[0:3] offset:0
    v_mfma_f32_32x32x16_bf16 a[48:63], v[196:199], v[112:115], a[48:63]
    ds_write_b128 v49, a[4:7] offset:0
    v_mfma_f32_32x32x16_bf16 a[32:47], v[200:203], v[116:119], a[32:47]
    ds_write_b128 v50, a[8:11] offset:0
    v_mfma_f32_32x32x16_bf16 a[48:63], v[204:207], v[116:119], a[48:63]
    ds_write_b128 v51, a[12:15] offset:0
    v_mfma_f32_32x32x16_bf16 a[32:47], v[208:211], v[120:123], a[32:47]
    ds_write_b128 v52, a[16:19] offset:0
    v_mfma_f32_32x32x16_bf16 a[48:63], v[212:215], v[120:123], a[48:63]
    ds_write_b128 v53, a[20:23] offset:0
    v_mfma_f32_32x32x16_bf16 a[32:47], v[216:219], v[124:127], a[32:47]
    ds_write_b128 v54, a[24:27] offset:0
    v_mfma_f32_32x32x16_bf16 a[48:63], v[220:223], v[124:127], a[48:63]
    ds_write_b128 v55, a[28:31] offset:0
    s_waitcnt vmcnt(0)
    v_mfma_f32_32x32x16_bf16 a[32:47], v[224:227], v[128:131], a[32:47]
    v_mfma_f32_32x32x16_bf16 a[48:63], v[228:231], v[128:131], a[48:63]
    v_mfma_f32_32x32x16_bf16 a[32:47], v[232:235], v[132:135], a[32:47]
    v_mfma_f32_32x32x16_bf16 a[48:63], v[236:239], v[132:135], a[48:63]
    v_mfma_f32_32x32x16_bf16 a[32:47], v[240:243], v[136:139], a[32:47]
    v_mfma_f32_32x32x16_bf16 a[48:63], v[244:247], v[136:139], a[48:63]
    v_mfma_f32_32x32x16_bf16 a[32:47], v[248:251], v[36:39], a[32:47]
    v_mfma_f32_32x32x16_bf16 a[48:63], v[252:255], v[36:39], a[48:63]
    s_nop 7
    s_nop 3
    ds_write_b128 v48, a[32:35] offset:32768
    ds_write_b128 v49, a[36:39] offset:32768
    ds_write_b128 v50, a[40:43] offset:32768
    ds_write_b128 v51, a[44:47] offset:32768
    ds_write_b128 v52, a[48:51] offset:32768
    ds_write_b128 v53, a[52:55] offset:32768
    ds_write_b128 v54, a[56:59] offset:32768
    ds_write_b128 v55, a[60:63] offset:32768
L_red:
    s_waitcnt lgkmcnt(0)
    s_barrier
    ds_read_b128 v[96:99], v56 offset:0
    ds_read_b128 v[100:103], v57 offset:0
    ds_read_b128 v[104:107], v56 offset:8192
    ds_read_b128 v[108:111], v57 offset:8192
    ds_read_b128 v[112:115], v56 offset:16384
    ds_read_b128 v[116:119], v57 offset:16384
    ds_read_b128 v[120:123], v56 offset:24576
    ds_read_b128 v[124:127], v57 offset:24576
    ds_read_b128 v[128:131], v58 offset:0
    ds_read_b128 v[132:135], v59 offset:0
    ds_read_b128 v[136:139], v58 offset:8192
    ds_read_b128 v[140:143], v59 offset:8192
    ds_read_b128 v[144:147], v58 offset:16384
    ds_read_b128 v[148:151], v59 offset:16384
    ds_read_b128 v[152:155], v58 offset:24576
    ds_read_b128 v[156:159], v59 offset:24576
    s_waitcnt lgkmcnt(8)
    v_add_f32 v96, v96, v104
    v_add_f32 v112, v112, v120
    v_add_f32 v97, v97, v105
    v_add_f32 v113, v113, v121
    v_add_f32 v98, v98, v106
    v_add_f32 v114, v114, v122
    v_add_f32 v99, v99, v107
    v_add_f32 v115, v115, v123
    v_add_f32 v100, v100, v108
    v_add_f32 v116, v116, v124
    v_add_f32 v101, v101, v109
    v_add_f32 v117, v117, v125
    v_add_f32 v102, v102, v110
    v_add_f32 v118, v118, v126
    v_add_f32 v103, v103, v111
    v_add_f32 v119, v119, v127
    v_add_f32 v96, v96, v112
    v_add_f32 v97, v97, v113
    v_add_f32 v98, v98, v114
    v_add_f32 v99, v99, v115
    v_add_f32 v100, v100, v116
    v_add_f32 v101, v101, v117
    v_add_f32 v102, v102, v118
    v_add_f32 v103, v103, v119
    v_cvt_pk_bf16_f32 v104, v96, v97
    v_cvt_pk_bf16_f32 v105, v98, v99
    v_cvt_pk_bf16_f32 v106, v100, v101
    v_cvt_pk_bf16_f32 v107, v102, v103
    buffer_store_dwordx4 v[104:107], v60, s[24:27], s47 offen
    s_waitcnt lgkmcnt(0)
    v_add_f32 v128, v128, v136
    v_add_f32 v144, v144, v152
    v_add_f32 v129, v129, v137
    v_add_f32 v145, v145, v153
    v_add_f32 v130, v130, v138
    v_add_f32 v146, v146, v154
    v_add_f32 v131, v131, v139
    v_add_f32 v147, v147, v155
    v_add_f32 v132, v132, v140
    v_add_f32 v148, v148, v156
    v_add_f32 v133, v133, v141
    v_add_f32 v149, v149, v157
    v_add_f32 v134, v134, v142
    v_add_f32 v150, v150, v158
    v_add_f32 v135, v135, v143
    v_add_f32 v151, v151, v159
    v_add_f32 v128, v128, v144
    v_add_f32 v129, v129, v145
    v_add_f32 v130, v130, v146
    v_add_f32 v131, v131, v147
    v_add_f32 v132, v132, v148
    v_add_f32 v133, v133, v149
    v_add_f32 v134, v134, v150
    v_add_f32 v135, v135, v151
    v_cvt_pk_bf16_f32 v136, v128, v129
    v_cvt_pk_bf16_f32 v137, v130, v131
    v_cvt_pk_bf16_f32 v138, v132, v133
    v_cvt_pk_bf16_f32 v139, v134, v135
    s_add_u32 s47, s47, 20480
    buffer_store_dwordx4 v[136:139], v60, s[24:27], s47 offen
L_exit:
    s_endpgm
L_end:
.section .rodata,"a"
.p2align 6
.amdhsa_kernel concat_heads__mha_block_cached__mha_block_cached__near_ridge_kernel
  .amdhsa_next_free_vgpr 512
  .amdhsa_next_free_sgpr 102
  .amdhsa_accum_offset 256
  .amdhsa_group_segment_fixed_size 0
  .amdhsa_kernarg_size 104
  .amdhsa_user_sgpr_count 2
  .amdhsa_user_sgpr_kernarg_segment_ptr 1
  .amdhsa_system_sgpr_workgroup_id_x 1
.end_amdhsa_kernel
```
